```python
import torch

def _softmax(x, axis=-1):
    return torch.softmax(x, dim=axis)
def _gelu(x):
    return torch.nn.functional.gelu(x, approximate="tanh")
def _silu(x):
    return torch.nn.functional.silu(x)
def _sigmoid(x):
    return torch.sigmoid(x)
def _layernorm(x, axis=-1, eps=1e-5):
    m = x.mean(dim=axis, keepdim=True)
    v = x.var(dim=axis, keepdim=True, unbiased=False)
    return (x - m) / torch.sqrt(v + eps)
def _scatter_add(tgt, idx, src, axis=0):
    return tgt.clone().index_add_(axis, idx, src)
def _segment_sum(src, seg, n):
    out = torch.zeros((n,) + src.shape[1:], dtype=src.dtype)
    return out.index_add_(0, seg, src)
def _pad(x, pw):
    flat = tuple(v for pair in reversed(pw) for v in pair)
    return torch.nn.functional.pad(x, flat)

kernel_name = 'concat_heads__gqa_block_cached__gqa_block_cached__near_ridge'

def setup_inputs():

    _w = (lambda a: (lambda t: t.to(torch.bfloat16) if t.is_floating_point() else t)(torch.as_tensor(a)))
    def _A_setup():
        B, Sq, D = 8, 160, 512
        Hq, Hkv, Sk, Dh = 32, 32, 512, 128
        assert Hq % Hkv == 0, (Hq, Hkv)
        return {
            "x": _w((lambda *s: torch.randn(*s, dtype=torch.bfloat16) * 0.8)(B, Sq, D)),
            "k_cache": _w((lambda *s: torch.randn(*s, dtype=torch.bfloat16) * 0.8)(B, Hkv, Sk, Dh)),
            "v_cache": _w((lambda *s: torch.randn(*s, dtype=torch.bfloat16) * 0.05)(B, Hkv, Sk, Dh)),
            "wq": _w((lambda *s: torch.randn(*s, dtype=torch.bfloat16) * 0.8)(D, Hq * Dh) * (D ** -0.5)),
            "wo": _w((lambda *s: torch.randn(*s, dtype=torch.bfloat16) * 0.05)(Hq * Dh, D) * ((Hq * Dh) ** -0.5)),
        }
    _A_in = _A_setup()

    def _B_setup():
        B, Sq, D = 8, 160, 512
        Hq, Hkv, Sk, Dh = 32, 32, 512, 128
        assert Hq % Hkv == 0, (Hq, Hkv)
        return {
            "x": _w((lambda *s: torch.randn(*s, dtype=torch.bfloat16) * 0.8)(B, Sq, D)),
            "k_cache": _w((lambda *s: torch.randn(*s, dtype=torch.bfloat16) * 0.8)(B, Hkv, Sk, Dh)),
            "v_cache": _w((lambda *s: torch.randn(*s, dtype=torch.bfloat16) * 0.05)(B, Hkv, Sk, Dh)),
            "wq": _w((lambda *s: torch.randn(*s, dtype=torch.bfloat16) * 0.8)(D, Hq * Dh) * (D ** -0.5)),
            "wo": _w((lambda *s: torch.randn(*s, dtype=torch.bfloat16) * 0.05)(Hq * Dh, D) * ((Hq * Dh) ** -0.5)),
        }
    _B_in = _B_setup()

    return {
        "A_x": _A_in["x"],
        "A_k_cache": _A_in["k_cache"],
        "A_v_cache": _A_in["v_cache"],
        "A_wq": _A_in["wq"],
        "A_wo": _A_in["wo"],
        "B_x": _B_in["x"],
        "B_k_cache": _B_in["k_cache"],
        "B_v_cache": _B_in["v_cache"],
        "B_wq": _B_in["wq"],
        "B_wo": _B_in["wo"],
    }

def reference(A_x, A_k_cache, A_v_cache, A_wq, A_wo, B_x, B_k_cache, B_v_cache, B_wq, B_wo):
    def _A_ref(x, k_cache, v_cache, wq, wo):
        B, Sq, D = x.shape
        Hq, Dh = 32, 128
        Hkv = k_cache.shape[1]
        rep = Hq // Hkv
        q = (lambda x, *d: x.permute(*d))((x @ wq).reshape(B, Sq, Hq, Dh), 0, 2, 1, 3)
        k = (lambda x, n, axis: torch.repeat_interleave(x, n, dim=axis))(k_cache, rep, axis=1)
        v = (lambda x, n, axis: torch.repeat_interleave(x, n, dim=axis))(v_cache, rep, axis=1)
        scores = torch.einsum("bhqd,bhkd->bhqk", q, k) * (Dh ** -0.5)
        p = _softmax(scores, axis=-1)
        o = torch.einsum("bhqk,bhkd->bhqd", p, v)
        return (lambda x, *d: x.permute(*d))(o, 0, 2, 1, 3).reshape(B, Sq, Hq * Dh) @ wo

    def _B_ref(x, k_cache, v_cache, wq, wo):
        B, Sq, D = x.shape
        Hq, Dh = 32, 128
        Hkv = k_cache.shape[1]
        rep = Hq // Hkv
        q = (lambda x, *d: x.permute(*d))((x @ wq).reshape(B, Sq, Hq, Dh), 0, 2, 1, 3)
        k = (lambda x, n, axis: torch.repeat_interleave(x, n, dim=axis))(k_cache, rep, axis=1)
        v = (lambda x, n, axis: torch.repeat_interleave(x, n, dim=axis))(v_cache, rep, axis=1)
        scores = torch.einsum("bhqd,bhkd->bhqk", q, k) * (Dh ** -0.5)
        p = _softmax(scores, axis=-1)
        o = torch.einsum("bhqk,bhkd->bhqd", p, v)
        return (lambda x, *d: x.permute(*d))(o, 0, 2, 1, 3).reshape(B, Sq, Hq * Dh) @ wo

    a = _A_ref(A_x, A_k_cache, A_v_cache, A_wq, A_wo)
    b = _B_ref(B_x, B_k_cache, B_v_cache, B_wq, B_wo)
    return torch.concatenate([a, b], axis=-1)
```

```asm
; @launch kernel=attn_kernel grid=(256,1,1) block=(256,1,1) lds=163840
; @launch kernel=reduce_kernel grid=(256,1,1) block=(640,1,1) lds=0
.amdgcn_target "amdgcn-amd-amdhsa--gfx950"
.text
.globl attn_kernel
.p2align 8
.type attn_kernel,@function
attn_kernel:

    s_cmp_ge_u32 s2, 256
    s_cbranch_scc1 L_end_attn_kernel
    s_mov_b32 s92, 0
    s_getpc_b64 s[66:67]
L_pce_attn_kernel:
    s_sub_u32 s66, s66, L_pce_attn_kernel-attn_kernel
    s_subb_u32 s67, s67, 0
    v_lshlrev_b32 v74, 7, v0
    v_min_u32 v75, CODE_END-attn_kernel-4, v74
    global_load_dword v76, v75, s[66:67]
    v_add_u32 v74, 0x8000, v74
    v_min_u32 v75, CODE_END-attn_kernel-4, v74
    global_load_dword v77, v75, s[66:67]
L_restart_attn_kernel:
    s_load_dwordx8 s[52:59], s[0:1], 0
    s_load_dwordx8 s[60:67], s[0:1], 40
    s_load_dwordx2 s[68:69], s[0:1], 96
    s_load_dwordx2 s[98:99], s[0:1], 32
    s_load_dwordx2 s[100:101], s[0:1], 72
    v_lshrrev_b32 v56, 6, v0
    v_and_b32 v57, 63, v0
    v_readfirstlane_b32 s4, v56
    s_and_b32 s3, s2, 7
    s_lshr_b32 s45, s2, 3
    s_lshr_b32 s48, s3, 2
    s_and_b32 s46, s3, 3
    s_lshr_b32 s47, s45, 2
    s_and_b32 s7, s45, 3
    s_lshr_b32 s5, s4, 1
    s_and_b32 s6, s4, 1
    s_lshl_b32 s49, s46, 3
    s_lshl_b32 s7, s7, 1
    s_add_u32 s49, s49, s7
    s_add_u32 s49, s49, s5
    v_and_b32 v58, 15, v57
    v_lshrrev_b32 v59, 4, v57
    v_bfe_u32 v60, v57, 2, 2
    v_and_b32 v61, 3, v57
    v_lshlrev_b32 v62, 2, v59
    v_xor_b32 v62, v62, v58
    v_lshlrev_b32 v62, 4, v62
    v_lshl_add_u32 v46, v59, 13, v62
    v_add_u32 v47, 31744, v46
    v_add_u32 v48, 63480, v46
    v_add_u32 v49, 95224, v46
    v_and_b32 v62, 7, v57
    v_xor_b32 v62, v62, v59
    v_lshlrev_b32 v62, 4, v62
    v_lshrrev_b32 v63, 3, v57
    v_lshl_add_u32 v62, v63, 10, v62
    s_and_b32 s3, s4, 1
    s_lshl_b32 s3, s3, 6
    v_xor_b32 v62, s3, v62
    v_xor_b32 v63, 64, v62
    v_add_u32 v50, 0, v62
    v_add_u32 v51, 7168, v63
    v_add_u32 v52, 14336, v62
    v_add_u32 v53, 21504, v63
    v_add_u32 v54, 32768, v62
    v_xor_b32 v62, v58, v59
    v_lshlrev_b32 v62, 4, v62
    v_lshl_add_u32 v252, v59, 8, v62
    v_xor_b32 v253, 64, v252
    v_xor_b32 v254, 0x80, v252
    v_xor_b32 v255, 0xc0, v252
    v_lshlrev_b32 v62, 1, v59
    v_xor_b32 v62, v62, v58
    v_lshlrev_b32 v62, 4, v62
    v_lshl_add_u32 v70, v59, 8, v62
    v_xor_b32 v71, 0x80, v70
    s_mul_i32 s3, s5, 8224
    s_add_u32 s3, s3, 32768
    v_mul_u32_u24 v62, 2056, v59
    v_lshl_add_u32 v62, v60, 8, v62
    v_lshl_add_u32 v62, v61, 4, v62
    v_add_u32 v62, s3, v62
    s_mul_i32 s7, s6, 4112
    s_add_u32 s35, s3, s7
    s_lshl_b32 s38, s6, 17
    v_xor_b32 v63, 0, v60
    v_lshl_add_u32 v40, v63, 6, v62
    v_xor_b32 v63, 1, v60
    v_lshl_add_u32 v41, v63, 6, v62
    v_xor_b32 v63, 2, v60
    v_lshl_add_u32 v42, v63, 6, v62
    v_xor_b32 v63, 3, v60
    v_lshl_add_u32 v43, v63, 6, v62
    s_mul_i32 s3, s6, 10240
    s_add_u32 s3, s3, 82176
    v_lshrrev_b32 v62, 1, v58
    v_xor_b32 v62, v62, v59
    v_lshlrev_b32 v62, 4, v62
    v_lshl_add_u32 v62, v58, 7, v62
    v_add_u32 v44, s3, v62
    v_xor_b32 v45, 64, v44
    s_mul_i32 s36, s4, 5120
    s_add_u32 s36, s36, 82176
    s_mul_i32 s37, s4, 40960
    s_lshl_b32 s3, s5, 13
    s_lshl_b32 s7, s6, 12
    s_add_u32 s39, s3, s7
    v_xor_b32 v62, v59, v58
    v_lshlrev_b32 v62, 4, v62
    v_lshl_add_u32 v62, v58, 8, v62
    v_add_u32 v240, s3, v62
    v_xor_b32 v241, 64, v240
    v_xor_b32 v242, 0x80, v240
    v_xor_b32 v243, 0xc0, v240
    v_lshlrev_b32 v72, 4, v57
    v_add_u32 v72, s39, v72
    v_add_u32 v73, 98304, v72
    s_add_u32 s3, s3, 0x20000
    v_lshl_add_u32 v62, v59, 2, v60
    v_and_b32 v63, 7, v62
    v_lshlrev_b32 v62, 8, v62
    v_lshl_add_u32 v62, v63, 5, v62
    v_lshl_add_u32 v62, v61, 3, v62
    v_add_u32 v244, s3, v62
    v_xor_b32 v245, 32, v244
    v_xor_b32 v246, 64, v244
    v_xor_b32 v247, 96, v244
    v_xor_b32 v248, 128, v244
    v_xor_b32 v249, 160, v244
    v_xor_b32 v250, 192, v244
    v_xor_b32 v251, 224, v244
    s_waitcnt lgkmcnt(0)
    s_cmp_eq_u32 s48, 0
    s_cselect_b32 s52, s52, s60
    s_cselect_b32 s53, s53, s61
    s_cselect_b32 s54, s54, s62
    s_cselect_b32 s55, s55, s63
    s_cselect_b32 s56, s56, s64
    s_cselect_b32 s57, s57, s65
    s_cselect_b32 s58, s58, s66
    s_cselect_b32 s59, s59, s67
    s_lshl_b32 s3, s49, 8
    s_add_u32 s12, s58, s3
    s_addc_u32 s13, s59, 0
    s_sub_u32 s14, 4194304, s3
    s_mov_b32 s15, 0x20000
    s_mul_i32 s3, s47, 163840
    s_add_u32 s8, s52, s3
    s_addc_u32 s9, s53, 0
    s_mov_b32 s10, 163840
    s_mov_b32 s11, 0x20000
    s_and_b32 s3, s45, 3
    s_lshl_b32 s3, s3, 0
    s_add_u32 s3, s3, s47
    s_and_b32 s3, s3, 1
    s_mul_i32 s3, s3, 4
    s_lshl_b32 s51, s3, 7
    s_lshl_b32 s3, s3, 19
    s_add_u32 s38, s38, s3
    s_add_u32 m0, s35, 0
    s_nop 0
    buffer_load_dwordx4 v46, s[12:15], s38 offen offset:0  lds
    buffer_load_dwordx4 v47, s[12:15], s38 offen offset:1024  lds
    buffer_load_dwordx4 v48, s[12:15], s38 offen offset:2056  lds
    buffer_load_dwordx4 v49, s[12:15], s38 offen offset:3080  lds
    s_add_u32 s38, s38, 262144
    s_and_b32 s38, s38, 0x3fffff
    s_add_u32 m0, s36, 0
    s_add_u32 s33, s37, s51
    buffer_load_dwordx4 v50, s[8:11], s33 offen offset:0  lds
    buffer_load_dwordx4 v51, s[8:11], s33 offen offset:1024  lds
    buffer_load_dwordx4 v52, s[8:11], s33 offen offset:2048  lds
    buffer_load_dwordx4 v53, s[8:11], s33 offen offset:3072  lds
    s_add_u32 m0, s36, 4096
    s_nop 0
    buffer_load_dwordx4 v54, s[8:11], s33 offen offset:0  lds
    s_add_u32 s51, s51, 128
    s_and_b32 s51, s51, 0x3ff
    s_add_u32 m0, s35, 16448
    s_nop 0
    buffer_load_dwordx4 v46, s[12:15], s38 offen offset:0  lds
    buffer_load_dwordx4 v47, s[12:15], s38 offen offset:1024  lds
    buffer_load_dwordx4 v48, s[12:15], s38 offen offset:2056  lds
    buffer_load_dwordx4 v49, s[12:15], s38 offen offset:3080  lds
    s_add_u32 s38, s38, 262144
    s_and_b32 s38, s38, 0x3fffff
    s_lshl_b32 s3, s47, 5
    s_add_u32 s3, s3, s49
    s_lshl_b32 s3, s3, 17
    s_add_u32 s16, s54, s3
    s_addc_u32 s17, s55, 0
    s_mov_b32 s18, 131072
    s_mov_b32 s19, 0x20000
    s_add_u32 s20, s56, s3
    s_addc_u32 s21, s57, 0
    s_mov_b32 s22, 131072
    s_mov_b32 s23, 0x20000
    s_lshl_b32 s3, s48, 3
    s_add_u32 s3, s3, s47
    s_lshl_b32 s3, s3, 1
    s_add_u32 s3, s3, s6
    s_lshl_b32 s3, s3, 5
    s_add_u32 s3, s3, s49
    s_mul_i32 s3, s3, 20480
    s_add_u32 s24, s68, s3
    s_addc_u32 s25, s69, 0
    s_mov_b32 s26, 20480
    s_mov_b32 s27, 0x20000
    s_mov_b32 s50, 0x3e0293ee
    s_mul_i32 s3, s2, 0
    s_lshr_b32 s3, s3, 3
    s_and_b32 s3, s3, 0
    s_lshl_b32 s3, s3, 13
    s_lshl_b32 s93, s6, 12
    s_add_u32 s93, s93, s3
    s_add_u32 s63, s93, 0x20000
    v_mov_b32 v64, 0x3f803f80
    v_accvgpr_write_b32 a180, v64
    v_accvgpr_write_b32 a181, v64
    v_accvgpr_write_b32 a182, v64
    v_accvgpr_write_b32 a183, v64
    s_waitcnt lgkmcnt(0)
    s_waitcnt vmcnt(4)
    s_barrier
    ds_read_b64_tr_b16 a[184:185], v40 offset:0
    ds_read_b64_tr_b16 a[186:187], v40 offset:1024
    ds_read_b128 v[0:3], v44 offset:0
    ds_read_b128 v[4:7], v44 offset:2048
    ds_read_b128 v[8:11], v44 offset:4096
    ds_read_b128 v[12:15], v44 offset:6144
    ds_read_b128 v[16:19], v44 offset:8192
    ds_read_b64_tr_b16 a[188:189], v40 offset:8
    ds_read_b64_tr_b16 a[190:191], v40 offset:1032
    ds_read_b64_tr_b16 a[192:193], v41 offset:0
    ds_read_b64_tr_b16 a[194:195], v41 offset:1024
    s_waitcnt lgkmcnt(8)
    v_mfma_f32_16x16x32_bf16 v[80:83], a[184:187], v[0:3], 0
    s_waitcnt lgkmcnt(7)
    ds_read_b64_tr_b16 a[196:197], v41 offset:8
    v_mfma_f32_16x16x32_bf16 v[84:87], a[184:187], v[4:7], 0
    s_waitcnt lgkmcnt(7)
    ds_read_b64_tr_b16 a[198:199], v41 offset:1032
    v_mfma_f32_16x16x32_bf16 v[88:91], a[184:187], v[8:11], 0
    s_waitcnt lgkmcnt(7)
    s_add_u32 m0, s35, 32896
    v_mfma_f32_16x16x32_bf16 v[92:95], a[184:187], v[12:15], 0
    s_waitcnt lgkmcnt(6)
    buffer_load_dwordx4 v46, s[12:15], s38 offen offset:0  lds
    v_mfma_f32_16x16x32_bf16 v[96:99], a[184:187], v[16:19], 0
    s_waitcnt lgkmcnt(4)
    buffer_load_dwordx4 v47, s[12:15], s38 offen offset:1024  lds
    v_mfma_f32_16x16x32_bf16 v[100:103], a[188:191], v[0:3], 0
    ds_read_b64_tr_b16 a[200:201], v42 offset:0
    v_mfma_f32_16x16x32_bf16 v[104:107], a[188:191], v[4:7], 0
    ds_read_b64_tr_b16 a[202:203], v42 offset:1024
    v_mfma_f32_16x16x32_bf16 v[108:111], a[188:191], v[8:11], 0
    buffer_load_dwordx4 v48, s[12:15], s38 offen offset:2056  lds
    v_mfma_f32_16x16x32_bf16 v[112:115], a[188:191], v[12:15], 0
    buffer_load_dwordx4 v49, s[12:15], s38 offen offset:3080  lds
    v_mfma_f32_16x16x32_bf16 v[116:119], a[188:191], v[16:19], 0
    s_waitcnt lgkmcnt(4)
    s_add_u32 s38, s38, 262144
    s_and_b32 s38, s38, 0x3fffff
    v_mfma_f32_16x16x32_bf16 v[120:123], a[192:195], v[0:3], 0
    s_add_u32 m0, s36, 20480
    ds_read_b64_tr_b16 a[204:205], v42 offset:8
    v_mfma_f32_16x16x32_bf16 v[124:127], a[192:195], v[4:7], 0
    s_add_u32 s33, s37, s51
    ds_read_b64_tr_b16 a[206:207], v42 offset:1032
    v_mfma_f32_16x16x32_bf16 v[128:131], a[192:195], v[8:11], 0
    ds_read_b64_tr_b16 a[208:209], v43 offset:0
    v_mfma_f32_16x16x32_bf16 v[132:135], a[192:195], v[12:15], 0
    ds_read_b64_tr_b16 a[210:211], v43 offset:1024
    v_mfma_f32_16x16x32_bf16 v[136:139], a[192:195], v[16:19], 0
    s_waitcnt lgkmcnt(6)
    ds_read_b64_tr_b16 a[212:213], v43 offset:8
    v_mfma_f32_16x16x32_bf16 v[140:143], a[196:199], v[0:3], 0
    ds_read_b64_tr_b16 a[214:215], v43 offset:1032
    v_mfma_f32_16x16x32_bf16 v[144:147], a[196:199], v[4:7], 0
    buffer_load_dwordx4 v50, s[8:11], s33 offen offset:0  lds
    v_mfma_f32_16x16x32_bf16 v[148:151], a[196:199], v[8:11], 0
    buffer_load_dwordx4 v51, s[8:11], s33 offen offset:1024  lds
    v_mfma_f32_16x16x32_bf16 v[152:155], a[196:199], v[12:15], 0
    buffer_load_dwordx4 v52, s[8:11], s33 offen offset:2048  lds
    v_mfma_f32_16x16x32_bf16 v[156:159], a[196:199], v[16:19], 0
    s_waitcnt lgkmcnt(6)
    buffer_load_dwordx4 v53, s[8:11], s33 offen offset:3072  lds
    v_mfma_f32_16x16x32_bf16 v[160:163], a[200:203], v[0:3], 0
    s_add_u32 m0, s36, 24576
    s_nop 0
    v_mfma_f32_16x16x32_bf16 v[164:167], a[200:203], v[4:7], 0
    buffer_load_dwordx4 v54, s[8:11], s33 offen offset:0  lds
    v_mfma_f32_16x16x32_bf16 v[168:171], a[200:203], v[8:11], 0
    s_add_u32 s51, s51, 128
    s_and_b32 s51, s51, 0x3ff
    v_mfma_f32_16x16x32_bf16 v[172:175], a[200:203], v[12:15], 0
    v_mfma_f32_16x16x32_bf16 v[176:179], a[200:203], v[16:19], 0
    s_waitcnt lgkmcnt(0)
    s_waitcnt vmcnt(9)
    s_barrier
    v_mfma_f32_16x16x32_bf16 v[180:183], a[204:207], v[0:3], 0
    s_add_u32 m0, s35, 0
    ds_read_b64_tr_b16 a[184:185], v40 offset:16448
    v_mfma_f32_16x16x32_bf16 v[184:187], a[204:207], v[4:7], 0
    ds_read_b64_tr_b16 a[186:187], v40 offset:17472
    v_mfma_f32_16x16x32_bf16 v[188:191], a[204:207], v[8:11], 0
    ds_read_b128 v[20:23], v45 offset:0
    v_mfma_f32_16x16x32_bf16 v[192:195], a[204:207], v[12:15], 0
    ds_read_b128 v[24:27], v45 offset:2048
    v_mfma_f32_16x16x32_bf16 v[196:199], a[204:207], v[16:19], 0
    ds_read_b128 v[28:31], v45 offset:4096
    v_mfma_f32_16x16x32_bf16 v[200:203], a[208:211], v[0:3], 0
    ds_read_b128 v[32:35], v45 offset:6144
    v_mfma_f32_16x16x32_bf16 v[204:207], a[208:211], v[4:7], 0
    ds_read_b128 v[36:39], v45 offset:8192
    v_mfma_f32_16x16x32_bf16 v[208:211], a[208:211], v[8:11], 0
    ds_read_b64_tr_b16 a[188:189], v40 offset:16456
    v_mfma_f32_16x16x32_bf16 v[212:215], a[208:211], v[12:15], 0
    ds_read_b64_tr_b16 a[190:191], v40 offset:17480
    v_mfma_f32_16x16x32_bf16 v[216:219], a[208:211], v[16:19], 0
    ds_read_b64_tr_b16 a[192:193], v41 offset:16448
    v_mfma_f32_16x16x32_bf16 v[220:223], a[212:215], v[0:3], 0
    ds_read_b64_tr_b16 a[194:195], v41 offset:17472
    v_mfma_f32_16x16x32_bf16 v[224:227], a[212:215], v[4:7], 0
    buffer_load_dwordx4 v46, s[12:15], s38 offen offset:0  lds
    v_mfma_f32_16x16x32_bf16 v[228:231], a[212:215], v[8:11], 0
    buffer_load_dwordx4 v47, s[12:15], s38 offen offset:1024  lds
    v_mfma_f32_16x16x32_bf16 v[232:235], a[212:215], v[12:15], 0
    buffer_load_dwordx4 v48, s[12:15], s38 offen offset:2056  lds
    v_mfma_f32_16x16x32_bf16 v[236:239], a[212:215], v[16:19], 0
    s_waitcnt lgkmcnt(8)
    buffer_load_dwordx4 v49, s[12:15], s38 offen offset:3080  lds
    v_mfma_f32_16x16x32_bf16 v[80:83], a[184:187], v[20:23], v[80:83]
    s_waitcnt lgkmcnt(7)
    ds_read_b64_tr_b16 a[196:197], v41 offset:16456
    v_mfma_f32_16x16x32_bf16 v[84:87], a[184:187], v[24:27], v[84:87]
    s_waitcnt lgkmcnt(7)
    ds_read_b64_tr_b16 a[198:199], v41 offset:17480
    v_mfma_f32_16x16x32_bf16 v[88:91], a[184:187], v[28:31], v[88:91]
    s_waitcnt lgkmcnt(7)
    s_add_u32 s38, s38, 262144
    s_and_b32 s38, s38, 0x3fffff
    v_mfma_f32_16x16x32_bf16 v[92:95], a[184:187], v[32:35], v[92:95]
    s_waitcnt lgkmcnt(6)
    v_mfma_f32_16x16x32_bf16 v[96:99], a[184:187], v[36:39], v[96:99]
    s_waitcnt lgkmcnt(4)
    v_mfma_f32_16x16x32_bf16 v[100:103], a[188:191], v[20:23], v[100:103]
    ds_read_b64_tr_b16 a[200:201], v42 offset:16448
    v_mfma_f32_16x16x32_bf16 v[104:107], a[188:191], v[24:27], v[104:107]
    ds_read_b64_tr_b16 a[202:203], v42 offset:17472
    v_mfma_f32_16x16x32_bf16 v[108:111], a[188:191], v[28:31], v[108:111]
    v_mfma_f32_16x16x32_bf16 v[112:115], a[188:191], v[32:35], v[112:115]
    v_mfma_f32_16x16x32_bf16 v[116:119], a[188:191], v[36:39], v[116:119]
    s_waitcnt lgkmcnt(4)
    v_mfma_f32_16x16x32_bf16 v[120:123], a[192:195], v[20:23], v[120:123]
    ds_read_b64_tr_b16 a[204:205], v42 offset:16456
    v_mfma_f32_16x16x32_bf16 v[124:127], a[192:195], v[24:27], v[124:127]
    ds_read_b64_tr_b16 a[206:207], v42 offset:17480
    v_mfma_f32_16x16x32_bf16 v[128:131], a[192:195], v[28:31], v[128:131]
    ds_read_b64_tr_b16 a[208:209], v43 offset:16448
    v_mfma_f32_16x16x32_bf16 v[132:135], a[192:195], v[32:35], v[132:135]
    ds_read_b64_tr_b16 a[210:211], v43 offset:17472
    v_mfma_f32_16x16x32_bf16 v[136:139], a[192:195], v[36:39], v[136:139]
    s_waitcnt lgkmcnt(6)
    ds_read_b64_tr_b16 a[212:213], v43 offset:16456
    v_mfma_f32_16x16x32_bf16 v[140:143], a[196:199], v[20:23], v[140:143]
    ds_read_b64_tr_b16 a[214:215], v43 offset:17480
    v_mfma_f32_16x16x32_bf16 v[144:147], a[196:199], v[24:27], v[144:147]
    v_mfma_f32_16x16x32_bf16 v[148:151], a[196:199], v[28:31], v[148:151]
    v_mfma_f32_16x16x32_bf16 v[152:155], a[196:199], v[32:35], v[152:155]
    v_mfma_f32_16x16x32_bf16 v[156:159], a[196:199], v[36:39], v[156:159]
    s_waitcnt lgkmcnt(6)
    v_mfma_f32_16x16x32_bf16 v[160:163], a[200:203], v[20:23], v[160:163]
    v_mfma_f32_16x16x32_bf16 v[164:167], a[200:203], v[24:27], v[164:167]
    v_mfma_f32_16x16x32_bf16 v[168:171], a[200:203], v[28:31], v[168:171]
    v_mfma_f32_16x16x32_bf16 v[172:175], a[200:203], v[32:35], v[172:175]
    v_mfma_f32_16x16x32_bf16 v[176:179], a[200:203], v[36:39], v[176:179]
    s_waitcnt lgkmcnt(0)
    s_waitcnt vmcnt(4)
    s_barrier
    v_mfma_f32_16x16x32_bf16 v[180:183], a[204:207], v[20:23], v[180:183]
    s_add_u32 m0, s35, 16448
    ds_read_b64_tr_b16 a[184:185], v40 offset:32896
    v_mfma_f32_16x16x32_bf16 v[184:187], a[204:207], v[24:27], v[184:187]
    ds_read_b64_tr_b16 a[186:187], v40 offset:33920
    v_mfma_f32_16x16x32_bf16 v[188:191], a[204:207], v[28:31], v[188:191]
    ds_read_b128 v[0:3], v44 offset:20480
    v_mfma_f32_16x16x32_bf16 v[192:195], a[204:207], v[32:35], v[192:195]
    ds_read_b128 v[4:7], v44 offset:22528
    v_mfma_f32_16x16x32_bf16 v[196:199], a[204:207], v[36:39], v[196:199]
    ds_read_b128 v[8:11], v44 offset:24576
    v_mfma_f32_16x16x32_bf16 v[200:203], a[208:211], v[20:23], v[200:203]
    ds_read_b128 v[12:15], v44 offset:26624
    v_mfma_f32_16x16x32_bf16 v[204:207], a[208:211], v[24:27], v[204:207]
    ds_read_b128 v[16:19], v44 offset:28672
    v_mfma_f32_16x16x32_bf16 v[208:211], a[208:211], v[28:31], v[208:211]
    ds_read_b64_tr_b16 a[188:189], v40 offset:32904
    v_mfma_f32_16x16x32_bf16 v[212:215], a[208:211], v[32:35], v[212:215]
    ds_read_b64_tr_b16 a[190:191], v40 offset:33928
    v_mfma_f32_16x16x32_bf16 v[216:219], a[208:211], v[36:39], v[216:219]
    ds_read_b64_tr_b16 a[192:193], v41 offset:32896
    v_mfma_f32_16x16x32_bf16 v[220:223], a[212:215], v[20:23], v[220:223]
    ds_read_b64_tr_b16 a[194:195], v41 offset:33920
    v_mfma_f32_16x16x32_bf16 v[224:227], a[212:215], v[24:27], v[224:227]
    buffer_load_dwordx4 v46, s[12:15], s38 offen offset:0  lds
    v_mfma_f32_16x16x32_bf16 v[228:231], a[212:215], v[28:31], v[228:231]
    buffer_load_dwordx4 v47, s[12:15], s38 offen offset:1024  lds
    v_mfma_f32_16x16x32_bf16 v[232:235], a[212:215], v[32:35], v[232:235]
    buffer_load_dwordx4 v48, s[12:15], s38 offen offset:2056  lds
    v_mfma_f32_16x16x32_bf16 v[236:239], a[212:215], v[36:39], v[236:239]
    s_waitcnt lgkmcnt(8)
    buffer_load_dwordx4 v49, s[12:15], s38 offen offset:3080  lds
    v_mfma_f32_16x16x32_bf16 v[80:83], a[184:187], v[0:3], v[80:83]
    s_waitcnt lgkmcnt(7)
    ds_read_b64_tr_b16 a[196:197], v41 offset:32904
    v_mfma_f32_16x16x32_bf16 v[84:87], a[184:187], v[4:7], v[84:87]
    s_waitcnt lgkmcnt(7)
    ds_read_b64_tr_b16 a[198:199], v41 offset:33928
    v_mfma_f32_16x16x32_bf16 v[88:91], a[184:187], v[8:11], v[88:91]
    s_waitcnt lgkmcnt(7)
    s_add_u32 s38, s38, 262144
    s_and_b32 s38, s38, 0x3fffff
    v_mfma_f32_16x16x32_bf16 v[92:95], a[184:187], v[12:15], v[92:95]
    s_waitcnt lgkmcnt(6)
    s_add_u32 m0, s36, 0
    s_add_u32 s33, s37, s51
    v_mfma_f32_16x16x32_bf16 v[96:99], a[184:187], v[16:19], v[96:99]
    s_waitcnt lgkmcnt(4)
    buffer_load_dwordx4 v50, s[8:11], s33 offen offset:0  lds
    v_mfma_f32_16x16x32_bf16 v[100:103], a[188:191], v[0:3], v[100:103]
    ds_read_b64_tr_b16 a[200:201], v42 offset:32896
    v_mfma_f32_16x16x32_bf16 v[104:107], a[188:191], v[4:7], v[104:107]
    ds_read_b64_tr_b16 a[202:203], v42 offset:33920
    v_mfma_f32_16x16x32_bf16 v[108:111], a[188:191], v[8:11], v[108:111]
    buffer_load_dwordx4 v51, s[8:11], s33 offen offset:1024  lds
    v_mfma_f32_16x16x32_bf16 v[112:115], a[188:191], v[12:15], v[112:115]
    buffer_load_dwordx4 v52, s[8:11], s33 offen offset:2048  lds
    v_mfma_f32_16x16x32_bf16 v[116:119], a[188:191], v[16:19], v[116:119]
    s_waitcnt lgkmcnt(4)
    buffer_load_dwordx4 v53, s[8:11], s33 offen offset:3072  lds
    v_mfma_f32_16x16x32_bf16 v[120:123], a[192:195], v[0:3], v[120:123]
    s_add_u32 m0, s36, 4096
    ds_read_b64_tr_b16 a[204:205], v42 offset:32904
    v_mfma_f32_16x16x32_bf16 v[124:127], a[192:195], v[4:7], v[124:127]
    s_nop 0
    ds_read_b64_tr_b16 a[206:207], v42 offset:33928
    v_mfma_f32_16x16x32_bf16 v[128:131], a[192:195], v[8:11], v[128:131]
    ds_read_b64_tr_b16 a[208:209], v43 offset:32896
    v_mfma_f32_16x16x32_bf16 v[132:135], a[192:195], v[12:15], v[132:135]
    ds_read_b64_tr_b16 a[210:211], v43 offset:33920
    v_mfma_f32_16x16x32_bf16 v[136:139], a[192:195], v[16:19], v[136:139]
    s_waitcnt lgkmcnt(6)
    ds_read_b64_tr_b16 a[212:213], v43 offset:32904
    v_mfma_f32_16x16x32_bf16 v[140:143], a[196:199], v[0:3], v[140:143]
    ds_read_b64_tr_b16 a[214:215], v43 offset:33928
    v_mfma_f32_16x16x32_bf16 v[144:147], a[196:199], v[4:7], v[144:147]
    buffer_load_dwordx4 v54, s[8:11], s33 offen offset:0  lds
    v_mfma_f32_16x16x32_bf16 v[148:151], a[196:199], v[8:11], v[148:151]
    s_add_u32 s51, s51, 128
    s_and_b32 s51, s51, 0x3ff
    v_mfma_f32_16x16x32_bf16 v[152:155], a[196:199], v[12:15], v[152:155]
    v_mfma_f32_16x16x32_bf16 v[156:159], a[196:199], v[16:19], v[156:159]
    s_waitcnt lgkmcnt(6)
    v_mfma_f32_16x16x32_bf16 v[160:163], a[200:203], v[0:3], v[160:163]
    v_mfma_f32_16x16x32_bf16 v[164:167], a[200:203], v[4:7], v[164:167]
    v_mfma_f32_16x16x32_bf16 v[168:171], a[200:203], v[8:11], v[168:171]
    v_mfma_f32_16x16x32_bf16 v[172:175], a[200:203], v[12:15], v[172:175]
    v_mfma_f32_16x16x32_bf16 v[176:179], a[200:203], v[16:19], v[176:179]
    s_waitcnt lgkmcnt(0)
    s_waitcnt vmcnt(9)
    s_barrier
    v_mfma_f32_16x16x32_bf16 v[180:183], a[204:207], v[0:3], v[180:183]
    s_add_u32 m0, s35, 32896
    ds_read_b64_tr_b16 a[184:185], v40 offset:0
    v_mfma_f32_16x16x32_bf16 v[184:187], a[204:207], v[4:7], v[184:187]
    ds_read_b64_tr_b16 a[186:187], v40 offset:1024
    v_mfma_f32_16x16x32_bf16 v[188:191], a[204:207], v[8:11], v[188:191]
    ds_read_b128 v[20:23], v45 offset:20480
    v_mfma_f32_16x16x32_bf16 v[192:195], a[204:207], v[12:15], v[192:195]
    ds_read_b128 v[24:27], v45 offset:22528
    v_mfma_f32_16x16x32_bf16 v[196:199], a[204:207], v[16:19], v[196:199]
    ds_read_b128 v[28:31], v45 offset:24576
    v_mfma_f32_16x16x32_bf16 v[200:203], a[208:211], v[0:3], v[200:203]
    ds_read_b128 v[32:35], v45 offset:26624
    v_mfma_f32_16x16x32_bf16 v[204:207], a[208:211], v[4:7], v[204:207]
    ds_read_b128 v[36:39], v45 offset:28672
    v_mfma_f32_16x16x32_bf16 v[208:211], a[208:211], v[8:11], v[208:211]
    ds_read_b64_tr_b16 a[188:189], v40 offset:8
    v_mfma_f32_16x16x32_bf16 v[212:215], a[208:211], v[12:15], v[212:215]
    ds_read_b64_tr_b16 a[190:191], v40 offset:1032
    v_mfma_f32_16x16x32_bf16 v[216:219], a[208:211], v[16:19], v[216:219]
    ds_read_b64_tr_b16 a[192:193], v41 offset:0
    v_mfma_f32_16x16x32_bf16 v[220:223], a[212:215], v[0:3], v[220:223]
    ds_read_b64_tr_b16 a[194:195], v41 offset:1024
    v_mfma_f32_16x16x32_bf16 v[224:227], a[212:215], v[4:7], v[224:227]
    buffer_load_dwordx4 v46, s[12:15], s38 offen offset:0  lds
    v_mfma_f32_16x16x32_bf16 v[228:231], a[212:215], v[8:11], v[228:231]
    buffer_load_dwordx4 v47, s[12:15], s38 offen offset:1024  lds
    v_mfma_f32_16x16x32_bf16 v[232:235], a[212:215], v[12:15], v[232:235]
    buffer_load_dwordx4 v48, s[12:15], s38 offen offset:2056  lds
    v_mfma_f32_16x16x32_bf16 v[236:239], a[212:215], v[16:19], v[236:239]
    s_waitcnt lgkmcnt(8)
    buffer_load_dwordx4 v49, s[12:15], s38 offen offset:3080  lds
    v_mfma_f32_16x16x32_bf16 v[80:83], a[184:187], v[20:23], v[80:83]
    s_waitcnt lgkmcnt(7)
    ds_read_b64_tr_b16 a[196:197], v41 offset:8
    v_mfma_f32_16x16x32_bf16 v[84:87], a[184:187], v[24:27], v[84:87]
    s_waitcnt lgkmcnt(7)
    ds_read_b64_tr_b16 a[198:199], v41 offset:1032
    v_mfma_f32_16x16x32_bf16 v[88:91], a[184:187], v[28:31], v[88:91]
    s_waitcnt lgkmcnt(7)
    s_add_u32 s38, s38, 262144
    s_and_b32 s38, s38, 0x3fffff
    v_mfma_f32_16x16x32_bf16 v[92:95], a[184:187], v[32:35], v[92:95]
    s_waitcnt lgkmcnt(6)
    v_mfma_f32_16x16x32_bf16 v[96:99], a[184:187], v[36:39], v[96:99]
    s_waitcnt lgkmcnt(4)
    v_mfma_f32_16x16x32_bf16 v[100:103], a[188:191], v[20:23], v[100:103]
    ds_read_b64_tr_b16 a[200:201], v42 offset:0
    v_mfma_f32_16x16x32_bf16 v[104:107], a[188:191], v[24:27], v[104:107]
    ds_read_b64_tr_b16 a[202:203], v42 offset:1024
    v_mfma_f32_16x16x32_bf16 v[108:111], a[188:191], v[28:31], v[108:111]
    v_mfma_f32_16x16x32_bf16 v[112:115], a[188:191], v[32:35], v[112:115]
    v_mfma_f32_16x16x32_bf16 v[116:119], a[188:191], v[36:39], v[116:119]
    s_waitcnt lgkmcnt(4)
    v_mfma_f32_16x16x32_bf16 v[120:123], a[192:195], v[20:23], v[120:123]
    ds_read_b64_tr_b16 a[204:205], v42 offset:8
    v_mfma_f32_16x16x32_bf16 v[124:127], a[192:195], v[24:27], v[124:127]
    ds_read_b64_tr_b16 a[206:207], v42 offset:1032
    v_mfma_f32_16x16x32_bf16 v[128:131], a[192:195], v[28:31], v[128:131]
    ds_read_b64_tr_b16 a[208:209], v43 offset:0
    v_mfma_f32_16x16x32_bf16 v[132:135], a[192:195], v[32:35], v[132:135]
    ds_read_b64_tr_b16 a[210:211], v43 offset:1024
    v_mfma_f32_16x16x32_bf16 v[136:139], a[192:195], v[36:39], v[136:139]
    s_waitcnt lgkmcnt(6)
    ds_read_b64_tr_b16 a[212:213], v43 offset:8
    v_mfma_f32_16x16x32_bf16 v[140:143], a[196:199], v[20:23], v[140:143]
    ds_read_b64_tr_b16 a[214:215], v43 offset:1032
    v_mfma_f32_16x16x32_bf16 v[144:147], a[196:199], v[24:27], v[144:147]
    v_mfma_f32_16x16x32_bf16 v[148:151], a[196:199], v[28:31], v[148:151]
    v_mfma_f32_16x16x32_bf16 v[152:155], a[196:199], v[32:35], v[152:155]
    v_mfma_f32_16x16x32_bf16 v[156:159], a[196:199], v[36:39], v[156:159]
    s_waitcnt lgkmcnt(6)
    v_mfma_f32_16x16x32_bf16 v[160:163], a[200:203], v[20:23], v[160:163]
    v_mfma_f32_16x16x32_bf16 v[164:167], a[200:203], v[24:27], v[164:167]
    v_mfma_f32_16x16x32_bf16 v[168:171], a[200:203], v[28:31], v[168:171]
    v_mfma_f32_16x16x32_bf16 v[172:175], a[200:203], v[32:35], v[172:175]
    v_mfma_f32_16x16x32_bf16 v[176:179], a[200:203], v[36:39], v[176:179]
    s_waitcnt lgkmcnt(0)
    s_waitcnt vmcnt(4)
    s_barrier
    v_mfma_f32_16x16x32_bf16 v[180:183], a[204:207], v[20:23], v[180:183]
    s_add_u32 m0, s35, 0
    ds_read_b64_tr_b16 a[184:185], v40 offset:16448
    v_mfma_f32_16x16x32_bf16 v[184:187], a[204:207], v[24:27], v[184:187]
    ds_read_b64_tr_b16 a[186:187], v40 offset:17472
    v_mfma_f32_16x16x32_bf16 v[188:191], a[204:207], v[28:31], v[188:191]
    ds_read_b128 v[0:3], v44 offset:0
    v_mfma_f32_16x16x32_bf16 v[192:195], a[204:207], v[32:35], v[192:195]
    ds_read_b128 v[4:7], v44 offset:2048
    v_mfma_f32_16x16x32_bf16 v[196:199], a[204:207], v[36:39], v[196:199]
    ds_read_b128 v[8:11], v44 offset:4096
    v_mfma_f32_16x16x32_bf16 v[200:203], a[208:211], v[20:23], v[200:203]
    ds_read_b128 v[12:15], v44 offset:6144
    v_mfma_f32_16x16x32_bf16 v[204:207], a[208:211], v[24:27], v[204:207]
    ds_read_b128 v[16:19], v44 offset:8192
    v_mfma_f32_16x16x32_bf16 v[208:211], a[208:211], v[28:31], v[208:211]
    ds_read_b64_tr_b16 a[188:189], v40 offset:16456
    v_mfma_f32_16x16x32_bf16 v[212:215], a[208:211], v[32:35], v[212:215]
    ds_read_b64_tr_b16 a[190:191], v40 offset:17480
    v_mfma_f32_16x16x32_bf16 v[216:219], a[208:211], v[36:39], v[216:219]
    ds_read_b64_tr_b16 a[192:193], v41 offset:16448
    v_mfma_f32_16x16x32_bf16 v[220:223], a[212:215], v[20:23], v[220:223]
    ds_read_b64_tr_b16 a[194:195], v41 offset:17472
    v_mfma_f32_16x16x32_bf16 v[224:227], a[212:215], v[24:27], v[224:227]
    buffer_load_dwordx4 v46, s[12:15], s38 offen offset:0  lds
    v_mfma_f32_16x16x32_bf16 v[228:231], a[212:215], v[28:31], v[228:231]
    buffer_load_dwordx4 v47, s[12:15], s38 offen offset:1024  lds
    v_mfma_f32_16x16x32_bf16 v[232:235], a[212:215], v[32:35], v[232:235]
    buffer_load_dwordx4 v48, s[12:15], s38 offen offset:2056  lds
    v_mfma_f32_16x16x32_bf16 v[236:239], a[212:215], v[36:39], v[236:239]
    s_waitcnt lgkmcnt(8)
    buffer_load_dwordx4 v49, s[12:15], s38 offen offset:3080  lds
    v_mfma_f32_16x16x32_bf16 v[80:83], a[184:187], v[0:3], v[80:83]
    s_waitcnt lgkmcnt(7)
    ds_read_b64_tr_b16 a[196:197], v41 offset:16456
    v_mfma_f32_16x16x32_bf16 v[84:87], a[184:187], v[4:7], v[84:87]
    s_waitcnt lgkmcnt(7)
    ds_read_b64_tr_b16 a[198:199], v41 offset:17480
    v_mfma_f32_16x16x32_bf16 v[88:91], a[184:187], v[8:11], v[88:91]
    s_waitcnt lgkmcnt(7)
    s_add_u32 s38, s38, 262144
    s_and_b32 s38, s38, 0x3fffff
    v_mfma_f32_16x16x32_bf16 v[92:95], a[184:187], v[12:15], v[92:95]
    s_waitcnt lgkmcnt(6)
    s_add_u32 m0, s36, 20480
    s_add_u32 s33, s37, s51
    v_mfma_f32_16x16x32_bf16 v[96:99], a[184:187], v[16:19], v[96:99]
    s_waitcnt lgkmcnt(4)
    buffer_load_dwordx4 v50, s[8:11], s33 offen offset:0  lds
    v_mfma_f32_16x16x32_bf16 v[100:103], a[188:191], v[0:3], v[100:103]
    ds_read_b64_tr_b16 a[200:201], v42 offset:16448
    v_mfma_f32_16x16x32_bf16 v[104:107], a[188:191], v[4:7], v[104:107]
    ds_read_b64_tr_b16 a[202:203], v42 offset:17472
    v_mfma_f32_16x16x32_bf16 v[108:111], a[188:191], v[8:11], v[108:111]
    buffer_load_dwordx4 v51, s[8:11], s33 offen offset:1024  lds
    v_mfma_f32_16x16x32_bf16 v[112:115], a[188:191], v[12:15], v[112:115]
    buffer_load_dwordx4 v52, s[8:11], s33 offen offset:2048  lds
    v_mfma_f32_16x16x32_bf16 v[116:119], a[188:191], v[16:19], v[116:119]
    s_waitcnt lgkmcnt(4)
    buffer_load_dwordx4 v53, s[8:11], s33 offen offset:3072  lds
    v_mfma_f32_16x16x32_bf16 v[120:123], a[192:195], v[0:3], v[120:123]
    s_add_u32 m0, s36, 24576
    ds_read_b64_tr_b16 a[204:205], v42 offset:16456
    v_mfma_f32_16x16x32_bf16 v[124:127], a[192:195], v[4:7], v[124:127]
    s_nop 0
    ds_read_b64_tr_b16 a[206:207], v42 offset:17480
    v_mfma_f32_16x16x32_bf16 v[128:131], a[192:195], v[8:11], v[128:131]
    ds_read_b64_tr_b16 a[208:209], v43 offset:16448
    v_mfma_f32_16x16x32_bf16 v[132:135], a[192:195], v[12:15], v[132:135]
    ds_read_b64_tr_b16 a[210:211], v43 offset:17472
    v_mfma_f32_16x16x32_bf16 v[136:139], a[192:195], v[16:19], v[136:139]
    s_waitcnt lgkmcnt(6)
    ds_read_b64_tr_b16 a[212:213], v43 offset:16456
    v_mfma_f32_16x16x32_bf16 v[140:143], a[196:199], v[0:3], v[140:143]
    ds_read_b64_tr_b16 a[214:215], v43 offset:17480
    v_mfma_f32_16x16x32_bf16 v[144:147], a[196:199], v[4:7], v[144:147]
    buffer_load_dwordx4 v54, s[8:11], s33 offen offset:0  lds
    v_mfma_f32_16x16x32_bf16 v[148:151], a[196:199], v[8:11], v[148:151]
    s_add_u32 s51, s51, 128
    s_and_b32 s51, s51, 0x3ff
    v_mfma_f32_16x16x32_bf16 v[152:155], a[196:199], v[12:15], v[152:155]
    v_mfma_f32_16x16x32_bf16 v[156:159], a[196:199], v[16:19], v[156:159]
    s_waitcnt lgkmcnt(6)
    v_mfma_f32_16x16x32_bf16 v[160:163], a[200:203], v[0:3], v[160:163]
    v_mfma_f32_16x16x32_bf16 v[164:167], a[200:203], v[4:7], v[164:167]
    v_mfma_f32_16x16x32_bf16 v[168:171], a[200:203], v[8:11], v[168:171]
    v_mfma_f32_16x16x32_bf16 v[172:175], a[200:203], v[12:15], v[172:175]
    v_mfma_f32_16x16x32_bf16 v[176:179], a[200:203], v[16:19], v[176:179]
    s_waitcnt lgkmcnt(0)
    s_waitcnt vmcnt(9)
    s_barrier
    v_mfma_f32_16x16x32_bf16 v[180:183], a[204:207], v[0:3], v[180:183]
    s_add_u32 m0, s35, 16448
    ds_read_b64_tr_b16 a[184:185], v40 offset:32896
    v_mfma_f32_16x16x32_bf16 v[184:187], a[204:207], v[4:7], v[184:187]
    ds_read_b64_tr_b16 a[186:187], v40 offset:33920
    v_mfma_f32_16x16x32_bf16 v[188:191], a[204:207], v[8:11], v[188:191]
    ds_read_b128 v[20:23], v45 offset:0
    v_mfma_f32_16x16x32_bf16 v[192:195], a[204:207], v[12:15], v[192:195]
    ds_read_b128 v[24:27], v45 offset:2048
    v_mfma_f32_16x16x32_bf16 v[196:199], a[204:207], v[16:19], v[196:199]
    ds_read_b128 v[28:31], v45 offset:4096
    v_mfma_f32_16x16x32_bf16 v[200:203], a[208:211], v[0:3], v[200:203]
    ds_read_b128 v[32:35], v45 offset:6144
    v_mfma_f32_16x16x32_bf16 v[204:207], a[208:211], v[4:7], v[204:207]
    ds_read_b128 v[36:39], v45 offset:8192
    v_mfma_f32_16x16x32_bf16 v[208:211], a[208:211], v[8:11], v[208:211]
    ds_read_b64_tr_b16 a[188:189], v40 offset:32904
    v_mfma_f32_16x16x32_bf16 v[212:215], a[208:211], v[12:15], v[212:215]
    ds_read_b64_tr_b16 a[190:191], v40 offset:33928
    v_mfma_f32_16x16x32_bf16 v[216:219], a[208:211], v[16:19], v[216:219]
    ds_read_b64_tr_b16 a[192:193], v41 offset:32896
    v_mfma_f32_16x16x32_bf16 v[220:223], a[212:215], v[0:3], v[220:223]
    ds_read_b64_tr_b16 a[194:195], v41 offset:33920
    v_mfma_f32_16x16x32_bf16 v[224:227], a[212:215], v[4:7], v[224:227]
    buffer_load_dwordx4 v46, s[12:15], s38 offen offset:0  lds
    v_mfma_f32_16x16x32_bf16 v[228:231], a[212:215], v[8:11], v[228:231]
    buffer_load_dwordx4 v47, s[12:15], s38 offen offset:1024  lds
    v_mfma_f32_16x16x32_bf16 v[232:235], a[212:215], v[12:15], v[232:235]
    buffer_load_dwordx4 v48, s[12:15], s38 offen offset:2056  lds
    v_mfma_f32_16x16x32_bf16 v[236:239], a[212:215], v[16:19], v[236:239]
    s_waitcnt lgkmcnt(8)
    buffer_load_dwordx4 v49, s[12:15], s38 offen offset:3080  lds
    v_mfma_f32_16x16x32_bf16 v[80:83], a[184:187], v[20:23], v[80:83]
    s_waitcnt lgkmcnt(7)
    ds_read_b64_tr_b16 a[196:197], v41 offset:32904
    v_mfma_f32_16x16x32_bf16 v[84:87], a[184:187], v[24:27], v[84:87]
    s_waitcnt lgkmcnt(7)
    ds_read_b64_tr_b16 a[198:199], v41 offset:33928
    v_mfma_f32_16x16x32_bf16 v[88:91], a[184:187], v[28:31], v[88:91]
    s_waitcnt lgkmcnt(7)
    s_add_u32 s38, s38, 262144
    s_and_b32 s38, s38, 0x3fffff
    v_mfma_f32_16x16x32_bf16 v[92:95], a[184:187], v[32:35], v[92:95]
    s_waitcnt lgkmcnt(6)
    v_mfma_f32_16x16x32_bf16 v[96:99], a[184:187], v[36:39], v[96:99]
    s_waitcnt lgkmcnt(4)
    v_mfma_f32_16x16x32_bf16 v[100:103], a[188:191], v[20:23], v[100:103]
    ds_read_b64_tr_b16 a[200:201], v42 offset:32896
    v_mfma_f32_16x16x32_bf16 v[104:107], a[188:191], v[24:27], v[104:107]
    ds_read_b64_tr_b16 a[202:203], v42 offset:33920
    v_mfma_f32_16x16x32_bf16 v[108:111], a[188:191], v[28:31], v[108:111]
    v_mfma_f32_16x16x32_bf16 v[112:115], a[188:191], v[32:35], v[112:115]
    v_mfma_f32_16x16x32_bf16 v[116:119], a[188:191], v[36:39], v[116:119]
    s_waitcnt lgkmcnt(4)
    v_mfma_f32_16x16x32_bf16 v[120:123], a[192:195], v[20:23], v[120:123]
    ds_read_b64_tr_b16 a[204:205], v42 offset:32904
    v_mfma_f32_16x16x32_bf16 v[124:127], a[192:195], v[24:27], v[124:127]
    ds_read_b64_tr_b16 a[206:207], v42 offset:33928
    v_mfma_f32_16x16x32_bf16 v[128:131], a[192:195], v[28:31], v[128:131]
    ds_read_b64_tr_b16 a[208:209], v43 offset:32896
    v_mfma_f32_16x16x32_bf16 v[132:135], a[192:195], v[32:35], v[132:135]
    ds_read_b64_tr_b16 a[210:211], v43 offset:33920
    v_mfma_f32_16x16x32_bf16 v[136:139], a[192:195], v[36:39], v[136:139]
    s_waitcnt lgkmcnt(6)
    ds_read_b64_tr_b16 a[212:213], v43 offset:32904
    v_mfma_f32_16x16x32_bf16 v[140:143], a[196:199], v[20:23], v[140:143]
    ds_read_b64_tr_b16 a[214:215], v43 offset:33928
    v_mfma_f32_16x16x32_bf16 v[144:147], a[196:199], v[24:27], v[144:147]
    v_mfma_f32_16x16x32_bf16 v[148:151], a[196:199], v[28:31], v[148:151]
    v_mfma_f32_16x16x32_bf16 v[152:155], a[196:199], v[32:35], v[152:155]
    v_mfma_f32_16x16x32_bf16 v[156:159], a[196:199], v[36:39], v[156:159]
    s_waitcnt lgkmcnt(6)
    v_mfma_f32_16x16x32_bf16 v[160:163], a[200:203], v[20:23], v[160:163]
    v_mfma_f32_16x16x32_bf16 v[164:167], a[200:203], v[24:27], v[164:167]
    v_mfma_f32_16x16x32_bf16 v[168:171], a[200:203], v[28:31], v[168:171]
    v_mfma_f32_16x16x32_bf16 v[172:175], a[200:203], v[32:35], v[172:175]
    v_mfma_f32_16x16x32_bf16 v[176:179], a[200:203], v[36:39], v[176:179]
    s_waitcnt lgkmcnt(0)
    s_waitcnt vmcnt(4)
    s_barrier
    v_mfma_f32_16x16x32_bf16 v[180:183], a[204:207], v[20:23], v[180:183]
    s_add_u32 m0, s35, 32896
    ds_read_b64_tr_b16 a[184:185], v40 offset:0
    v_mfma_f32_16x16x32_bf16 v[184:187], a[204:207], v[24:27], v[184:187]
    ds_read_b64_tr_b16 a[186:187], v40 offset:1024
    v_mfma_f32_16x16x32_bf16 v[188:191], a[204:207], v[28:31], v[188:191]
    ds_read_b128 v[0:3], v44 offset:20480
    v_mfma_f32_16x16x32_bf16 v[192:195], a[204:207], v[32:35], v[192:195]
    ds_read_b128 v[4:7], v44 offset:22528
    v_mfma_f32_16x16x32_bf16 v[196:199], a[204:207], v[36:39], v[196:199]
    ds_read_b128 v[8:11], v44 offset:24576
    v_mfma_f32_16x16x32_bf16 v[200:203], a[208:211], v[20:23], v[200:203]
    ds_read_b128 v[12:15], v44 offset:26624
    v_mfma_f32_16x16x32_bf16 v[204:207], a[208:211], v[24:27], v[204:207]
    ds_read_b128 v[16:19], v44 offset:28672
    v_mfma_f32_16x16x32_bf16 v[208:211], a[208:211], v[28:31], v[208:211]
    ds_read_b64_tr_b16 a[188:189], v40 offset:8
    v_mfma_f32_16x16x32_bf16 v[212:215], a[208:211], v[32:35], v[212:215]
    ds_read_b64_tr_b16 a[190:191], v40 offset:1032
    v_mfma_f32_16x16x32_bf16 v[216:219], a[208:211], v[36:39], v[216:219]
    ds_read_b64_tr_b16 a[192:193], v41 offset:0
    v_mfma_f32_16x16x32_bf16 v[220:223], a[212:215], v[20:23], v[220:223]
    ds_read_b64_tr_b16 a[194:195], v41 offset:1024
    v_mfma_f32_16x16x32_bf16 v[224:227], a[212:215], v[24:27], v[224:227]
    buffer_load_dwordx4 v46, s[12:15], s38 offen offset:0  lds
    v_mfma_f32_16x16x32_bf16 v[228:231], a[212:215], v[28:31], v[228:231]
    buffer_load_dwordx4 v47, s[12:15], s38 offen offset:1024  lds
    v_mfma_f32_16x16x32_bf16 v[232:235], a[212:215], v[32:35], v[232:235]
    buffer_load_dwordx4 v48, s[12:15], s38 offen offset:2056  lds
    v_mfma_f32_16x16x32_bf16 v[236:239], a[212:215], v[36:39], v[236:239]
    s_waitcnt lgkmcnt(8)
    buffer_load_dwordx4 v49, s[12:15], s38 offen offset:3080  lds
    v_mfma_f32_16x16x32_bf16 v[80:83], a[184:187], v[0:3], v[80:83]
    s_waitcnt lgkmcnt(7)
    ds_read_b64_tr_b16 a[196:197], v41 offset:8
    v_mfma_f32_16x16x32_bf16 v[84:87], a[184:187], v[4:7], v[84:87]
    s_waitcnt lgkmcnt(7)
    ds_read_b64_tr_b16 a[198:199], v41 offset:1032
    v_mfma_f32_16x16x32_bf16 v[88:91], a[184:187], v[8:11], v[88:91]
    s_waitcnt lgkmcnt(7)
    s_add_u32 s38, s38, 262144
    s_and_b32 s38, s38, 0x3fffff
    v_mfma_f32_16x16x32_bf16 v[92:95], a[184:187], v[12:15], v[92:95]
    s_waitcnt lgkmcnt(6)
    s_add_u32 m0, s36, 0
    s_add_u32 s33, s37, s51
    v_mfma_f32_16x16x32_bf16 v[96:99], a[184:187], v[16:19], v[96:99]
    s_waitcnt lgkmcnt(4)
    buffer_load_dwordx4 v50, s[8:11], s33 offen offset:0  lds
    v_mfma_f32_16x16x32_bf16 v[100:103], a[188:191], v[0:3], v[100:103]
    ds_read_b64_tr_b16 a[200:201], v42 offset:0
    v_mfma_f32_16x16x32_bf16 v[104:107], a[188:191], v[4:7], v[104:107]
    ds_read_b64_tr_b16 a[202:203], v42 offset:1024
    v_mfma_f32_16x16x32_bf16 v[108:111], a[188:191], v[8:11], v[108:111]
    buffer_load_dwordx4 v51, s[8:11], s33 offen offset:1024  lds
    v_mfma_f32_16x16x32_bf16 v[112:115], a[188:191], v[12:15], v[112:115]
    buffer_load_dwordx4 v52, s[8:11], s33 offen offset:2048  lds
    v_mfma_f32_16x16x32_bf16 v[116:119], a[188:191], v[16:19], v[116:119]
    s_waitcnt lgkmcnt(4)
    buffer_load_dwordx4 v53, s[8:11], s33 offen offset:3072  lds
    v_mfma_f32_16x16x32_bf16 v[120:123], a[192:195], v[0:3], v[120:123]
    s_add_u32 m0, s36, 4096
    ds_read_b64_tr_b16 a[204:205], v42 offset:8
    v_mfma_f32_16x16x32_bf16 v[124:127], a[192:195], v[4:7], v[124:127]
    s_nop 0
    ds_read_b64_tr_b16 a[206:207], v42 offset:1032
    v_mfma_f32_16x16x32_bf16 v[128:131], a[192:195], v[8:11], v[128:131]
    ds_read_b64_tr_b16 a[208:209], v43 offset:0
    v_mfma_f32_16x16x32_bf16 v[132:135], a[192:195], v[12:15], v[132:135]
    ds_read_b64_tr_b16 a[210:211], v43 offset:1024
    v_mfma_f32_16x16x32_bf16 v[136:139], a[192:195], v[16:19], v[136:139]
    s_waitcnt lgkmcnt(6)
    ds_read_b64_tr_b16 a[212:213], v43 offset:8
    v_mfma_f32_16x16x32_bf16 v[140:143], a[196:199], v[0:3], v[140:143]
    ds_read_b64_tr_b16 a[214:215], v43 offset:1032
    v_mfma_f32_16x16x32_bf16 v[144:147], a[196:199], v[4:7], v[144:147]
    buffer_load_dwordx4 v54, s[8:11], s33 offen offset:0  lds
    v_mfma_f32_16x16x32_bf16 v[148:151], a[196:199], v[8:11], v[148:151]
    s_add_u32 s51, s51, 128
    s_and_b32 s51, s51, 0x3ff
    v_mfma_f32_16x16x32_bf16 v[152:155], a[196:199], v[12:15], v[152:155]
    v_mfma_f32_16x16x32_bf16 v[156:159], a[196:199], v[16:19], v[156:159]
    s_waitcnt lgkmcnt(6)
    v_mfma_f32_16x16x32_bf16 v[160:163], a[200:203], v[0:3], v[160:163]
    v_mfma_f32_16x16x32_bf16 v[164:167], a[200:203], v[4:7], v[164:167]
    v_mfma_f32_16x16x32_bf16 v[168:171], a[200:203], v[8:11], v[168:171]
    v_mfma_f32_16x16x32_bf16 v[172:175], a[200:203], v[12:15], v[172:175]
    v_mfma_f32_16x16x32_bf16 v[176:179], a[200:203], v[16:19], v[176:179]
    s_waitcnt lgkmcnt(0)
    s_waitcnt vmcnt(9)
    s_barrier
    v_mfma_f32_16x16x32_bf16 v[180:183], a[204:207], v[0:3], v[180:183]
    s_add_u32 m0, s35, 0
    ds_read_b64_tr_b16 a[184:185], v40 offset:16448
    v_mfma_f32_16x16x32_bf16 v[184:187], a[204:207], v[4:7], v[184:187]
    ds_read_b64_tr_b16 a[186:187], v40 offset:17472
    v_mfma_f32_16x16x32_bf16 v[188:191], a[204:207], v[8:11], v[188:191]
    ds_read_b128 v[20:23], v45 offset:20480
    v_mfma_f32_16x16x32_bf16 v[192:195], a[204:207], v[12:15], v[192:195]
    ds_read_b128 v[24:27], v45 offset:22528
    v_mfma_f32_16x16x32_bf16 v[196:199], a[204:207], v[16:19], v[196:199]
    ds_read_b128 v[28:31], v45 offset:24576
    v_mfma_f32_16x16x32_bf16 v[200:203], a[208:211], v[0:3], v[200:203]
    ds_read_b128 v[32:35], v45 offset:26624
    v_mfma_f32_16x16x32_bf16 v[204:207], a[208:211], v[4:7], v[204:207]
    ds_read_b128 v[36:39], v45 offset:28672
    v_mfma_f32_16x16x32_bf16 v[208:211], a[208:211], v[8:11], v[208:211]
    ds_read_b64_tr_b16 a[188:189], v40 offset:16456
    v_mfma_f32_16x16x32_bf16 v[212:215], a[208:211], v[12:15], v[212:215]
    ds_read_b64_tr_b16 a[190:191], v40 offset:17480
    v_mfma_f32_16x16x32_bf16 v[216:219], a[208:211], v[16:19], v[216:219]
    ds_read_b64_tr_b16 a[192:193], v41 offset:16448
    v_mfma_f32_16x16x32_bf16 v[220:223], a[212:215], v[0:3], v[220:223]
    ds_read_b64_tr_b16 a[194:195], v41 offset:17472
    v_mfma_f32_16x16x32_bf16 v[224:227], a[212:215], v[4:7], v[224:227]
    buffer_load_dwordx4 v46, s[12:15], s38 offen offset:0  lds
    v_mfma_f32_16x16x32_bf16 v[228:231], a[212:215], v[8:11], v[228:231]
    buffer_load_dwordx4 v47, s[12:15], s38 offen offset:1024  lds
    v_mfma_f32_16x16x32_bf16 v[232:235], a[212:215], v[12:15], v[232:235]
    buffer_load_dwordx4 v48, s[12:15], s38 offen offset:2056  lds
    v_mfma_f32_16x16x32_bf16 v[236:239], a[212:215], v[16:19], v[236:239]
    s_waitcnt lgkmcnt(8)
    buffer_load_dwordx4 v49, s[12:15], s38 offen offset:3080  lds
    v_mfma_f32_16x16x32_bf16 v[80:83], a[184:187], v[20:23], v[80:83]
    s_waitcnt lgkmcnt(7)
    ds_read_b64_tr_b16 a[196:197], v41 offset:16456
    v_mfma_f32_16x16x32_bf16 v[84:87], a[184:187], v[24:27], v[84:87]
    s_waitcnt lgkmcnt(7)
    ds_read_b64_tr_b16 a[198:199], v41 offset:17480
    v_mfma_f32_16x16x32_bf16 v[88:91], a[184:187], v[28:31], v[88:91]
    s_waitcnt lgkmcnt(7)
    s_add_u32 s38, s38, 262144
    s_and_b32 s38, s38, 0x3fffff
    v_mfma_f32_16x16x32_bf16 v[92:95], a[184:187], v[32:35], v[92:95]
    s_waitcnt lgkmcnt(6)
    v_mfma_f32_16x16x32_bf16 v[96:99], a[184:187], v[36:39], v[96:99]
    s_waitcnt lgkmcnt(4)
    v_mfma_f32_16x16x32_bf16 v[100:103], a[188:191], v[20:23], v[100:103]
    ds_read_b64_tr_b16 a[200:201], v42 offset:16448
    v_mfma_f32_16x16x32_bf16 v[104:107], a[188:191], v[24:27], v[104:107]
    ds_read_b64_tr_b16 a[202:203], v42 offset:17472
    v_mfma_f32_16x16x32_bf16 v[108:111], a[188:191], v[28:31], v[108:111]
    v_mfma_f32_16x16x32_bf16 v[112:115], a[188:191], v[32:35], v[112:115]
    v_mfma_f32_16x16x32_bf16 v[116:119], a[188:191], v[36:39], v[116:119]
    s_waitcnt lgkmcnt(4)
    v_mfma_f32_16x16x32_bf16 v[120:123], a[192:195], v[20:23], v[120:123]
    ds_read_b64_tr_b16 a[204:205], v42 offset:16456
    v_mfma_f32_16x16x32_bf16 v[124:127], a[192:195], v[24:27], v[124:127]
    ds_read_b64_tr_b16 a[206:207], v42 offset:17480
    v_mfma_f32_16x16x32_bf16 v[128:131], a[192:195], v[28:31], v[128:131]
    ds_read_b64_tr_b16 a[208:209], v43 offset:16448
    v_mfma_f32_16x16x32_bf16 v[132:135], a[192:195], v[32:35], v[132:135]
    ds_read_b64_tr_b16 a[210:211], v43 offset:17472
    v_mfma_f32_16x16x32_bf16 v[136:139], a[192:195], v[36:39], v[136:139]
    s_waitcnt lgkmcnt(6)
    ds_read_b64_tr_b16 a[212:213], v43 offset:16456
    v_mfma_f32_16x16x32_bf16 v[140:143], a[196:199], v[20:23], v[140:143]
    ds_read_b64_tr_b16 a[214:215], v43 offset:17480
    v_mfma_f32_16x16x32_bf16 v[144:147], a[196:199], v[24:27], v[144:147]
    v_mfma_f32_16x16x32_bf16 v[148:151], a[196:199], v[28:31], v[148:151]
    v_mfma_f32_16x16x32_bf16 v[152:155], a[196:199], v[32:35], v[152:155]
    v_mfma_f32_16x16x32_bf16 v[156:159], a[196:199], v[36:39], v[156:159]
    s_waitcnt lgkmcnt(6)
    v_mfma_f32_16x16x32_bf16 v[160:163], a[200:203], v[20:23], v[160:163]
    v_mfma_f32_16x16x32_bf16 v[164:167], a[200:203], v[24:27], v[164:167]
    v_mfma_f32_16x16x32_bf16 v[168:171], a[200:203], v[28:31], v[168:171]
    v_mfma_f32_16x16x32_bf16 v[172:175], a[200:203], v[32:35], v[172:175]
    v_mfma_f32_16x16x32_bf16 v[176:179], a[200:203], v[36:39], v[176:179]
    s_waitcnt lgkmcnt(0)
    s_waitcnt vmcnt(4)
    s_barrier
    v_mfma_f32_16x16x32_bf16 v[180:183], a[204:207], v[20:23], v[180:183]
    s_add_u32 m0, s35, 16448
    ds_read_b64_tr_b16 a[184:185], v40 offset:32896
    v_mfma_f32_16x16x32_bf16 v[184:187], a[204:207], v[24:27], v[184:187]
    ds_read_b64_tr_b16 a[186:187], v40 offset:33920
    v_mfma_f32_16x16x32_bf16 v[188:191], a[204:207], v[28:31], v[188:191]
    ds_read_b128 v[0:3], v44 offset:0
    v_mfma_f32_16x16x32_bf16 v[192:195], a[204:207], v[32:35], v[192:195]
    ds_read_b128 v[4:7], v44 offset:2048
    v_mfma_f32_16x16x32_bf16 v[196:199], a[204:207], v[36:39], v[196:199]
    ds_read_b128 v[8:11], v44 offset:4096
    v_mfma_f32_16x16x32_bf16 v[200:203], a[208:211], v[20:23], v[200:203]
    ds_read_b128 v[12:15], v44 offset:6144
    v_mfma_f32_16x16x32_bf16 v[204:207], a[208:211], v[24:27], v[204:207]
    ds_read_b128 v[16:19], v44 offset:8192
    v_mfma_f32_16x16x32_bf16 v[208:211], a[208:211], v[28:31], v[208:211]
    ds_read_b64_tr_b16 a[188:189], v40 offset:32904
    v_mfma_f32_16x16x32_bf16 v[212:215], a[208:211], v[32:35], v[212:215]
    ds_read_b64_tr_b16 a[190:191], v40 offset:33928
    v_mfma_f32_16x16x32_bf16 v[216:219], a[208:211], v[36:39], v[216:219]
    ds_read_b64_tr_b16 a[192:193], v41 offset:32896
    v_mfma_f32_16x16x32_bf16 v[220:223], a[212:215], v[20:23], v[220:223]
    ds_read_b64_tr_b16 a[194:195], v41 offset:33920
    v_mfma_f32_16x16x32_bf16 v[224:227], a[212:215], v[24:27], v[224:227]
    buffer_load_dwordx4 v46, s[12:15], s38 offen offset:0  lds
    v_mfma_f32_16x16x32_bf16 v[228:231], a[212:215], v[28:31], v[228:231]
    buffer_load_dwordx4 v47, s[12:15], s38 offen offset:1024  lds
    v_mfma_f32_16x16x32_bf16 v[232:235], a[212:215], v[32:35], v[232:235]
    buffer_load_dwordx4 v48, s[12:15], s38 offen offset:2056  lds
    v_mfma_f32_16x16x32_bf16 v[236:239], a[212:215], v[36:39], v[236:239]
    s_waitcnt lgkmcnt(8)
    buffer_load_dwordx4 v49, s[12:15], s38 offen offset:3080  lds
    v_mfma_f32_16x16x32_bf16 v[80:83], a[184:187], v[0:3], v[80:83]
    s_waitcnt lgkmcnt(7)
    ds_read_b64_tr_b16 a[196:197], v41 offset:32904
    v_mfma_f32_16x16x32_bf16 v[84:87], a[184:187], v[4:7], v[84:87]
    s_waitcnt lgkmcnt(7)
    ds_read_b64_tr_b16 a[198:199], v41 offset:33928
    v_mfma_f32_16x16x32_bf16 v[88:91], a[184:187], v[8:11], v[88:91]
    s_waitcnt lgkmcnt(7)
    s_add_u32 s38, s38, 262144
    s_and_b32 s38, s38, 0x3fffff
    v_mfma_f32_16x16x32_bf16 v[92:95], a[184:187], v[12:15], v[92:95]
    s_waitcnt lgkmcnt(6)
    s_add_u32 m0, s36, 20480
    s_add_u32 s33, s37, s51
    v_mfma_f32_16x16x32_bf16 v[96:99], a[184:187], v[16:19], v[96:99]
    s_waitcnt lgkmcnt(4)
    buffer_load_dwordx4 v50, s[8:11], s33 offen offset:0  lds
    v_mfma_f32_16x16x32_bf16 v[100:103], a[188:191], v[0:3], v[100:103]
    ds_read_b64_tr_b16 a[200:201], v42 offset:32896
    v_mfma_f32_16x16x32_bf16 v[104:107], a[188:191], v[4:7], v[104:107]
    ds_read_b64_tr_b16 a[202:203], v42 offset:33920
    v_mfma_f32_16x16x32_bf16 v[108:111], a[188:191], v[8:11], v[108:111]
    buffer_load_dwordx4 v51, s[8:11], s33 offen offset:1024  lds
    v_mfma_f32_16x16x32_bf16 v[112:115], a[188:191], v[12:15], v[112:115]
    buffer_load_dwordx4 v52, s[8:11], s33 offen offset:2048  lds
    v_mfma_f32_16x16x32_bf16 v[116:119], a[188:191], v[16:19], v[116:119]
    s_waitcnt lgkmcnt(4)
    buffer_load_dwordx4 v53, s[8:11], s33 offen offset:3072  lds
    v_mfma_f32_16x16x32_bf16 v[120:123], a[192:195], v[0:3], v[120:123]
    s_add_u32 m0, s36, 24576
    ds_read_b64_tr_b16 a[204:205], v42 offset:32904
    v_mfma_f32_16x16x32_bf16 v[124:127], a[192:195], v[4:7], v[124:127]
    s_nop 0
    ds_read_b64_tr_b16 a[206:207], v42 offset:33928
    v_mfma_f32_16x16x32_bf16 v[128:131], a[192:195], v[8:11], v[128:131]
    ds_read_b64_tr_b16 a[208:209], v43 offset:32896
    v_mfma_f32_16x16x32_bf16 v[132:135], a[192:195], v[12:15], v[132:135]
    ds_read_b64_tr_b16 a[210:211], v43 offset:33920
    v_mfma_f32_16x16x32_bf16 v[136:139], a[192:195], v[16:19], v[136:139]
    s_waitcnt lgkmcnt(6)
    ds_read_b64_tr_b16 a[212:213], v43 offset:32904
    v_mfma_f32_16x16x32_bf16 v[140:143], a[196:199], v[0:3], v[140:143]
    ds_read_b64_tr_b16 a[214:215], v43 offset:33928
    v_mfma_f32_16x16x32_bf16 v[144:147], a[196:199], v[4:7], v[144:147]
    buffer_load_dwordx4 v54, s[8:11], s33 offen offset:0  lds
    v_mfma_f32_16x16x32_bf16 v[148:151], a[196:199], v[8:11], v[148:151]
    s_add_u32 s51, s51, 128
    s_and_b32 s51, s51, 0x3ff
    s_add_u32 m0, s39, 0
    v_mfma_f32_16x16x32_bf16 v[152:155], a[196:199], v[12:15], v[152:155]
    s_add_u32 s34, s93, 0
    s_and_b32 s34, s34, 0x1ffff
    v_mfma_f32_16x16x32_bf16 v[156:159], a[196:199], v[16:19], v[156:159]
    s_waitcnt lgkmcnt(6)
    buffer_load_dwordx4 v252, s[16:19], s34 offen offset:0 nt lds
    v_mfma_f32_16x16x32_bf16 v[160:163], a[200:203], v[0:3], v[160:163]
    buffer_load_dwordx4 v253, s[16:19], s34 offen offset:1024 nt lds
    v_mfma_f32_16x16x32_bf16 v[164:167], a[200:203], v[4:7], v[164:167]
    buffer_load_dwordx4 v254, s[16:19], s34 offen offset:2048 nt lds
    v_mfma_f32_16x16x32_bf16 v[168:171], a[200:203], v[8:11], v[168:171]
    buffer_load_dwordx4 v255, s[16:19], s34 offen offset:3072 nt lds
    v_mfma_f32_16x16x32_bf16 v[172:175], a[200:203], v[12:15], v[172:175]
    v_mfma_f32_16x16x32_bf16 v[176:179], a[200:203], v[16:19], v[176:179]
    s_waitcnt lgkmcnt(0)
    s_waitcnt vmcnt(13)
    s_barrier
    v_mfma_f32_16x16x32_bf16 v[180:183], a[204:207], v[0:3], v[180:183]
    s_add_u32 m0, s35, 32896
    ds_read_b64_tr_b16 a[184:185], v40 offset:0
    v_mfma_f32_16x16x32_bf16 v[184:187], a[204:207], v[4:7], v[184:187]
    ds_read_b64_tr_b16 a[186:187], v40 offset:1024
    v_mfma_f32_16x16x32_bf16 v[188:191], a[204:207], v[8:11], v[188:191]
    ds_read_b128 v[20:23], v45 offset:0
    v_mfma_f32_16x16x32_bf16 v[192:195], a[204:207], v[12:15], v[192:195]
    ds_read_b128 v[24:27], v45 offset:2048
    v_mfma_f32_16x16x32_bf16 v[196:199], a[204:207], v[16:19], v[196:199]
    ds_read_b128 v[28:31], v45 offset:4096
    v_mfma_f32_16x16x32_bf16 v[200:203], a[208:211], v[0:3], v[200:203]
    ds_read_b128 v[32:35], v45 offset:6144
    v_mfma_f32_16x16x32_bf16 v[204:207], a[208:211], v[4:7], v[204:207]
    ds_read_b128 v[36:39], v45 offset:8192
    v_mfma_f32_16x16x32_bf16 v[208:211], a[208:211], v[8:11], v[208:211]
    ds_read_b64_tr_b16 a[188:189], v40 offset:8
    v_mfma_f32_16x16x32_bf16 v[212:215], a[208:211], v[12:15], v[212:215]
    ds_read_b64_tr_b16 a[190:191], v40 offset:1032
    v_mfma_f32_16x16x32_bf16 v[216:219], a[208:211], v[16:19], v[216:219]
    ds_read_b64_tr_b16 a[192:193], v41 offset:0
    v_mfma_f32_16x16x32_bf16 v[220:223], a[212:215], v[0:3], v[220:223]
    ds_read_b64_tr_b16 a[194:195], v41 offset:1024
    v_mfma_f32_16x16x32_bf16 v[224:227], a[212:215], v[4:7], v[224:227]
    buffer_load_dwordx4 v46, s[12:15], s38 offen offset:0  lds
    v_mfma_f32_16x16x32_bf16 v[228:231], a[212:215], v[8:11], v[228:231]
    buffer_load_dwordx4 v47, s[12:15], s38 offen offset:1024  lds
    v_mfma_f32_16x16x32_bf16 v[232:235], a[212:215], v[12:15], v[232:235]
    buffer_load_dwordx4 v48, s[12:15], s38 offen offset:2056  lds
    v_mfma_f32_16x16x32_bf16 v[236:239], a[212:215], v[16:19], v[236:239]
    s_waitcnt lgkmcnt(8)
    buffer_load_dwordx4 v49, s[12:15], s38 offen offset:3080  lds
    v_mfma_f32_16x16x32_bf16 v[80:83], a[184:187], v[20:23], v[80:83]
    s_waitcnt lgkmcnt(7)
    ds_read_b64_tr_b16 a[196:197], v41 offset:8
    v_mfma_f32_16x16x32_bf16 v[84:87], a[184:187], v[24:27], v[84:87]
    s_waitcnt lgkmcnt(7)
    ds_read_b64_tr_b16 a[198:199], v41 offset:1032
    v_mfma_f32_16x16x32_bf16 v[88:91], a[184:187], v[28:31], v[88:91]
    s_waitcnt lgkmcnt(7)
    s_add_u32 s38, s38, 262144
    s_and_b32 s38, s38, 0x3fffff
    v_mfma_f32_16x16x32_bf16 v[92:95], a[184:187], v[32:35], v[92:95]
    s_waitcnt lgkmcnt(6)
    v_mfma_f32_16x16x32_bf16 v[96:99], a[184:187], v[36:39], v[96:99]
    s_waitcnt lgkmcnt(4)
    v_mfma_f32_16x16x32_bf16 v[100:103], a[188:191], v[20:23], v[100:103]
    ds_read_b64_tr_b16 a[200:201], v42 offset:0
    v_mfma_f32_16x16x32_bf16 v[104:107], a[188:191], v[24:27], v[104:107]
    ds_read_b64_tr_b16 a[202:203], v42 offset:1024
    v_mfma_f32_16x16x32_bf16 v[108:111], a[188:191], v[28:31], v[108:111]
    v_mfma_f32_16x16x32_bf16 v[112:115], a[188:191], v[32:35], v[112:115]
    v_mfma_f32_16x16x32_bf16 v[116:119], a[188:191], v[36:39], v[116:119]
    s_waitcnt lgkmcnt(4)
    v_mfma_f32_16x16x32_bf16 v[120:123], a[192:195], v[20:23], v[120:123]
    ds_read_b64_tr_b16 a[204:205], v42 offset:8
    v_mfma_f32_16x16x32_bf16 v[124:127], a[192:195], v[24:27], v[124:127]
    ds_read_b64_tr_b16 a[206:207], v42 offset:1032
    v_mfma_f32_16x16x32_bf16 v[128:131], a[192:195], v[28:31], v[128:131]
    ds_read_b64_tr_b16 a[208:209], v43 offset:0
    v_mfma_f32_16x16x32_bf16 v[132:135], a[192:195], v[32:35], v[132:135]
    ds_read_b64_tr_b16 a[210:211], v43 offset:1024
    v_mfma_f32_16x16x32_bf16 v[136:139], a[192:195], v[36:39], v[136:139]
    s_waitcnt lgkmcnt(6)
    ds_read_b64_tr_b16 a[212:213], v43 offset:8
    v_mfma_f32_16x16x32_bf16 v[140:143], a[196:199], v[20:23], v[140:143]
    ds_read_b64_tr_b16 a[214:215], v43 offset:1032
    v_mfma_f32_16x16x32_bf16 v[144:147], a[196:199], v[24:27], v[144:147]
    v_mfma_f32_16x16x32_bf16 v[148:151], a[196:199], v[28:31], v[148:151]
    v_mfma_f32_16x16x32_bf16 v[152:155], a[196:199], v[32:35], v[152:155]
    v_mfma_f32_16x16x32_bf16 v[156:159], a[196:199], v[36:39], v[156:159]
    s_waitcnt lgkmcnt(6)
    v_mfma_f32_16x16x32_bf16 v[160:163], a[200:203], v[20:23], v[160:163]
    v_mfma_f32_16x16x32_bf16 v[164:167], a[200:203], v[24:27], v[164:167]
    v_mfma_f32_16x16x32_bf16 v[168:171], a[200:203], v[28:31], v[168:171]
    v_mfma_f32_16x16x32_bf16 v[172:175], a[200:203], v[32:35], v[172:175]
    v_mfma_f32_16x16x32_bf16 v[176:179], a[200:203], v[36:39], v[176:179]
    s_waitcnt lgkmcnt(0)
    s_waitcnt vmcnt(8)
    s_barrier
    v_mfma_f32_16x16x32_bf16 v[180:183], a[204:207], v[20:23], v[180:183]
    s_add_u32 m0, s35, 0
    ds_read_b64_tr_b16 a[184:185], v40 offset:16448
    v_mfma_f32_16x16x32_bf16 v[184:187], a[204:207], v[24:27], v[184:187]
    ds_read_b64_tr_b16 a[186:187], v40 offset:17472
    v_mfma_f32_16x16x32_bf16 v[188:191], a[204:207], v[28:31], v[188:191]
    ds_read_b128 v[0:3], v44 offset:20480
    v_mfma_f32_16x16x32_bf16 v[192:195], a[204:207], v[32:35], v[192:195]
    ds_read_b128 v[4:7], v44 offset:22528
    v_mfma_f32_16x16x32_bf16 v[196:199], a[204:207], v[36:39], v[196:199]
    ds_read_b128 v[8:11], v44 offset:24576
    v_mfma_f32_16x16x32_bf16 v[200:203], a[208:211], v[20:23], v[200:203]
    ds_read_b128 v[12:15], v44 offset:26624
    v_mfma_f32_16x16x32_bf16 v[204:207], a[208:211], v[24:27], v[204:207]
    ds_read_b128 v[16:19], v44 offset:28672
    v_mfma_f32_16x16x32_bf16 v[208:211], a[208:211], v[28:31], v[208:211]
    ds_read_b64_tr_b16 a[188:189], v40 offset:16456
    v_mfma_f32_16x16x32_bf16 v[212:215], a[208:211], v[32:35], v[212:215]
    ds_read_b64_tr_b16 a[190:191], v40 offset:17480
    v_mfma_f32_16x16x32_bf16 v[216:219], a[208:211], v[36:39], v[216:219]
    ds_read_b64_tr_b16 a[192:193], v41 offset:16448
    v_mfma_f32_16x16x32_bf16 v[220:223], a[212:215], v[20:23], v[220:223]
    ds_read_b64_tr_b16 a[194:195], v41 offset:17472
    v_mfma_f32_16x16x32_bf16 v[224:227], a[212:215], v[24:27], v[224:227]
    buffer_load_dwordx4 v46, s[12:15], s38 offen offset:0  lds
    v_mfma_f32_16x16x32_bf16 v[228:231], a[212:215], v[28:31], v[228:231]
    buffer_load_dwordx4 v47, s[12:15], s38 offen offset:1024  lds
    v_mfma_f32_16x16x32_bf16 v[232:235], a[212:215], v[32:35], v[232:235]
    buffer_load_dwordx4 v48, s[12:15], s38 offen offset:2056  lds
    v_mfma_f32_16x16x32_bf16 v[236:239], a[212:215], v[36:39], v[236:239]
    s_waitcnt lgkmcnt(8)
    buffer_load_dwordx4 v49, s[12:15], s38 offen offset:3080  lds
    v_mfma_f32_16x16x32_bf16 v[80:83], a[184:187], v[0:3], v[80:83]
    s_waitcnt lgkmcnt(7)
    ds_read_b64_tr_b16 a[196:197], v41 offset:16456
    v_mfma_f32_16x16x32_bf16 v[84:87], a[184:187], v[4:7], v[84:87]
    s_waitcnt lgkmcnt(7)
    ds_read_b64_tr_b16 a[198:199], v41 offset:17480
    v_mfma_f32_16x16x32_bf16 v[88:91], a[184:187], v[8:11], v[88:91]
    s_waitcnt lgkmcnt(7)
    s_add_u32 s38, s38, 262144
    s_and_b32 s38, s38, 0x3fffff
    v_mfma_f32_16x16x32_bf16 v[92:95], a[184:187], v[12:15], v[92:95]
    s_waitcnt lgkmcnt(6)
    s_add_u32 m0, s36, 0
    s_add_u32 s33, s37, s51
    v_mfma_f32_16x16x32_bf16 v[96:99], a[184:187], v[16:19], v[96:99]
    s_waitcnt lgkmcnt(4)
    buffer_load_dwordx4 v50, s[8:11], s33 offen offset:0  lds
    v_mfma_f32_16x16x32_bf16 v[100:103], a[188:191], v[0:3], v[100:103]
    ds_read_b64_tr_b16 a[200:201], v42 offset:16448
    v_mfma_f32_16x16x32_bf16 v[104:107], a[188:191], v[4:7], v[104:107]
    ds_read_b64_tr_b16 a[202:203], v42 offset:17472
    v_mfma_f32_16x16x32_bf16 v[108:111], a[188:191], v[8:11], v[108:111]
    buffer_load_dwordx4 v51, s[8:11], s33 offen offset:1024  lds
    v_mfma_f32_16x16x32_bf16 v[112:115], a[188:191], v[12:15], v[112:115]
    buffer_load_dwordx4 v52, s[8:11], s33 offen offset:2048  lds
    v_mfma_f32_16x16x32_bf16 v[116:119], a[188:191], v[16:19], v[116:119]
    s_waitcnt lgkmcnt(4)
    buffer_load_dwordx4 v53, s[8:11], s33 offen offset:3072  lds
    v_mfma_f32_16x16x32_bf16 v[120:123], a[192:195], v[0:3], v[120:123]
    s_add_u32 m0, s36, 4096
    ds_read_b64_tr_b16 a[204:205], v42 offset:16456
    v_mfma_f32_16x16x32_bf16 v[124:127], a[192:195], v[4:7], v[124:127]
    s_nop 0
    ds_read_b64_tr_b16 a[206:207], v42 offset:17480
    v_mfma_f32_16x16x32_bf16 v[128:131], a[192:195], v[8:11], v[128:131]
    ds_read_b64_tr_b16 a[208:209], v43 offset:16448
    v_mfma_f32_16x16x32_bf16 v[132:135], a[192:195], v[12:15], v[132:135]
    ds_read_b64_tr_b16 a[210:211], v43 offset:17472
    v_mfma_f32_16x16x32_bf16 v[136:139], a[192:195], v[16:19], v[136:139]
    s_waitcnt lgkmcnt(6)
    ds_read_b64_tr_b16 a[212:213], v43 offset:16456
    v_mfma_f32_16x16x32_bf16 v[140:143], a[196:199], v[0:3], v[140:143]
    ds_read_b64_tr_b16 a[214:215], v43 offset:17480
    v_mfma_f32_16x16x32_bf16 v[144:147], a[196:199], v[4:7], v[144:147]
    buffer_load_dwordx4 v54, s[8:11], s33 offen offset:0  lds
    v_mfma_f32_16x16x32_bf16 v[148:151], a[196:199], v[8:11], v[148:151]
    s_add_u32 s51, s51, 128
    s_and_b32 s51, s51, 0x3ff
    s_add_u32 m0, s39, 16384
    v_mfma_f32_16x16x32_bf16 v[152:155], a[196:199], v[12:15], v[152:155]
    s_add_u32 s34, s93, 8192
    s_and_b32 s34, s34, 0x1ffff
    v_mfma_f32_16x16x32_bf16 v[156:159], a[196:199], v[16:19], v[156:159]
    s_waitcnt lgkmcnt(6)
    buffer_load_dwordx4 v252, s[16:19], s34 offen offset:0 nt lds
    v_mfma_f32_16x16x32_bf16 v[160:163], a[200:203], v[0:3], v[160:163]
    buffer_load_dwordx4 v253, s[16:19], s34 offen offset:1024 nt lds
    v_mfma_f32_16x16x32_bf16 v[164:167], a[200:203], v[4:7], v[164:167]
    buffer_load_dwordx4 v254, s[16:19], s34 offen offset:2048 nt lds
    v_mfma_f32_16x16x32_bf16 v[168:171], a[200:203], v[8:11], v[168:171]
    buffer_load_dwordx4 v255, s[16:19], s34 offen offset:3072 nt lds
    v_mfma_f32_16x16x32_bf16 v[172:175], a[200:203], v[12:15], v[172:175]
    v_mfma_f32_16x16x32_bf16 v[176:179], a[200:203], v[16:19], v[176:179]
    s_waitcnt lgkmcnt(0)
    s_waitcnt vmcnt(13)
    s_barrier
    v_mfma_f32_16x16x32_bf16 v[180:183], a[204:207], v[0:3], v[180:183]
    s_add_u32 m0, s35, 16448
    ds_read_b64_tr_b16 a[184:185], v40 offset:32896
    v_mfma_f32_16x16x32_bf16 v[184:187], a[204:207], v[4:7], v[184:187]
    ds_read_b64_tr_b16 a[186:187], v40 offset:33920
    v_mfma_f32_16x16x32_bf16 v[188:191], a[204:207], v[8:11], v[188:191]
    ds_read_b128 v[20:23], v45 offset:20480
    v_mfma_f32_16x16x32_bf16 v[192:195], a[204:207], v[12:15], v[192:195]
    ds_read_b128 v[24:27], v45 offset:22528
    v_mfma_f32_16x16x32_bf16 v[196:199], a[204:207], v[16:19], v[196:199]
    ds_read_b128 v[28:31], v45 offset:24576
    v_mfma_f32_16x16x32_bf16 v[200:203], a[208:211], v[0:3], v[200:203]
    ds_read_b128 v[32:35], v45 offset:26624
    v_mfma_f32_16x16x32_bf16 v[204:207], a[208:211], v[4:7], v[204:207]
    ds_read_b128 v[36:39], v45 offset:28672
    v_mfma_f32_16x16x32_bf16 v[208:211], a[208:211], v[8:11], v[208:211]
    ds_read_b64_tr_b16 a[188:189], v40 offset:32904
    v_mfma_f32_16x16x32_bf16 v[212:215], a[208:211], v[12:15], v[212:215]
    ds_read_b64_tr_b16 a[190:191], v40 offset:33928
    v_mfma_f32_16x16x32_bf16 v[216:219], a[208:211], v[16:19], v[216:219]
    ds_read_b64_tr_b16 a[192:193], v41 offset:32896
    v_mfma_f32_16x16x32_bf16 v[220:223], a[212:215], v[0:3], v[220:223]
    ds_read_b64_tr_b16 a[194:195], v41 offset:33920
    v_mfma_f32_16x16x32_bf16 v[224:227], a[212:215], v[4:7], v[224:227]
    buffer_load_dwordx4 v46, s[12:15], s38 offen offset:0  lds
    v_mfma_f32_16x16x32_bf16 v[228:231], a[212:215], v[8:11], v[228:231]
    buffer_load_dwordx4 v47, s[12:15], s38 offen offset:1024  lds
    v_mfma_f32_16x16x32_bf16 v[232:235], a[212:215], v[12:15], v[232:235]
    buffer_load_dwordx4 v48, s[12:15], s38 offen offset:2056  lds
    v_mfma_f32_16x16x32_bf16 v[236:239], a[212:215], v[16:19], v[236:239]
    s_waitcnt lgkmcnt(8)
    buffer_load_dwordx4 v49, s[12:15], s38 offen offset:3080  lds
    v_mfma_f32_16x16x32_bf16 v[80:83], a[184:187], v[20:23], v[80:83]
    s_waitcnt lgkmcnt(7)
    ds_read_b64_tr_b16 a[196:197], v41 offset:32904
    v_mfma_f32_16x16x32_bf16 v[84:87], a[184:187], v[24:27], v[84:87]
    s_waitcnt lgkmcnt(7)
    ds_read_b64_tr_b16 a[198:199], v41 offset:33928
    v_mfma_f32_16x16x32_bf16 v[88:91], a[184:187], v[28:31], v[88:91]
    s_waitcnt lgkmcnt(7)
    s_add_u32 s38, s38, 262144
    s_and_b32 s38, s38, 0x3fffff
    v_mfma_f32_16x16x32_bf16 v[92:95], a[184:187], v[32:35], v[92:95]
    s_waitcnt lgkmcnt(6)
    v_mfma_f32_16x16x32_bf16 v[96:99], a[184:187], v[36:39], v[96:99]
    s_waitcnt lgkmcnt(4)
    v_mfma_f32_16x16x32_bf16 v[100:103], a[188:191], v[20:23], v[100:103]
    ds_read_b64_tr_b16 a[200:201], v42 offset:32896
    v_mfma_f32_16x16x32_bf16 v[104:107], a[188:191], v[24:27], v[104:107]
    ds_read_b64_tr_b16 a[202:203], v42 offset:33920
    v_mfma_f32_16x16x32_bf16 v[108:111], a[188:191], v[28:31], v[108:111]
    v_mfma_f32_16x16x32_bf16 v[112:115], a[188:191], v[32:35], v[112:115]
    v_mfma_f32_16x16x32_bf16 v[116:119], a[188:191], v[36:39], v[116:119]
    s_waitcnt lgkmcnt(4)
    v_mfma_f32_16x16x32_bf16 v[120:123], a[192:195], v[20:23], v[120:123]
    ds_read_b64_tr_b16 a[204:205], v42 offset:32904
    v_mfma_f32_16x16x32_bf16 v[124:127], a[192:195], v[24:27], v[124:127]
    ds_read_b64_tr_b16 a[206:207], v42 offset:33928
    v_mfma_f32_16x16x32_bf16 v[128:131], a[192:195], v[28:31], v[128:131]
    ds_read_b64_tr_b16 a[208:209], v43 offset:32896
    v_mfma_f32_16x16x32_bf16 v[132:135], a[192:195], v[32:35], v[132:135]
    ds_read_b64_tr_b16 a[210:211], v43 offset:33920
    v_mfma_f32_16x16x32_bf16 v[136:139], a[192:195], v[36:39], v[136:139]
    s_waitcnt lgkmcnt(6)
    ds_read_b64_tr_b16 a[212:213], v43 offset:32904
    v_mfma_f32_16x16x32_bf16 v[140:143], a[196:199], v[20:23], v[140:143]
    ds_read_b64_tr_b16 a[214:215], v43 offset:33928
    v_mfma_f32_16x16x32_bf16 v[144:147], a[196:199], v[24:27], v[144:147]
    v_mfma_f32_16x16x32_bf16 v[148:151], a[196:199], v[28:31], v[148:151]
    v_mfma_f32_16x16x32_bf16 v[152:155], a[196:199], v[32:35], v[152:155]
    v_mfma_f32_16x16x32_bf16 v[156:159], a[196:199], v[36:39], v[156:159]
    s_waitcnt lgkmcnt(6)
    v_mfma_f32_16x16x32_bf16 v[160:163], a[200:203], v[20:23], v[160:163]
    v_mfma_f32_16x16x32_bf16 v[164:167], a[200:203], v[24:27], v[164:167]
    v_mfma_f32_16x16x32_bf16 v[168:171], a[200:203], v[28:31], v[168:171]
    v_mfma_f32_16x16x32_bf16 v[172:175], a[200:203], v[32:35], v[172:175]
    v_mfma_f32_16x16x32_bf16 v[176:179], a[200:203], v[36:39], v[176:179]
    s_waitcnt lgkmcnt(0)
    s_waitcnt vmcnt(8)
    s_barrier
    v_mfma_f32_16x16x32_bf16 v[180:183], a[204:207], v[20:23], v[180:183]
    s_add_u32 m0, s35, 32896
    ds_read_b64_tr_b16 a[184:185], v40 offset:0
    v_mfma_f32_16x16x32_bf16 v[184:187], a[204:207], v[24:27], v[184:187]
    ds_read_b64_tr_b16 a[186:187], v40 offset:1024
    v_mfma_f32_16x16x32_bf16 v[188:191], a[204:207], v[28:31], v[188:191]
    ds_read_b128 v[0:3], v44 offset:0
    v_mfma_f32_16x16x32_bf16 v[192:195], a[204:207], v[32:35], v[192:195]
    ds_read_b128 v[4:7], v44 offset:2048
    v_mfma_f32_16x16x32_bf16 v[196:199], a[204:207], v[36:39], v[196:199]
    ds_read_b128 v[8:11], v44 offset:4096
    v_mfma_f32_16x16x32_bf16 v[200:203], a[208:211], v[20:23], v[200:203]
    ds_read_b128 v[12:15], v44 offset:6144
    v_mfma_f32_16x16x32_bf16 v[204:207], a[208:211], v[24:27], v[204:207]
    ds_read_b128 v[16:19], v44 offset:8192
    v_mfma_f32_16x16x32_bf16 v[208:211], a[208:211], v[28:31], v[208:211]
    ds_read_b64_tr_b16 a[188:189], v40 offset:8
    v_mfma_f32_16x16x32_bf16 v[212:215], a[208:211], v[32:35], v[212:215]
    ds_read_b64_tr_b16 a[190:191], v40 offset:1032
    v_mfma_f32_16x16x32_bf16 v[216:219], a[208:211], v[36:39], v[216:219]
    ds_read_b64_tr_b16 a[192:193], v41 offset:0
    v_mfma_f32_16x16x32_bf16 v[220:223], a[212:215], v[20:23], v[220:223]
    ds_read_b64_tr_b16 a[194:195], v41 offset:1024
    v_mfma_f32_16x16x32_bf16 v[224:227], a[212:215], v[24:27], v[224:227]
    buffer_load_dwordx4 v46, s[12:15], s38 offen offset:0  lds
    v_mfma_f32_16x16x32_bf16 v[228:231], a[212:215], v[28:31], v[228:231]
    buffer_load_dwordx4 v47, s[12:15], s38 offen offset:1024  lds
    v_mfma_f32_16x16x32_bf16 v[232:235], a[212:215], v[32:35], v[232:235]
    buffer_load_dwordx4 v48, s[12:15], s38 offen offset:2056  lds
    v_mfma_f32_16x16x32_bf16 v[236:239], a[212:215], v[36:39], v[236:239]
    s_waitcnt lgkmcnt(8)
    buffer_load_dwordx4 v49, s[12:15], s38 offen offset:3080  lds
    v_mfma_f32_16x16x32_bf16 v[80:83], a[184:187], v[0:3], v[80:83]
    s_waitcnt lgkmcnt(7)
    ds_read_b64_tr_b16 a[196:197], v41 offset:8
    v_mfma_f32_16x16x32_bf16 v[84:87], a[184:187], v[4:7], v[84:87]
    s_waitcnt lgkmcnt(7)
    ds_read_b64_tr_b16 a[198:199], v41 offset:1032
    v_mfma_f32_16x16x32_bf16 v[88:91], a[184:187], v[8:11], v[88:91]
    s_waitcnt lgkmcnt(7)
    s_add_u32 s38, s38, 262144
    s_and_b32 s38, s38, 0x3fffff
    v_mfma_f32_16x16x32_bf16 v[92:95], a[184:187], v[12:15], v[92:95]
    s_waitcnt lgkmcnt(6)
    s_add_u32 m0, s36, 20480
    s_add_u32 s33, s37, s51
    v_mfma_f32_16x16x32_bf16 v[96:99], a[184:187], v[16:19], v[96:99]
    s_waitcnt lgkmcnt(4)
    buffer_load_dwordx4 v50, s[8:11], s33 offen offset:0  lds
    v_mfma_f32_16x16x32_bf16 v[100:103], a[188:191], v[0:3], v[100:103]
    ds_read_b64_tr_b16 a[200:201], v42 offset:0
    v_mfma_f32_16x16x32_bf16 v[104:107], a[188:191], v[4:7], v[104:107]
    ds_read_b64_tr_b16 a[202:203], v42 offset:1024
    v_mfma_f32_16x16x32_bf16 v[108:111], a[188:191], v[8:11], v[108:111]
    buffer_load_dwordx4 v51, s[8:11], s33 offen offset:1024  lds
    v_mfma_f32_16x16x32_bf16 v[112:115], a[188:191], v[12:15], v[112:115]
    buffer_load_dwordx4 v52, s[8:11], s33 offen offset:2048  lds
    v_mfma_f32_16x16x32_bf16 v[116:119], a[188:191], v[16:19], v[116:119]
    s_waitcnt lgkmcnt(4)
    buffer_load_dwordx4 v53, s[8:11], s33 offen offset:3072  lds
    v_mfma_f32_16x16x32_bf16 v[120:123], a[192:195], v[0:3], v[120:123]
    s_add_u32 m0, s36, 24576
    ds_read_b64_tr_b16 a[204:205], v42 offset:8
    v_mfma_f32_16x16x32_bf16 v[124:127], a[192:195], v[4:7], v[124:127]
    s_nop 0
    ds_read_b64_tr_b16 a[206:207], v42 offset:1032
    v_mfma_f32_16x16x32_bf16 v[128:131], a[192:195], v[8:11], v[128:131]
    ds_read_b64_tr_b16 a[208:209], v43 offset:0
    v_mfma_f32_16x16x32_bf16 v[132:135], a[192:195], v[12:15], v[132:135]
    ds_read_b64_tr_b16 a[210:211], v43 offset:1024
    v_mfma_f32_16x16x32_bf16 v[136:139], a[192:195], v[16:19], v[136:139]
    s_waitcnt lgkmcnt(6)
    ds_read_b64_tr_b16 a[212:213], v43 offset:8
    v_mfma_f32_16x16x32_bf16 v[140:143], a[196:199], v[0:3], v[140:143]
    ds_read_b64_tr_b16 a[214:215], v43 offset:1032
    v_mfma_f32_16x16x32_bf16 v[144:147], a[196:199], v[4:7], v[144:147]
    buffer_load_dwordx4 v54, s[8:11], s33 offen offset:0  lds
    v_mfma_f32_16x16x32_bf16 v[148:151], a[196:199], v[8:11], v[148:151]
    s_add_u32 s51, s51, 128
    s_and_b32 s51, s51, 0x3ff
    s_add_u32 m0, s39, 131072
    v_mfma_f32_16x16x32_bf16 v[152:155], a[196:199], v[12:15], v[152:155]
    s_add_u32 s34, s93, 0
    s_and_b32 s34, s34, 0x1ffff
    v_mfma_f32_16x16x32_bf16 v[156:159], a[196:199], v[16:19], v[156:159]
    s_waitcnt lgkmcnt(6)
    buffer_load_dwordx4 v70, s[20:23], s34 offen offset:0 nt lds
    v_mfma_f32_16x16x32_bf16 v[160:163], a[200:203], v[0:3], v[160:163]
    buffer_load_dwordx4 v71, s[20:23], s34 offen offset:1024 nt lds
    v_mfma_f32_16x16x32_bf16 v[164:167], a[200:203], v[4:7], v[164:167]
    buffer_load_dwordx4 v70, s[20:23], s34 offen offset:2048 nt lds
    v_mfma_f32_16x16x32_bf16 v[168:171], a[200:203], v[8:11], v[168:171]
    buffer_load_dwordx4 v71, s[20:23], s34 offen offset:3072 nt lds
    v_mfma_f32_16x16x32_bf16 v[172:175], a[200:203], v[12:15], v[172:175]
    v_mfma_f32_16x16x32_bf16 v[176:179], a[200:203], v[16:19], v[176:179]
    s_waitcnt lgkmcnt(0)
    s_waitcnt vmcnt(13)
    s_barrier
    v_mfma_f32_16x16x32_bf16 v[180:183], a[204:207], v[0:3], v[180:183]
    s_add_u32 m0, s35, 0
    ds_read_b64_tr_b16 a[184:185], v40 offset:16448
    v_mfma_f32_16x16x32_bf16 v[184:187], a[204:207], v[4:7], v[184:187]
    ds_read_b64_tr_b16 a[186:187], v40 offset:17472
    v_mfma_f32_16x16x32_bf16 v[188:191], a[204:207], v[8:11], v[188:191]
    ds_read_b128 v[20:23], v45 offset:0
    v_mfma_f32_16x16x32_bf16 v[192:195], a[204:207], v[12:15], v[192:195]
    ds_read_b128 v[24:27], v45 offset:2048
    v_mfma_f32_16x16x32_bf16 v[196:199], a[204:207], v[16:19], v[196:199]
    ds_read_b128 v[28:31], v45 offset:4096
    v_mfma_f32_16x16x32_bf16 v[200:203], a[208:211], v[0:3], v[200:203]
    ds_read_b128 v[32:35], v45 offset:6144
    v_mfma_f32_16x16x32_bf16 v[204:207], a[208:211], v[4:7], v[204:207]
    ds_read_b128 v[36:39], v45 offset:8192
    v_mfma_f32_16x16x32_bf16 v[208:211], a[208:211], v[8:11], v[208:211]
    ds_read_b64_tr_b16 a[188:189], v40 offset:16456
    v_mfma_f32_16x16x32_bf16 v[212:215], a[208:211], v[12:15], v[212:215]
    ds_read_b64_tr_b16 a[190:191], v40 offset:17480
    v_mfma_f32_16x16x32_bf16 v[216:219], a[208:211], v[16:19], v[216:219]
    ds_read_b64_tr_b16 a[192:193], v41 offset:16448
    v_mfma_f32_16x16x32_bf16 v[220:223], a[212:215], v[0:3], v[220:223]
    ds_read_b64_tr_b16 a[194:195], v41 offset:17472
    v_mfma_f32_16x16x32_bf16 v[224:227], a[212:215], v[4:7], v[224:227]
    buffer_load_dwordx4 v46, s[12:15], s38 offen offset:0  lds
    v_mfma_f32_16x16x32_bf16 v[228:231], a[212:215], v[8:11], v[228:231]
    buffer_load_dwordx4 v47, s[12:15], s38 offen offset:1024  lds
    v_mfma_f32_16x16x32_bf16 v[232:235], a[212:215], v[12:15], v[232:235]
    buffer_load_dwordx4 v48, s[12:15], s38 offen offset:2056  lds
    v_mfma_f32_16x16x32_bf16 v[236:239], a[212:215], v[16:19], v[236:239]
    s_waitcnt lgkmcnt(8)
    buffer_load_dwordx4 v49, s[12:15], s38 offen offset:3080  lds
    v_mfma_f32_16x16x32_bf16 v[80:83], a[184:187], v[20:23], v[80:83]
    s_waitcnt lgkmcnt(7)
    ds_read_b64_tr_b16 a[196:197], v41 offset:16456
    v_mfma_f32_16x16x32_bf16 v[84:87], a[184:187], v[24:27], v[84:87]
    s_waitcnt lgkmcnt(7)
    ds_read_b64_tr_b16 a[198:199], v41 offset:17480
    v_mfma_f32_16x16x32_bf16 v[88:91], a[184:187], v[28:31], v[88:91]
    s_waitcnt lgkmcnt(7)
    s_add_u32 s38, s38, 262144
    s_and_b32 s38, s38, 0x3fffff
    v_mfma_f32_16x16x32_bf16 v[92:95], a[184:187], v[32:35], v[92:95]
    s_waitcnt lgkmcnt(6)
    v_mfma_f32_16x16x32_bf16 v[96:99], a[184:187], v[36:39], v[96:99]
    s_waitcnt lgkmcnt(4)
    v_mfma_f32_16x16x32_bf16 v[100:103], a[188:191], v[20:23], v[100:103]
    ds_read_b64_tr_b16 a[200:201], v42 offset:16448
    v_mfma_f32_16x16x32_bf16 v[104:107], a[188:191], v[24:27], v[104:107]
    ds_read_b64_tr_b16 a[202:203], v42 offset:17472
    v_mfma_f32_16x16x32_bf16 v[108:111], a[188:191], v[28:31], v[108:111]
    v_mfma_f32_16x16x32_bf16 v[112:115], a[188:191], v[32:35], v[112:115]
    v_mfma_f32_16x16x32_bf16 v[116:119], a[188:191], v[36:39], v[116:119]
    s_waitcnt lgkmcnt(4)
    v_mfma_f32_16x16x32_bf16 v[120:123], a[192:195], v[20:23], v[120:123]
    ds_read_b64_tr_b16 a[204:205], v42 offset:16456
    v_mfma_f32_16x16x32_bf16 v[124:127], a[192:195], v[24:27], v[124:127]
    ds_read_b64_tr_b16 a[206:207], v42 offset:17480
    v_mfma_f32_16x16x32_bf16 v[128:131], a[192:195], v[28:31], v[128:131]
    ds_read_b64_tr_b16 a[208:209], v43 offset:16448
    v_mfma_f32_16x16x32_bf16 v[132:135], a[192:195], v[32:35], v[132:135]
    ds_read_b64_tr_b16 a[210:211], v43 offset:17472
    v_mfma_f32_16x16x32_bf16 v[136:139], a[192:195], v[36:39], v[136:139]
    s_waitcnt lgkmcnt(6)
    ds_read_b64_tr_b16 a[212:213], v43 offset:16456
    v_mfma_f32_16x16x32_bf16 v[140:143], a[196:199], v[20:23], v[140:143]
    ds_read_b64_tr_b16 a[214:215], v43 offset:17480
    v_mfma_f32_16x16x32_bf16 v[144:147], a[196:199], v[24:27], v[144:147]
    v_mfma_f32_16x16x32_bf16 v[148:151], a[196:199], v[28:31], v[148:151]
    v_mfma_f32_16x16x32_bf16 v[152:155], a[196:199], v[32:35], v[152:155]
    v_mfma_f32_16x16x32_bf16 v[156:159], a[196:199], v[36:39], v[156:159]
    s_waitcnt lgkmcnt(6)
    v_mfma_f32_16x16x32_bf16 v[160:163], a[200:203], v[20:23], v[160:163]
    v_mfma_f32_16x16x32_bf16 v[164:167], a[200:203], v[24:27], v[164:167]
    v_mfma_f32_16x16x32_bf16 v[168:171], a[200:203], v[28:31], v[168:171]
    v_mfma_f32_16x16x32_bf16 v[172:175], a[200:203], v[32:35], v[172:175]
    v_mfma_f32_16x16x32_bf16 v[176:179], a[200:203], v[36:39], v[176:179]
    s_waitcnt lgkmcnt(0)
    s_waitcnt vmcnt(8)
    s_barrier
    v_mfma_f32_16x16x32_bf16 v[180:183], a[204:207], v[20:23], v[180:183]
    s_add_u32 m0, s39, 147456
    ds_read_b64_tr_b16 a[184:185], v40 offset:32896
    v_mfma_f32_16x16x32_bf16 v[184:187], a[204:207], v[24:27], v[184:187]
    s_add_u32 s34, s93, 8192
    ds_read_b64_tr_b16 a[186:187], v40 offset:33920
    v_mfma_f32_16x16x32_bf16 v[188:191], a[204:207], v[28:31], v[188:191]
    s_and_b32 s34, s34, 0x1ffff
    ds_read_b128 v[0:3], v44 offset:20480
    v_mfma_f32_16x16x32_bf16 v[192:195], a[204:207], v[32:35], v[192:195]
    ds_read_b128 v[4:7], v44 offset:22528
    v_mfma_f32_16x16x32_bf16 v[196:199], a[204:207], v[36:39], v[196:199]
    ds_read_b128 v[8:11], v44 offset:24576
    v_mfma_f32_16x16x32_bf16 v[200:203], a[208:211], v[20:23], v[200:203]
    ds_read_b128 v[12:15], v44 offset:26624
    v_mfma_f32_16x16x32_bf16 v[204:207], a[208:211], v[24:27], v[204:207]
    ds_read_b128 v[16:19], v44 offset:28672
    v_mfma_f32_16x16x32_bf16 v[208:211], a[208:211], v[28:31], v[208:211]
    ds_read_b64_tr_b16 a[188:189], v40 offset:32904
    v_mfma_f32_16x16x32_bf16 v[212:215], a[208:211], v[32:35], v[212:215]
    ds_read_b64_tr_b16 a[190:191], v40 offset:33928
    v_mfma_f32_16x16x32_bf16 v[216:219], a[208:211], v[36:39], v[216:219]
    ds_read_b64_tr_b16 a[192:193], v41 offset:32896
    v_mfma_f32_16x16x32_bf16 v[220:223], a[212:215], v[20:23], v[220:223]
    ds_read_b64_tr_b16 a[194:195], v41 offset:33920
    v_mfma_f32_16x16x32_bf16 v[224:227], a[212:215], v[24:27], v[224:227]
    buffer_load_dwordx4 v70, s[20:23], s34 offen offset:0 nt lds
    v_mfma_f32_16x16x32_bf16 v[228:231], a[212:215], v[28:31], v[228:231]
    buffer_load_dwordx4 v71, s[20:23], s34 offen offset:1024 nt lds
    v_mfma_f32_16x16x32_bf16 v[232:235], a[212:215], v[32:35], v[232:235]
    buffer_load_dwordx4 v70, s[20:23], s34 offen offset:2048 nt lds
    v_mfma_f32_16x16x32_bf16 v[236:239], a[212:215], v[36:39], v[236:239]
    s_waitcnt lgkmcnt(8)
    buffer_load_dwordx4 v71, s[20:23], s34 offen offset:3072 nt lds
    v_mfma_f32_16x16x32_bf16 v[80:83], a[184:187], v[0:3], v[80:83]
    s_waitcnt lgkmcnt(7)
    ds_read_b64_tr_b16 a[196:197], v41 offset:32904
    v_mfma_f32_16x16x32_bf16 v[84:87], a[184:187], v[4:7], v[84:87]
    s_waitcnt lgkmcnt(7)
    ds_read_b64_tr_b16 a[198:199], v41 offset:33928
    v_mfma_f32_16x16x32_bf16 v[88:91], a[184:187], v[8:11], v[88:91]
    s_waitcnt lgkmcnt(7)
    v_mfma_f32_16x16x32_bf16 v[92:95], a[184:187], v[12:15], v[92:95]
    s_waitcnt lgkmcnt(6)
    v_mfma_f32_16x16x32_bf16 v[96:99], a[184:187], v[16:19], v[96:99]
    s_waitcnt lgkmcnt(4)
    v_mfma_f32_16x16x32_bf16 v[100:103], a[188:191], v[0:3], v[100:103]
    ds_read_b64_tr_b16 a[200:201], v42 offset:32896
    v_mfma_f32_16x16x32_bf16 v[104:107], a[188:191], v[4:7], v[104:107]
    ds_read_b64_tr_b16 a[202:203], v42 offset:33920
    v_mfma_f32_16x16x32_bf16 v[108:111], a[188:191], v[8:11], v[108:111]
    v_mfma_f32_16x16x32_bf16 v[112:115], a[188:191], v[12:15], v[112:115]
    v_mfma_f32_16x16x32_bf16 v[116:119], a[188:191], v[16:19], v[116:119]
    s_waitcnt lgkmcnt(4)
    v_mfma_f32_16x16x32_bf16 v[120:123], a[192:195], v[0:3], v[120:123]
    ds_read_b64_tr_b16 a[204:205], v42 offset:32904
    v_mfma_f32_16x16x32_bf16 v[124:127], a[192:195], v[4:7], v[124:127]
    ds_read_b64_tr_b16 a[206:207], v42 offset:33928
    v_mfma_f32_16x16x32_bf16 v[128:131], a[192:195], v[8:11], v[128:131]
    ds_read_b64_tr_b16 a[208:209], v43 offset:32896
    v_mfma_f32_16x16x32_bf16 v[132:135], a[192:195], v[12:15], v[132:135]
    ds_read_b64_tr_b16 a[210:211], v43 offset:33920
    v_mfma_f32_16x16x32_bf16 v[136:139], a[192:195], v[16:19], v[136:139]
    s_waitcnt lgkmcnt(6)
    ds_read_b64_tr_b16 a[212:213], v43 offset:32904
    v_mfma_f32_16x16x32_bf16 v[140:143], a[196:199], v[0:3], v[140:143]
    ds_read_b64_tr_b16 a[214:215], v43 offset:33928
    v_mfma_f32_16x16x32_bf16 v[144:147], a[196:199], v[4:7], v[144:147]
    v_mfma_f32_16x16x32_bf16 v[148:151], a[196:199], v[8:11], v[148:151]
    v_mfma_f32_16x16x32_bf16 v[152:155], a[196:199], v[12:15], v[152:155]
    v_mfma_f32_16x16x32_bf16 v[156:159], a[196:199], v[16:19], v[156:159]
    s_waitcnt lgkmcnt(6)
    v_mfma_f32_16x16x32_bf16 v[160:163], a[200:203], v[0:3], v[160:163]
    v_mfma_f32_16x16x32_bf16 v[164:167], a[200:203], v[4:7], v[164:167]
    v_mfma_f32_16x16x32_bf16 v[168:171], a[200:203], v[8:11], v[168:171]
    v_mfma_f32_16x16x32_bf16 v[172:175], a[200:203], v[12:15], v[172:175]
    v_mfma_f32_16x16x32_bf16 v[176:179], a[200:203], v[16:19], v[176:179]
    s_waitcnt lgkmcnt(0)
    s_waitcnt vmcnt(4)
    s_barrier
    v_mfma_f32_16x16x32_bf16 v[180:183], a[204:207], v[0:3], v[180:183]
    ds_read_b64_tr_b16 a[184:185], v40 offset:0
    v_mfma_f32_16x16x32_bf16 v[184:187], a[204:207], v[4:7], v[184:187]
    ds_read_b64_tr_b16 a[186:187], v40 offset:1024
    v_mfma_f32_16x16x32_bf16 v[188:191], a[204:207], v[8:11], v[188:191]
    ds_read_b128 v[20:23], v45 offset:20480
    v_mfma_f32_16x16x32_bf16 v[192:195], a[204:207], v[12:15], v[192:195]
    ds_read_b128 v[24:27], v45 offset:22528
    v_mfma_f32_16x16x32_bf16 v[196:199], a[204:207], v[16:19], v[196:199]
    ds_read_b128 v[28:31], v45 offset:24576
    v_mfma_f32_16x16x32_bf16 v[200:203], a[208:211], v[0:3], v[200:203]
    ds_read_b128 v[32:35], v45 offset:26624
    v_mfma_f32_16x16x32_bf16 v[204:207], a[208:211], v[4:7], v[204:207]
    ds_read_b128 v[36:39], v45 offset:28672
    v_mfma_f32_16x16x32_bf16 v[208:211], a[208:211], v[8:11], v[208:211]
    ds_read_b64_tr_b16 a[188:189], v40 offset:8
    v_mfma_f32_16x16x32_bf16 v[212:215], a[208:211], v[12:15], v[212:215]
    ds_read_b64_tr_b16 a[190:191], v40 offset:1032
    v_mfma_f32_16x16x32_bf16 v[216:219], a[208:211], v[16:19], v[216:219]
    ds_read_b64_tr_b16 a[192:193], v41 offset:0
    v_mfma_f32_16x16x32_bf16 v[220:223], a[212:215], v[0:3], v[220:223]
    ds_read_b64_tr_b16 a[194:195], v41 offset:1024
    v_mfma_f32_16x16x32_bf16 v[224:227], a[212:215], v[4:7], v[224:227]
    v_mfma_f32_16x16x32_bf16 v[228:231], a[212:215], v[8:11], v[228:231]
    v_mfma_f32_16x16x32_bf16 v[232:235], a[212:215], v[12:15], v[232:235]
    v_mfma_f32_16x16x32_bf16 v[236:239], a[212:215], v[16:19], v[236:239]
    s_waitcnt lgkmcnt(8)
    v_mfma_f32_16x16x32_bf16 v[80:83], a[184:187], v[20:23], v[80:83]
    s_waitcnt lgkmcnt(7)
    ds_read_b64_tr_b16 a[196:197], v41 offset:8
    v_mfma_f32_16x16x32_bf16 v[84:87], a[184:187], v[24:27], v[84:87]
    s_waitcnt lgkmcnt(7)
    ds_read_b64_tr_b16 a[198:199], v41 offset:1032
    v_mfma_f32_16x16x32_bf16 v[88:91], a[184:187], v[28:31], v[88:91]
    s_waitcnt lgkmcnt(7)
    v_mfma_f32_16x16x32_bf16 v[92:95], a[184:187], v[32:35], v[92:95]
    s_waitcnt lgkmcnt(6)
    v_mfma_f32_16x16x32_bf16 v[96:99], a[184:187], v[36:39], v[96:99]
    s_waitcnt lgkmcnt(4)
    v_mfma_f32_16x16x32_bf16 v[100:103], a[188:191], v[20:23], v[100:103]
    ds_read_b64_tr_b16 a[200:201], v42 offset:0
    v_mfma_f32_16x16x32_bf16 v[104:107], a[188:191], v[24:27], v[104:107]
    ds_read_b64_tr_b16 a[202:203], v42 offset:1024
    v_mfma_f32_16x16x32_bf16 v[108:111], a[188:191], v[28:31], v[108:111]
    v_mfma_f32_16x16x32_bf16 v[112:115], a[188:191], v[32:35], v[112:115]
    v_mfma_f32_16x16x32_bf16 v[116:119], a[188:191], v[36:39], v[116:119]
    s_waitcnt lgkmcnt(4)
    v_mfma_f32_16x16x32_bf16 v[120:123], a[192:195], v[20:23], v[120:123]
    ds_read_b64_tr_b16 a[204:205], v42 offset:8
    v_mfma_f32_16x16x32_bf16 v[124:127], a[192:195], v[24:27], v[124:127]
    ds_read_b64_tr_b16 a[206:207], v42 offset:1032
    v_mfma_f32_16x16x32_bf16 v[128:131], a[192:195], v[28:31], v[128:131]
    ds_read_b64_tr_b16 a[208:209], v43 offset:0
    v_mfma_f32_16x16x32_bf16 v[132:135], a[192:195], v[32:35], v[132:135]
    ds_read_b64_tr_b16 a[210:211], v43 offset:1024
    v_mfma_f32_16x16x32_bf16 v[136:139], a[192:195], v[36:39], v[136:139]
    s_waitcnt lgkmcnt(6)
    ds_read_b64_tr_b16 a[212:213], v43 offset:8
    v_mfma_f32_16x16x32_bf16 v[140:143], a[196:199], v[20:23], v[140:143]
    ds_read_b64_tr_b16 a[214:215], v43 offset:1032
    v_mfma_f32_16x16x32_bf16 v[144:147], a[196:199], v[24:27], v[144:147]
    v_mfma_f32_16x16x32_bf16 v[148:151], a[196:199], v[28:31], v[148:151]
    v_mfma_f32_16x16x32_bf16 v[152:155], a[196:199], v[32:35], v[152:155]
    v_mfma_f32_16x16x32_bf16 v[156:159], a[196:199], v[36:39], v[156:159]
    s_waitcnt lgkmcnt(6)
    v_mfma_f32_16x16x32_bf16 v[160:163], a[200:203], v[20:23], v[160:163]
    v_mfma_f32_16x16x32_bf16 v[164:167], a[200:203], v[24:27], v[164:167]
    v_mfma_f32_16x16x32_bf16 v[168:171], a[200:203], v[28:31], v[168:171]
    v_mfma_f32_16x16x32_bf16 v[172:175], a[200:203], v[32:35], v[172:175]
    v_mfma_f32_16x16x32_bf16 v[176:179], a[200:203], v[36:39], v[176:179]
    s_waitcnt lgkmcnt(0)
    s_waitcnt vmcnt(0)
    s_barrier
    v_mfma_f32_16x16x32_bf16 v[180:183], a[204:207], v[20:23], v[180:183]
    s_add_u32 m0, s39, 32768
    s_add_u32 s34, s93, 16384
    s_and_b32 s34, s34, 0x1ffff
    v_mfma_f32_16x16x32_bf16 v[184:187], a[204:207], v[24:27], v[184:187]
    buffer_load_dwordx4 v252, s[16:19], s34 offen offset:0 nt lds
    v_mfma_f32_16x16x32_bf16 v[188:191], a[204:207], v[28:31], v[188:191]
    buffer_load_dwordx4 v253, s[16:19], s34 offen offset:1024 nt lds
    v_mfma_f32_16x16x32_bf16 v[192:195], a[204:207], v[32:35], v[192:195]
    buffer_load_dwordx4 v254, s[16:19], s34 offen offset:2048 nt lds
    v_mfma_f32_16x16x32_bf16 v[196:199], a[204:207], v[36:39], v[196:199]
    buffer_load_dwordx4 v255, s[16:19], s34 offen offset:3072 nt lds
    v_mfma_f32_16x16x32_bf16 v[200:203], a[208:211], v[20:23], v[200:203]
    s_add_u32 m0, s39, 49152
    s_add_u32 s34, s93, 24576
    s_and_b32 s34, s34, 0x1ffff
    v_mfma_f32_16x16x32_bf16 v[204:207], a[208:211], v[24:27], v[204:207]
    buffer_load_dwordx4 v252, s[16:19], s34 offen offset:0 nt lds
    v_mfma_f32_16x16x32_bf16 v[208:211], a[208:211], v[28:31], v[208:211]
    buffer_load_dwordx4 v253, s[16:19], s34 offen offset:1024 nt lds
    v_mfma_f32_16x16x32_bf16 v[212:215], a[208:211], v[32:35], v[212:215]
    buffer_load_dwordx4 v254, s[16:19], s34 offen offset:2048 nt lds
    v_mfma_f32_16x16x32_bf16 v[216:219], a[208:211], v[36:39], v[216:219]
    buffer_load_dwordx4 v255, s[16:19], s34 offen offset:3072 nt lds
    v_mfma_f32_16x16x32_bf16 v[220:223], a[212:215], v[20:23], v[220:223]
    v_mfma_f32_16x16x32_bf16 v[224:227], a[212:215], v[24:27], v[224:227]
    v_mfma_f32_16x16x32_bf16 v[228:231], a[212:215], v[28:31], v[228:231]
    v_mfma_f32_16x16x32_bf16 v[232:235], a[212:215], v[32:35], v[232:235]
    v_mfma_f32_16x16x32_bf16 v[236:239], a[212:215], v[36:39], v[236:239]
    v_accvgpr_write_b32 a216, v70
    v_accvgpr_write_b32 a217, v71
    v_accvgpr_write_b32 a218, v57
    ds_read_b128 a[184:187], v240 offset:0
    ds_read_b128 a[188:191], v241 offset:0
    ds_read_b128 a[192:195], v242 offset:0
    s_nop 7
    v_pk_mul_f32 v[80:81], v[80:81], s[50:51] op_sel_hi:[1,0]
    v_pk_mul_f32 v[82:83], v[82:83], s[50:51] op_sel_hi:[1,0]
    v_pk_mul_f32 v[84:85], v[84:85], s[50:51] op_sel_hi:[1,0]
    v_pk_mul_f32 v[86:87], v[86:87], s[50:51] op_sel_hi:[1,0]
    v_pk_mul_f32 v[88:89], v[88:89], s[50:51] op_sel_hi:[1,0]
    v_pk_mul_f32 v[90:91], v[90:91], s[50:51] op_sel_hi:[1,0]
    v_pk_mul_f32 v[92:93], v[92:93], s[50:51] op_sel_hi:[1,0]
    v_pk_mul_f32 v[94:95], v[94:95], s[50:51] op_sel_hi:[1,0]
    v_pk_mul_f32 v[96:97], v[96:97], s[50:51] op_sel_hi:[1,0]
    v_pk_mul_f32 v[98:99], v[98:99], s[50:51] op_sel_hi:[1,0]
    v_pk_mul_f32 v[100:101], v[100:101], s[50:51] op_sel_hi:[1,0]
    v_pk_mul_f32 v[102:103], v[102:103], s[50:51] op_sel_hi:[1,0]
    v_pk_mul_f32 v[104:105], v[104:105], s[50:51] op_sel_hi:[1,0]
    v_pk_mul_f32 v[106:107], v[106:107], s[50:51] op_sel_hi:[1,0]
    v_pk_mul_f32 v[108:109], v[108:109], s[50:51] op_sel_hi:[1,0]
    v_pk_mul_f32 v[110:111], v[110:111], s[50:51] op_sel_hi:[1,0]
    v_pk_mul_f32 v[112:113], v[112:113], s[50:51] op_sel_hi:[1,0]
    v_pk_mul_f32 v[114:115], v[114:115], s[50:51] op_sel_hi:[1,0]
    v_pk_mul_f32 v[116:117], v[116:117], s[50:51] op_sel_hi:[1,0]
    v_pk_mul_f32 v[118:119], v[118:119], s[50:51] op_sel_hi:[1,0]
    v_pk_mul_f32 v[120:121], v[120:121], s[50:51] op_sel_hi:[1,0]
    v_pk_mul_f32 v[122:123], v[122:123], s[50:51] op_sel_hi:[1,0]
    v_pk_mul_f32 v[124:125], v[124:125], s[50:51] op_sel_hi:[1,0]
    v_pk_mul_f32 v[126:127], v[126:127], s[50:51] op_sel_hi:[1,0]
    v_pk_mul_f32 v[128:129], v[128:129], s[50:51] op_sel_hi:[1,0]
    v_pk_mul_f32 v[130:131], v[130:131], s[50:51] op_sel_hi:[1,0]
    v_pk_mul_f32 v[132:133], v[132:133], s[50:51] op_sel_hi:[1,0]
    v_pk_mul_f32 v[134:135], v[134:135], s[50:51] op_sel_hi:[1,0]
    v_pk_mul_f32 v[136:137], v[136:137], s[50:51] op_sel_hi:[1,0]
    v_pk_mul_f32 v[138:139], v[138:139], s[50:51] op_sel_hi:[1,0]
    v_pk_mul_f32 v[140:141], v[140:141], s[50:51] op_sel_hi:[1,0]
    v_pk_mul_f32 v[142:143], v[142:143], s[50:51] op_sel_hi:[1,0]
    v_pk_mul_f32 v[144:145], v[144:145], s[50:51] op_sel_hi:[1,0]
    v_pk_mul_f32 v[146:147], v[146:147], s[50:51] op_sel_hi:[1,0]
    v_pk_mul_f32 v[148:149], v[148:149], s[50:51] op_sel_hi:[1,0]
    v_pk_mul_f32 v[150:151], v[150:151], s[50:51] op_sel_hi:[1,0]
    v_pk_mul_f32 v[152:153], v[152:153], s[50:51] op_sel_hi:[1,0]
    v_pk_mul_f32 v[154:155], v[154:155], s[50:51] op_sel_hi:[1,0]
    v_pk_mul_f32 v[156:157], v[156:157], s[50:51] op_sel_hi:[1,0]
    v_pk_mul_f32 v[158:159], v[158:159], s[50:51] op_sel_hi:[1,0]
    v_pk_mul_f32 v[160:161], v[160:161], s[50:51] op_sel_hi:[1,0]
    v_pk_mul_f32 v[162:163], v[162:163], s[50:51] op_sel_hi:[1,0]
    v_pk_mul_f32 v[164:165], v[164:165], s[50:51] op_sel_hi:[1,0]
    v_pk_mul_f32 v[166:167], v[166:167], s[50:51] op_sel_hi:[1,0]
    v_pk_mul_f32 v[168:169], v[168:169], s[50:51] op_sel_hi:[1,0]
    v_pk_mul_f32 v[170:171], v[170:171], s[50:51] op_sel_hi:[1,0]
    v_pk_mul_f32 v[172:173], v[172:173], s[50:51] op_sel_hi:[1,0]
    v_pk_mul_f32 v[174:175], v[174:175], s[50:51] op_sel_hi:[1,0]
    v_pk_mul_f32 v[176:177], v[176:177], s[50:51] op_sel_hi:[1,0]
    v_pk_mul_f32 v[178:179], v[178:179], s[50:51] op_sel_hi:[1,0]
    v_pk_mul_f32 v[180:181], v[180:181], s[50:51] op_sel_hi:[1,0]
    v_pk_mul_f32 v[182:183], v[182:183], s[50:51] op_sel_hi:[1,0]
    v_pk_mul_f32 v[184:185], v[184:185], s[50:51] op_sel_hi:[1,0]
    v_pk_mul_f32 v[186:187], v[186:187], s[50:51] op_sel_hi:[1,0]
    v_pk_mul_f32 v[188:189], v[188:189], s[50:51] op_sel_hi:[1,0]
    v_pk_mul_f32 v[190:191], v[190:191], s[50:51] op_sel_hi:[1,0]
    v_pk_mul_f32 v[192:193], v[192:193], s[50:51] op_sel_hi:[1,0]
    v_pk_mul_f32 v[194:195], v[194:195], s[50:51] op_sel_hi:[1,0]
    v_pk_mul_f32 v[196:197], v[196:197], s[50:51] op_sel_hi:[1,0]
    v_pk_mul_f32 v[198:199], v[198:199], s[50:51] op_sel_hi:[1,0]
    v_pk_mul_f32 v[200:201], v[200:201], s[50:51] op_sel_hi:[1,0]
    v_pk_mul_f32 v[202:203], v[202:203], s[50:51] op_sel_hi:[1,0]
    v_pk_mul_f32 v[204:205], v[204:205], s[50:51] op_sel_hi:[1,0]
    v_pk_mul_f32 v[206:207], v[206:207], s[50:51] op_sel_hi:[1,0]
    v_pk_mul_f32 v[208:209], v[208:209], s[50:51] op_sel_hi:[1,0]
    v_pk_mul_f32 v[210:211], v[210:211], s[50:51] op_sel_hi:[1,0]
    v_pk_mul_f32 v[212:213], v[212:213], s[50:51] op_sel_hi:[1,0]
    v_pk_mul_f32 v[214:215], v[214:215], s[50:51] op_sel_hi:[1,0]
    v_pk_mul_f32 v[216:217], v[216:217], s[50:51] op_sel_hi:[1,0]
    v_pk_mul_f32 v[218:219], v[218:219], s[50:51] op_sel_hi:[1,0]
    v_pk_mul_f32 v[220:221], v[220:221], s[50:51] op_sel_hi:[1,0]
    v_pk_mul_f32 v[222:223], v[222:223], s[50:51] op_sel_hi:[1,0]
    v_pk_mul_f32 v[224:225], v[224:225], s[50:51] op_sel_hi:[1,0]
    v_pk_mul_f32 v[226:227], v[226:227], s[50:51] op_sel_hi:[1,0]
    v_pk_mul_f32 v[228:229], v[228:229], s[50:51] op_sel_hi:[1,0]
    v_pk_mul_f32 v[230:231], v[230:231], s[50:51] op_sel_hi:[1,0]
    v_pk_mul_f32 v[232:233], v[232:233], s[50:51] op_sel_hi:[1,0]
    v_pk_mul_f32 v[234:235], v[234:235], s[50:51] op_sel_hi:[1,0]
    v_pk_mul_f32 v[236:237], v[236:237], s[50:51] op_sel_hi:[1,0]
    v_pk_mul_f32 v[238:239], v[238:239], s[50:51] op_sel_hi:[1,0]
    v_cvt_pk_bf16_f32 v0, v80, v81
    v_cvt_pk_bf16_f32 v1, v82, v83
    v_cvt_pk_bf16_f32 v2, v100, v101
    v_cvt_pk_bf16_f32 v3, v102, v103
    v_cvt_pk_bf16_f32 v4, v84, v85
    v_cvt_pk_bf16_f32 v5, v86, v87
    v_cvt_pk_bf16_f32 v6, v104, v105
    v_cvt_pk_bf16_f32 v7, v106, v107
    v_cvt_pk_bf16_f32 v8, v88, v89
    v_cvt_pk_bf16_f32 v9, v90, v91
    v_cvt_pk_bf16_f32 v10, v108, v109
    v_cvt_pk_bf16_f32 v11, v110, v111
    v_cvt_pk_bf16_f32 v12, v92, v93
    v_cvt_pk_bf16_f32 v13, v94, v95
    v_cvt_pk_bf16_f32 v14, v112, v113
    v_cvt_pk_bf16_f32 v15, v114, v115
    v_cvt_pk_bf16_f32 v16, v96, v97
    v_cvt_pk_bf16_f32 v17, v98, v99
    v_cvt_pk_bf16_f32 v18, v116, v117
    v_cvt_pk_bf16_f32 v19, v118, v119
    v_cvt_pk_bf16_f32 v20, v120, v121
    v_cvt_pk_bf16_f32 v21, v122, v123
    v_cvt_pk_bf16_f32 v22, v140, v141
    v_cvt_pk_bf16_f32 v23, v142, v143
    v_cvt_pk_bf16_f32 v24, v124, v125
    v_cvt_pk_bf16_f32 v25, v126, v127
    v_cvt_pk_bf16_f32 v26, v144, v145
    v_cvt_pk_bf16_f32 v27, v146, v147
    v_cvt_pk_bf16_f32 v28, v128, v129
    v_cvt_pk_bf16_f32 v29, v130, v131
    v_cvt_pk_bf16_f32 v30, v148, v149
    v_cvt_pk_bf16_f32 v31, v150, v151
    v_cvt_pk_bf16_f32 v32, v132, v133
    v_cvt_pk_bf16_f32 v33, v134, v135
    v_cvt_pk_bf16_f32 v34, v152, v153
    v_cvt_pk_bf16_f32 v35, v154, v155
    v_cvt_pk_bf16_f32 v36, v136, v137
    v_cvt_pk_bf16_f32 v37, v138, v139
    v_cvt_pk_bf16_f32 v38, v156, v157
    v_cvt_pk_bf16_f32 v39, v158, v159
    v_cvt_pk_bf16_f32 v40, v160, v161
    v_cvt_pk_bf16_f32 v41, v162, v163
    v_cvt_pk_bf16_f32 v42, v180, v181
    v_cvt_pk_bf16_f32 v43, v182, v183
    v_cvt_pk_bf16_f32 v44, v164, v165
    v_cvt_pk_bf16_f32 v45, v166, v167
    v_cvt_pk_bf16_f32 v46, v184, v185
    v_cvt_pk_bf16_f32 v47, v186, v187
    v_cvt_pk_bf16_f32 v48, v168, v169
    v_cvt_pk_bf16_f32 v49, v170, v171
    v_cvt_pk_bf16_f32 v50, v188, v189
    v_cvt_pk_bf16_f32 v51, v190, v191
    v_cvt_pk_bf16_f32 v52, v172, v173
    v_cvt_pk_bf16_f32 v53, v174, v175
    v_cvt_pk_bf16_f32 v54, v192, v193
    v_cvt_pk_bf16_f32 v55, v194, v195
    v_cvt_pk_bf16_f32 v56, v176, v177
    v_cvt_pk_bf16_f32 v57, v178, v179
    v_cvt_pk_bf16_f32 v58, v196, v197
    v_cvt_pk_bf16_f32 v59, v198, v199
    v_cvt_pk_bf16_f32 v60, v200, v201
    v_cvt_pk_bf16_f32 v61, v202, v203
    v_cvt_pk_bf16_f32 v62, v220, v221
    v_cvt_pk_bf16_f32 v63, v222, v223
    v_cvt_pk_bf16_f32 v64, v204, v205
    v_cvt_pk_bf16_f32 v65, v206, v207
    v_cvt_pk_bf16_f32 v66, v224, v225
    v_cvt_pk_bf16_f32 v67, v226, v227
    v_cvt_pk_bf16_f32 v68, v208, v209
    v_cvt_pk_bf16_f32 v69, v210, v211
    v_cvt_pk_bf16_f32 v70, v228, v229
    v_cvt_pk_bf16_f32 v71, v230, v231
    v_cvt_pk_bf16_f32 v72, v212, v213
    v_cvt_pk_bf16_f32 v73, v214, v215
    v_cvt_pk_bf16_f32 v74, v232, v233
    v_cvt_pk_bf16_f32 v75, v234, v235
    v_cvt_pk_bf16_f32 v76, v216, v217
    v_cvt_pk_bf16_f32 v77, v218, v219
    v_cvt_pk_bf16_f32 v78, v236, v237
    v_cvt_pk_bf16_f32 v79, v238, v239
    v_accvgpr_read_b32 v200, a216
    v_accvgpr_read_b32 v201, a217
    v_accvgpr_read_b32 v207, a218
    s_mov_b32 s40, s39
    s_add_u32 s41, s39, 0
    s_add_u32 s42, s93, 32768
    s_add_u32 s43, s93, 16384
    v_lshlrev_b32 v207, 4, v207
    v_mov_b32 v208, 0
    v_mov_b32 v209, 0
    v_mov_b32 v210, 0
    v_mov_b32 v211, 0
    v_mov_b32 v212, 0
    v_mov_b32 v213, 0
    v_mov_b32 v214, 0
    v_mov_b32 v215, 0
    v_mov_b32 v216, 0
    v_mov_b32 v217, 0
    v_mov_b32 v218, 0
    v_mov_b32 v219, 0
    v_mov_b32 v220, 0
    v_mov_b32 v221, 0
    v_mov_b32 v222, 0
    v_mov_b32 v223, 0
    v_mov_b32 v224, 0
    v_mov_b32 v225, 0
    v_mov_b32 v226, 0
    v_mov_b32 v227, 0
    s_cmp_eq_u32 s92, 0
    s_cbranch_scc0 L_maxpass_attn_kernel
L_maxdone_attn_kernel:
    s_waitcnt lgkmcnt(2)
    v_mfma_f32_16x16x32_bf16 v[80:83], a[184:187], v[0:3], v[208:211]
    ds_read_b128 a[196:199], v243 offset:0
    v_mfma_f32_16x16x32_bf16 v[84:87], a[184:187], v[4:7], v[212:215]
    ds_read_b128 a[200:203], v240 offset:4096
    v_mfma_f32_16x16x32_bf16 v[88:91], a[184:187], v[8:11], v[216:219]
    v_mfma_f32_16x16x32_bf16 v[92:95], a[184:187], v[12:15], v[220:223]
    v_mfma_f32_16x16x32_bf16 v[96:99], a[184:187], v[16:19], v[224:227]
    s_waitcnt lgkmcnt(3)
    v_mfma_f32_16x16x32_bf16 v[80:83], a[188:191], v[20:23], v[80:83]
    v_mfma_f32_16x16x32_bf16 v[84:87], a[188:191], v[24:27], v[84:87]
    v_mfma_f32_16x16x32_bf16 v[88:91], a[188:191], v[28:31], v[88:91]
    v_mfma_f32_16x16x32_bf16 v[92:95], a[188:191], v[32:35], v[92:95]
    v_mfma_f32_16x16x32_bf16 v[96:99], a[188:191], v[36:39], v[96:99]
    s_waitcnt lgkmcnt(2)
    v_mfma_f32_16x16x32_bf16 v[80:83], a[192:195], v[40:43], v[80:83]
    ds_read_b128 a[204:207], v241 offset:4096
    v_mfma_f32_16x16x32_bf16 v[84:87], a[192:195], v[44:47], v[84:87]
    ds_read_b128 a[208:211], v242 offset:4096
    v_mfma_f32_16x16x32_bf16 v[88:91], a[192:195], v[48:51], v[88:91]
    ds_read_b128 a[212:215], v243 offset:4096
    v_mfma_f32_16x16x32_bf16 v[92:95], a[192:195], v[52:55], v[92:95]
    v_mfma_f32_16x16x32_bf16 v[96:99], a[192:195], v[56:59], v[96:99]
    s_waitcnt lgkmcnt(4)
    v_mfma_f32_16x16x32_bf16 v[80:83], a[196:199], v[60:63], v[80:83]
    v_mfma_f32_16x16x32_bf16 v[84:87], a[196:199], v[64:67], v[84:87]
    v_mfma_f32_16x16x32_bf16 v[88:91], a[196:199], v[68:71], v[88:91]
    v_mfma_f32_16x16x32_bf16 v[92:95], a[196:199], v[72:75], v[92:95]
    v_mfma_f32_16x16x32_bf16 v[96:99], a[196:199], v[76:79], v[96:99]
    s_waitcnt lgkmcnt(3)
    v_mfma_f32_16x16x32_bf16 v[100:103], a[200:203], v[0:3], v[208:211]
    v_mfma_f32_16x16x32_bf16 v[104:107], a[200:203], v[4:7], v[212:215]
    v_mfma_f32_16x16x32_bf16 v[108:111], a[200:203], v[8:11], v[216:219]
    v_mfma_f32_16x16x32_bf16 v[112:115], a[200:203], v[12:15], v[220:223]
    v_mfma_f32_16x16x32_bf16 v[116:119], a[200:203], v[16:19], v[224:227]
    s_waitcnt lgkmcnt(2)
    v_mfma_f32_16x16x32_bf16 v[100:103], a[204:207], v[20:23], v[100:103]
    v_mfma_f32_16x16x32_bf16 v[104:107], a[204:207], v[24:27], v[104:107]
    v_mfma_f32_16x16x32_bf16 v[108:111], a[204:207], v[28:31], v[108:111]
    v_mfma_f32_16x16x32_bf16 v[112:115], a[204:207], v[32:35], v[112:115]
    v_mfma_f32_16x16x32_bf16 v[116:119], a[204:207], v[36:39], v[116:119]
    s_waitcnt lgkmcnt(0)
    s_barrier
    v_mfma_f32_16x16x32_bf16 v[100:103], a[208:211], v[40:43], v[100:103]
    ds_read_b128 a[184:187], v240 offset:16384
    v_mfma_f32_16x16x32_bf16 v[104:107], a[208:211], v[44:47], v[104:107]
    ds_read_b128 a[188:191], v241 offset:16384
    v_mfma_f32_16x16x32_bf16 v[108:111], a[208:211], v[48:51], v[108:111]
    ds_read_b128 a[192:195], v242 offset:16384
    v_mfma_f32_16x16x32_bf16 v[112:115], a[208:211], v[52:55], v[112:115]
    v_mfma_f32_16x16x32_bf16 v[116:119], a[208:211], v[56:59], v[116:119]
    v_mfma_f32_16x16x32_bf16 v[100:103], a[212:215], v[60:63], v[100:103]
    v_mfma_f32_16x16x32_bf16 v[104:107], a[212:215], v[64:67], v[104:107]
    v_mfma_f32_16x16x32_bf16 v[108:111], a[212:215], v[68:71], v[108:111]
    v_mfma_f32_16x16x32_bf16 v[112:115], a[212:215], v[72:75], v[112:115]
    v_mfma_f32_16x16x32_bf16 v[116:119], a[212:215], v[76:79], v[116:119]
    s_waitcnt lgkmcnt(2)
    v_mfma_f32_16x16x32_bf16 v[120:123], a[184:187], v[0:3], v[208:211]
    s_mov_b32 m0, s40
    v_exp_f32 v80, v80
    v_mfma_f32_16x16x32_bf16 v[124:127], a[184:187], v[4:7], v[212:215]
    s_add_u32 s40, s40, 16384
    buffer_load_dwordx4 v252, s[16:19], s42 offen offset:0 nt lds
    v_mfma_f32_16x16x32_bf16 v[128:131], a[184:187], v[8:11], v[216:219]
    v_exp_f32 v81, v81
    v_mfma_f32_16x16x32_bf16 v[132:135], a[184:187], v[12:15], v[220:223]
    v_exp_f32 v82, v82
    v_mfma_f32_16x16x32_bf16 v[136:139], a[184:187], v[16:19], v[224:227]
    s_waitcnt lgkmcnt(1)
    ds_read_b128 a[196:199], v243 offset:16384
    v_cvt_pk_bf16_f32 v160, v80, v81
    v_mfma_f32_16x16x32_bf16 v[120:123], a[188:191], v[20:23], v[120:123]
    v_exp_f32 v83, v83
    v_mfma_f32_16x16x32_bf16 v[124:127], a[188:191], v[24:27], v[124:127]
    v_exp_f32 v100, v100
    v_mfma_f32_16x16x32_bf16 v[128:131], a[188:191], v[28:31], v[128:131]
    ds_read_b128 a[200:203], v240 offset:20480
    v_cvt_pk_bf16_f32 v161, v82, v83
    v_mfma_f32_16x16x32_bf16 v[132:135], a[188:191], v[32:35], v[132:135]
    buffer_load_dwordx4 v253, s[16:19], s42 offen offset:1024 nt lds
    v_mfma_f32_16x16x32_bf16 v[136:139], a[188:191], v[36:39], v[136:139]
    s_waitcnt lgkmcnt(2)
    v_exp_f32 v101, v101
    v_mfma_f32_16x16x32_bf16 v[120:123], a[192:195], v[40:43], v[120:123]
    v_exp_f32 v102, v102
    v_mfma_f32_16x16x32_bf16 v[124:127], a[192:195], v[44:47], v[124:127]
    ds_read_b128 a[204:207], v241 offset:20480
    v_cvt_pk_bf16_f32 v162, v100, v101
    v_mfma_f32_16x16x32_bf16 v[128:131], a[192:195], v[48:51], v[128:131]
    v_exp_f32 v103, v103
    v_mfma_f32_16x16x32_bf16 v[132:135], a[192:195], v[52:55], v[132:135]
    v_exp_f32 v84, v84
    v_mfma_f32_16x16x32_bf16 v[136:139], a[192:195], v[56:59], v[136:139]
    s_waitcnt lgkmcnt(2)
    ds_read_b128 a[208:211], v242 offset:20480
    v_cvt_pk_bf16_f32 v163, v102, v103
    v_mfma_f32_16x16x32_bf16 v[120:123], a[196:199], v[60:63], v[120:123]
    buffer_load_dwordx4 v254, s[16:19], s42 offen offset:2048 nt lds
    v_mfma_f32_16x16x32_bf16 v[124:127], a[196:199], v[64:67], v[124:127]
    v_exp_f32 v85, v85
    v_mfma_f32_16x16x32_bf16 v[128:131], a[196:199], v[68:71], v[128:131]
    v_exp_f32 v86, v86
    v_mfma_f32_16x16x32_bf16 v[132:135], a[196:199], v[72:75], v[132:135]
    ds_read_b128 a[212:215], v243 offset:20480
    v_cvt_pk_bf16_f32 v164, v84, v85
    v_mfma_f32_16x16x32_bf16 v[136:139], a[196:199], v[76:79], v[136:139]
    s_waitcnt lgkmcnt(3)
    v_exp_f32 v87, v87
    v_mfma_f32_16x16x32_bf16 v[140:143], a[200:203], v[0:3], v[208:211]
    v_exp_f32 v104, v104
    v_mfma_f32_16x16x32_bf16 v[144:147], a[200:203], v[4:7], v[212:215]
    v_cvt_pk_bf16_f32 v165, v86, v87
    v_mfma_f32_16x16x32_bf16 v[148:151], a[200:203], v[8:11], v[216:219]
    v_exp_f32 v105, v105
    v_mfma_f32_16x16x32_bf16 v[152:155], a[200:203], v[12:15], v[220:223]
    buffer_load_dwordx4 v255, s[16:19], s42 offen offset:3072 nt lds
    v_mfma_f32_16x16x32_bf16 v[156:159], a[200:203], v[16:19], v[224:227]
    s_waitcnt lgkmcnt(2)
    v_exp_f32 v106, v106
    v_mfma_f32_16x16x32_bf16 v[140:143], a[204:207], v[20:23], v[140:143]
    s_and_b32 s40, s40, 0xffff
    s_add_u32 s42, s42, 8192
    v_cvt_pk_bf16_f32 v166, v104, v105
    v_mfma_f32_16x16x32_bf16 v[144:147], a[204:207], v[24:27], v[144:147]
    s_add_u32 m0, s41, 98304
    v_exp_f32 v107, v107
    v_mfma_f32_16x16x32_bf16 v[148:151], a[204:207], v[28:31], v[148:151]
    s_add_u32 s41, s41, 16384
    v_exp_f32 v88, v88
    v_mfma_f32_16x16x32_bf16 v[152:155], a[204:207], v[32:35], v[152:155]
    v_cvt_pk_bf16_f32 v167, v106, v107
    v_mfma_f32_16x16x32_bf16 v[156:159], a[204:207], v[36:39], v[156:159]
    v_exp_f32 v89, v89
    s_waitcnt lgkmcnt(0)
    s_waitcnt vmcnt(8)
    s_barrier
    v_mfma_f32_16x16x32_bf16 v[140:143], a[208:211], v[40:43], v[140:143]
    v_exp_f32 v90, v90
    v_mfma_f32_16x16x32_bf16 v[144:147], a[208:211], v[44:47], v[144:147]
    buffer_load_dwordx4 v200, s[20:23], s43 offen offset:0 nt lds
    v_mfma_f32_16x16x32_bf16 v[148:151], a[208:211], v[48:51], v[148:151]
    v_xor_b32 v240, 0x8000, v240
    v_mfma_f32_16x16x32_bf16 v[152:155], a[208:211], v[52:55], v[152:155]
    v_xor_b32 v241, 0x8000, v241
    v_mfma_f32_16x16x32_bf16 v[156:159], a[208:211], v[56:59], v[156:159]
    v_xor_b32 v242, 0x8000, v242
    v_mfma_f32_16x16x32_bf16 v[140:143], a[212:215], v[60:63], v[140:143]
    v_xor_b32 v243, 0x8000, v243
    v_mfma_f32_16x16x32_bf16 v[144:147], a[212:215], v[64:67], v[144:147]
    ds_read_b128 a[184:187], v240 offset:0
    v_cvt_pk_bf16_f32 v168, v88, v89
    v_mfma_f32_16x16x32_bf16 v[148:151], a[212:215], v[68:71], v[148:151]
    ds_read_b128 a[188:191], v241 offset:0
    v_mfma_f32_16x16x32_bf16 v[152:155], a[212:215], v[72:75], v[152:155]
    ds_read_b128 a[192:195], v242 offset:0
    v_mfma_f32_16x16x32_bf16 v[156:159], a[212:215], v[76:79], v[156:159]
    buffer_load_dwordx4 v201, s[20:23], s43 offen offset:1024 nt lds
    buffer_load_dwordx4 v200, s[20:23], s43 offen offset:2048 nt lds
    buffer_load_dwordx4 v201, s[20:23], s43 offen offset:3072 nt lds
    s_and_b32 s41, s41, 0xffff
    s_add_u32 s43, s43, 8192
    v_exp_f32 v91, v91
    v_exp_f32 v108, v108
    v_cvt_pk_bf16_f32 v169, v90, v91
    v_exp_f32 v109, v109
    v_exp_f32 v110, v110
    v_cvt_pk_bf16_f32 v170, v108, v109
    v_exp_f32 v111, v111
    v_exp_f32 v92, v92
    v_cvt_pk_bf16_f32 v171, v110, v111
    v_exp_f32 v93, v93
    v_exp_f32 v94, v94
    v_cvt_pk_bf16_f32 v172, v92, v93
    v_exp_f32 v95, v95
    v_exp_f32 v112, v112
    v_cvt_pk_bf16_f32 v173, v94, v95
    v_exp_f32 v113, v113
    v_exp_f32 v114, v114
    v_cvt_pk_bf16_f32 v174, v112, v113
    v_exp_f32 v115, v115
    v_exp_f32 v96, v96
    v_cvt_pk_bf16_f32 v175, v114, v115
    v_exp_f32 v97, v97
    v_exp_f32 v98, v98
    v_cvt_pk_bf16_f32 v176, v96, v97
    v_exp_f32 v99, v99
    v_exp_f32 v116, v116
    v_cvt_pk_bf16_f32 v177, v98, v99
    v_exp_f32 v117, v117
    v_exp_f32 v118, v118
    v_cvt_pk_bf16_f32 v178, v116, v117
    v_exp_f32 v119, v119
    s_nop 0
    v_cvt_pk_bf16_f32 v179, v118, v119
    s_waitcnt lgkmcnt(2)
    v_mfma_f32_16x16x32_bf16 v[80:83], a[184:187], v[0:3], v[208:211]
    s_mov_b32 m0, s40
    v_exp_f32 v120, v120
    v_mfma_f32_16x16x32_bf16 v[84:87], a[184:187], v[4:7], v[212:215]
    s_add_u32 s40, s40, 16384
    buffer_load_dwordx4 v252, s[16:19], s42 offen offset:0 nt lds
    v_mfma_f32_16x16x32_bf16 v[88:91], a[184:187], v[8:11], v[216:219]
    v_exp_f32 v121, v121
    v_mfma_f32_16x16x32_bf16 v[92:95], a[184:187], v[12:15], v[220:223]
    v_exp_f32 v122, v122
    v_mfma_f32_16x16x32_bf16 v[96:99], a[184:187], v[16:19], v[224:227]
    s_waitcnt lgkmcnt(1)
    ds_read_b128 a[196:199], v243 offset:0
    v_cvt_pk_bf16_f32 v180, v120, v121
    v_mfma_f32_16x16x32_bf16 v[80:83], a[188:191], v[20:23], v[80:83]
    v_exp_f32 v123, v123
    v_mfma_f32_16x16x32_bf16 v[84:87], a[188:191], v[24:27], v[84:87]
    v_exp_f32 v140, v140
    v_mfma_f32_16x16x32_bf16 v[88:91], a[188:191], v[28:31], v[88:91]
    ds_read_b128 a[200:203], v240 offset:4096
    v_cvt_pk_bf16_f32 v181, v122, v123
    v_mfma_f32_16x16x32_bf16 v[92:95], a[188:191], v[32:35], v[92:95]
    buffer_load_dwordx4 v253, s[16:19], s42 offen offset:1024 nt lds
    v_mfma_f32_16x16x32_bf16 v[96:99], a[188:191], v[36:39], v[96:99]
    s_waitcnt lgkmcnt(2)
    v_exp_f32 v141, v141
    v_mfma_f32_16x16x32_bf16 v[80:83], a[192:195], v[40:43], v[80:83]
    v_exp_f32 v142, v142
    v_mfma_f32_16x16x32_bf16 v[84:87], a[192:195], v[44:47], v[84:87]
    ds_read_b128 a[204:207], v241 offset:4096
    v_cvt_pk_bf16_f32 v182, v140, v141
    v_mfma_f32_16x16x32_bf16 v[88:91], a[192:195], v[48:51], v[88:91]
    v_exp_f32 v143, v143
    v_mfma_f32_16x16x32_bf16 v[92:95], a[192:195], v[52:55], v[92:95]
    v_exp_f32 v124, v124
    v_mfma_f32_16x16x32_bf16 v[96:99], a[192:195], v[56:59], v[96:99]
    s_waitcnt lgkmcnt(2)
    ds_read_b128 a[208:211], v242 offset:4096
    v_cvt_pk_bf16_f32 v183, v142, v143
    v_mfma_f32_16x16x32_bf16 v[80:83], a[196:199], v[60:63], v[80:83]
    buffer_load_dwordx4 v254, s[16:19], s42 offen offset:2048 nt lds
    v_mfma_f32_16x16x32_bf16 v[84:87], a[196:199], v[64:67], v[84:87]
    v_exp_f32 v125, v125
    v_mfma_f32_16x16x32_bf16 v[88:91], a[196:199], v[68:71], v[88:91]
    v_exp_f32 v126, v126
    v_mfma_f32_16x16x32_bf16 v[92:95], a[196:199], v[72:75], v[92:95]
    ds_read_b128 a[212:215], v243 offset:4096
    v_cvt_pk_bf16_f32 v184, v124, v125
    v_mfma_f32_16x16x32_bf16 v[96:99], a[196:199], v[76:79], v[96:99]
    s_waitcnt lgkmcnt(3)
    v_exp_f32 v127, v127
    v_mfma_f32_16x16x32_bf16 v[100:103], a[200:203], v[0:3], v[208:211]
    v_exp_f32 v144, v144
    v_mfma_f32_16x16x32_bf16 v[104:107], a[200:203], v[4:7], v[212:215]
    ds_read_b64_tr_b16 a[184:185], v244 offset:0
    v_cvt_pk_bf16_f32 v185, v126, v127
    v_mfma_f32_16x16x32_bf16 v[108:111], a[200:203], v[8:11], v[216:219]
    v_exp_f32 v145, v145
    v_mfma_f32_16x16x32_bf16 v[112:115], a[200:203], v[12:15], v[220:223]
    buffer_load_dwordx4 v255, s[16:19], s42 offen offset:3072 nt lds
    v_mfma_f32_16x16x32_bf16 v[116:119], a[200:203], v[16:19], v[224:227]
    s_waitcnt lgkmcnt(3)
    v_exp_f32 v146, v146
    v_mfma_f32_16x16x32_bf16 v[100:103], a[204:207], v[20:23], v[100:103]
    s_and_b32 s40, s40, 0xffff
    ds_read_b64_tr_b16 a[186:187], v244 offset:4096
    v_cvt_pk_bf16_f32 v186, v144, v145
    v_mfma_f32_16x16x32_bf16 v[104:107], a[204:207], v[24:27], v[104:107]
    s_add_u32 s42, s42, 8192
    v_exp_f32 v147, v147
    v_mfma_f32_16x16x32_bf16 v[108:111], a[204:207], v[28:31], v[108:111]
    s_add_u32 m0, s41, 98304
    v_exp_f32 v128, v128
    v_mfma_f32_16x16x32_bf16 v[112:115], a[204:207], v[32:35], v[112:115]
    s_add_u32 s41, s41, 16384
    ds_read_b64_tr_b16 a[188:189], v245 offset:0
    v_cvt_pk_bf16_f32 v187, v146, v147
    v_mfma_f32_16x16x32_bf16 v[116:119], a[204:207], v[36:39], v[116:119]
    s_waitcnt lgkmcnt(4)
    v_exp_f32 v129, v129
    v_mfma_f32_16x16x32_bf16 v[100:103], a[208:211], v[40:43], v[100:103]
    v_exp_f32 v130, v130
    v_mfma_f32_16x16x32_bf16 v[104:107], a[208:211], v[44:47], v[104:107]
    ds_read_b64_tr_b16 a[190:191], v245 offset:4096
    v_cvt_pk_bf16_f32 v188, v128, v129
    v_mfma_f32_16x16x32_bf16 v[108:111], a[208:211], v[48:51], v[108:111]
    buffer_load_dwordx4 v200, s[20:23], s43 offen offset:0 nt lds
    v_mfma_f32_16x16x32_bf16 v[112:115], a[208:211], v[52:55], v[112:115]
    v_exp_f32 v131, v131
    v_mfma_f32_16x16x32_bf16 v[116:119], a[208:211], v[56:59], v[116:119]
    s_waitcnt lgkmcnt(4)
    v_exp_f32 v148, v148
    v_mfma_f32_16x16x32_bf16 v[100:103], a[212:215], v[60:63], v[100:103]
    ds_read_b64_tr_b16 a[192:193], v246 offset:0
    v_cvt_pk_bf16_f32 v189, v130, v131
    v_mfma_f32_16x16x32_bf16 v[104:107], a[212:215], v[64:67], v[104:107]
    v_exp_f32 v149, v149
    v_mfma_f32_16x16x32_bf16 v[108:111], a[212:215], v[68:71], v[108:111]
    v_exp_f32 v150, v150
    v_mfma_f32_16x16x32_bf16 v[112:115], a[212:215], v[72:75], v[112:115]
    ds_read_b64_tr_b16 a[194:195], v246 offset:4096
    v_cvt_pk_bf16_f32 v190, v148, v149
    v_mfma_f32_16x16x32_bf16 v[116:119], a[212:215], v[76:79], v[116:119]
    buffer_load_dwordx4 v201, s[20:23], s43 offen offset:1024 nt lds
    v_mfma_f32_16x16x32_bf16 a[160:163], a[180:183], v[160:163], 0
    v_exp_f32 v151, v151
    v_mfma_f32_16x16x32_bf16 a[164:167], a[180:183], v[164:167], 0
    v_exp_f32 v132, v132
    v_mfma_f32_16x16x32_bf16 a[168:171], a[180:183], v[168:171], 0
    ds_read_b64_tr_b16 a[196:197], v247 offset:0
    v_cvt_pk_bf16_f32 v191, v150, v151
    v_mfma_f32_16x16x32_bf16 a[172:175], a[180:183], v[172:175], 0
    v_exp_f32 v133, v133
    v_mfma_f32_16x16x32_bf16 a[176:179], a[180:183], v[176:179], 0
    s_waitcnt lgkmcnt(5)
    v_exp_f32 v134, v134
    v_mfma_f32_16x16x32_bf16 a[0:3], a[184:187], v[160:163], 0
    ds_read_b64_tr_b16 a[198:199], v247 offset:4096
    v_cvt_pk_bf16_f32 v192, v132, v133
    v_mfma_f32_16x16x32_bf16 a[4:7], a[184:187], v[164:167], 0
    v_exp_f32 v135, v135
    v_mfma_f32_16x16x32_bf16 a[8:11], a[184:187], v[168:171], 0
    buffer_load_dwordx4 v200, s[20:23], s43 offen offset:2048 nt lds
    v_mfma_f32_16x16x32_bf16 a[12:15], a[184:187], v[172:175], 0
    v_exp_f32 v152, v152
    v_mfma_f32_16x16x32_bf16 a[16:19], a[184:187], v[176:179], 0
    s_waitcnt lgkmcnt(4)
    ds_read_b64_tr_b16 a[200:201], v248 offset:0
    v_cvt_pk_bf16_f32 v193, v134, v135
    v_mfma_f32_16x16x32_bf16 a[20:23], a[188:191], v[160:163], 0
    v_exp_f32 v153, v153
    v_mfma_f32_16x16x32_bf16 a[24:27], a[188:191], v[164:167], 0
    v_exp_f32 v154, v154
    v_mfma_f32_16x16x32_bf16 a[28:31], a[188:191], v[168:171], 0
    ds_read_b64_tr_b16 a[202:203], v248 offset:4096
    v_cvt_pk_bf16_f32 v194, v152, v153
    v_mfma_f32_16x16x32_bf16 a[32:35], a[188:191], v[172:175], 0
    v_exp_f32 v155, v155
    v_mfma_f32_16x16x32_bf16 a[36:39], a[188:191], v[176:179], 0
    s_waitcnt lgkmcnt(4)
    v_exp_f32 v136, v136
    v_mfma_f32_16x16x32_bf16 a[40:43], a[192:195], v[160:163], 0
    ds_read_b64_tr_b16 a[204:205], v249 offset:0
    v_cvt_pk_bf16_f32 v195, v154, v155
    v_mfma_f32_16x16x32_bf16 a[44:47], a[192:195], v[164:167], 0
    buffer_load_dwordx4 v201, s[20:23], s43 offen offset:3072 nt lds
    v_mfma_f32_16x16x32_bf16 a[48:51], a[192:195], v[168:171], 0
    s_and_b32 s41, s41, 0xffff
    v_exp_f32 v137, v137
    v_mfma_f32_16x16x32_bf16 a[52:55], a[192:195], v[172:175], 0
    s_add_u32 s43, s43, 8192
    v_exp_f32 v138, v138
    v_mfma_f32_16x16x32_bf16 a[56:59], a[192:195], v[176:179], 0
    s_waitcnt lgkmcnt(3)
    ds_read_b64_tr_b16 a[206:207], v249 offset:4096
    v_cvt_pk_bf16_f32 v196, v136, v137
    v_mfma_f32_16x16x32_bf16 a[60:63], a[196:199], v[160:163], 0
    v_exp_f32 v139, v139
    v_mfma_f32_16x16x32_bf16 a[64:67], a[196:199], v[164:167], 0
    v_exp_f32 v156, v156
    v_mfma_f32_16x16x32_bf16 a[68:71], a[196:199], v[168:171], 0
    ds_read_b64_tr_b16 a[208:209], v250 offset:0
    v_cvt_pk_bf16_f32 v197, v138, v139
    v_mfma_f32_16x16x32_bf16 a[72:75], a[196:199], v[172:175], 0
    v_exp_f32 v157, v157
    v_mfma_f32_16x16x32_bf16 a[76:79], a[196:199], v[176:179], 0
    s_waitcnt lgkmcnt(3)
    v_exp_f32 v158, v158
    v_mfma_f32_16x16x32_bf16 a[80:83], a[200:203], v[160:163], 0
    ds_read_b64_tr_b16 a[210:211], v250 offset:4096
    v_cvt_pk_bf16_f32 v198, v156, v157
    v_mfma_f32_16x16x32_bf16 a[84:87], a[200:203], v[164:167], 0
    v_exp_f32 v159, v159
    v_mfma_f32_16x16x32_bf16 a[88:91], a[200:203], v[168:171], 0
    s_nop 0
    ds_read_b64_tr_b16 a[212:213], v251 offset:0
    v_cvt_pk_bf16_f32 v199, v158, v159
    v_mfma_f32_16x16x32_bf16 a[92:95], a[200:203], v[172:175], 0
    ds_read_b64_tr_b16 a[214:215], v251 offset:4096
    v_mfma_f32_16x16x32_bf16 a[96:99], a[200:203], v[176:179], 0
    s_waitcnt lgkmcnt(4)
    v_mfma_f32_16x16x32_bf16 a[100:103], a[204:207], v[160:163], 0
    v_mfma_f32_16x16x32_bf16 a[104:107], a[204:207], v[164:167], 0
    v_mfma_f32_16x16x32_bf16 a[108:111], a[204:207], v[168:171], 0
    v_mfma_f32_16x16x32_bf16 a[112:115], a[204:207], v[172:175], 0
    v_mfma_f32_16x16x32_bf16 a[116:119], a[204:207], v[176:179], 0
    s_waitcnt lgkmcnt(0)
    s_waitcnt vmcnt(16)
    s_barrier
    v_mfma_f32_16x16x32_bf16 a[120:123], a[208:211], v[160:163], 0
    ds_read_b128 a[184:187], v240 offset:16384
    v_mfma_f32_16x16x32_bf16 a[124:127], a[208:211], v[164:167], 0
    ds_read_b128 a[188:191], v241 offset:16384
    v_mfma_f32_16x16x32_bf16 a[128:131], a[208:211], v[168:171], 0
    ds_read_b128 a[192:195], v242 offset:16384
    v_mfma_f32_16x16x32_bf16 a[132:135], a[208:211], v[172:175], 0
    v_mfma_f32_16x16x32_bf16 a[136:139], a[208:211], v[176:179], 0
    v_mfma_f32_16x16x32_bf16 a[140:143], a[212:215], v[160:163], 0
    v_mfma_f32_16x16x32_bf16 a[144:147], a[212:215], v[164:167], 0
    v_mfma_f32_16x16x32_bf16 a[148:151], a[212:215], v[168:171], 0
    v_mfma_f32_16x16x32_bf16 a[152:155], a[212:215], v[172:175], 0
    v_mfma_f32_16x16x32_bf16 a[156:159], a[212:215], v[176:179], 0
    s_waitcnt lgkmcnt(2)
    v_mfma_f32_16x16x32_bf16 v[120:123], a[184:187], v[0:3], v[208:211]
    s_mov_b32 m0, s40
    v_exp_f32 v80, v80
    v_mfma_f32_16x16x32_bf16 v[124:127], a[184:187], v[4:7], v[212:215]
    s_add_u32 s40, s40, 16384
    buffer_load_dwordx4 v252, s[16:19], s42 offen offset:0 nt lds
    v_mfma_f32_16x16x32_bf16 v[128:131], a[184:187], v[8:11], v[216:219]
    v_exp_f32 v81, v81
    v_mfma_f32_16x16x32_bf16 v[132:135], a[184:187], v[12:15], v[220:223]
    v_exp_f32 v82, v82
    v_mfma_f32_16x16x32_bf16 v[136:139], a[184:187], v[16:19], v[224:227]
    s_waitcnt lgkmcnt(1)
    ds_read_b128 a[196:199], v243 offset:16384
    v_cvt_pk_bf16_f32 v160, v80, v81
    v_mfma_f32_16x16x32_bf16 v[120:123], a[188:191], v[20:23], v[120:123]
    v_exp_f32 v83, v83
    v_mfma_f32_16x16x32_bf16 v[124:127], a[188:191], v[24:27], v[124:127]
    v_exp_f32 v100, v100
    v_mfma_f32_16x16x32_bf16 v[128:131], a[188:191], v[28:31], v[128:131]
    ds_read_b128 a[200:203], v240 offset:20480
    v_cvt_pk_bf16_f32 v161, v82, v83
    v_mfma_f32_16x16x32_bf16 v[132:135], a[188:191], v[32:35], v[132:135]
    buffer_load_dwordx4 v253, s[16:19], s42 offen offset:1024 nt lds
    v_mfma_f32_16x16x32_bf16 v[136:139], a[188:191], v[36:39], v[136:139]
    s_waitcnt lgkmcnt(2)
    v_exp_f32 v101, v101
    v_mfma_f32_16x16x32_bf16 v[120:123], a[192:195], v[40:43], v[120:123]
    v_exp_f32 v102, v102
    v_mfma_f32_16x16x32_bf16 v[124:127], a[192:195], v[44:47], v[124:127]
    ds_read_b128 a[204:207], v241 offset:20480
    v_cvt_pk_bf16_f32 v162, v100, v101
    v_mfma_f32_16x16x32_bf16 v[128:131], a[192:195], v[48:51], v[128:131]
    v_exp_f32 v103, v103
    v_mfma_f32_16x16x32_bf16 v[132:135], a[192:195], v[52:55], v[132:135]
    v_exp_f32 v84, v84
    v_mfma_f32_16x16x32_bf16 v[136:139], a[192:195], v[56:59], v[136:139]
    s_waitcnt lgkmcnt(2)
    ds_read_b128 a[208:211], v242 offset:20480
    v_cvt_pk_bf16_f32 v163, v102, v103
    v_mfma_f32_16x16x32_bf16 v[120:123], a[196:199], v[60:63], v[120:123]
    buffer_load_dwordx4 v254, s[16:19], s42 offen offset:2048 nt lds
    v_mfma_f32_16x16x32_bf16 v[124:127], a[196:199], v[64:67], v[124:127]
    v_exp_f32 v85, v85
    v_mfma_f32_16x16x32_bf16 v[128:131], a[196:199], v[68:71], v[128:131]
    v_exp_f32 v86, v86
    v_mfma_f32_16x16x32_bf16 v[132:135], a[196:199], v[72:75], v[132:135]
    ds_read_b128 a[212:215], v243 offset:20480
    v_cvt_pk_bf16_f32 v164, v84, v85
    v_mfma_f32_16x16x32_bf16 v[136:139], a[196:199], v[76:79], v[136:139]
    s_waitcnt lgkmcnt(3)
    v_exp_f32 v87, v87
    v_mfma_f32_16x16x32_bf16 v[140:143], a[200:203], v[0:3], v[208:211]
    v_exp_f32 v104, v104
    v_mfma_f32_16x16x32_bf16 v[144:147], a[200:203], v[4:7], v[212:215]
    ds_read_b64_tr_b16 a[184:185], v244 offset:16384
    v_cvt_pk_bf16_f32 v165, v86, v87
    v_mfma_f32_16x16x32_bf16 v[148:151], a[200:203], v[8:11], v[216:219]
    v_exp_f32 v105, v105
    v_mfma_f32_16x16x32_bf16 v[152:155], a[200:203], v[12:15], v[220:223]
    buffer_load_dwordx4 v255, s[16:19], s42 offen offset:3072 nt lds
    v_mfma_f32_16x16x32_bf16 v[156:159], a[200:203], v[16:19], v[224:227]
    s_waitcnt lgkmcnt(3)
    v_exp_f32 v106, v106
    v_mfma_f32_16x16x32_bf16 v[140:143], a[204:207], v[20:23], v[140:143]
    s_and_b32 s40, s40, 0xffff
    ds_read_b64_tr_b16 a[186:187], v244 offset:20480
    v_cvt_pk_bf16_f32 v166, v104, v105
    v_mfma_f32_16x16x32_bf16 v[144:147], a[204:207], v[24:27], v[144:147]
    s_add_u32 s42, s42, 8192
    v_exp_f32 v107, v107
    v_mfma_f32_16x16x32_bf16 v[148:151], a[204:207], v[28:31], v[148:151]
    s_add_u32 m0, s41, 98304
    v_exp_f32 v88, v88
    v_mfma_f32_16x16x32_bf16 v[152:155], a[204:207], v[32:35], v[152:155]
    s_add_u32 s41, s41, 16384
    ds_read_b64_tr_b16 a[188:189], v245 offset:16384
    v_cvt_pk_bf16_f32 v167, v106, v107
    v_mfma_f32_16x16x32_bf16 v[156:159], a[204:207], v[36:39], v[156:159]
    s_waitcnt lgkmcnt(4)
    v_exp_f32 v89, v89
    v_mfma_f32_16x16x32_bf16 v[140:143], a[208:211], v[40:43], v[140:143]
    v_exp_f32 v90, v90
    v_mfma_f32_16x16x32_bf16 v[144:147], a[208:211], v[44:47], v[144:147]
    ds_read_b64_tr_b16 a[190:191], v245 offset:20480
    v_cvt_pk_bf16_f32 v168, v88, v89
    v_mfma_f32_16x16x32_bf16 v[148:151], a[208:211], v[48:51], v[148:151]
    buffer_load_dwordx4 v200, s[20:23], s43 offen offset:0 nt lds
    v_mfma_f32_16x16x32_bf16 v[152:155], a[208:211], v[52:55], v[152:155]
    v_exp_f32 v91, v91
    v_mfma_f32_16x16x32_bf16 v[156:159], a[208:211], v[56:59], v[156:159]
    s_waitcnt lgkmcnt(4)
    v_exp_f32 v108, v108
    v_mfma_f32_16x16x32_bf16 v[140:143], a[212:215], v[60:63], v[140:143]
    ds_read_b64_tr_b16 a[192:193], v246 offset:16384
    v_cvt_pk_bf16_f32 v169, v90, v91
    v_mfma_f32_16x16x32_bf16 v[144:147], a[212:215], v[64:67], v[144:147]
    v_exp_f32 v109, v109
    v_mfma_f32_16x16x32_bf16 v[148:151], a[212:215], v[68:71], v[148:151]
    v_exp_f32 v110, v110
    v_mfma_f32_16x16x32_bf16 v[152:155], a[212:215], v[72:75], v[152:155]
    ds_read_b64_tr_b16 a[194:195], v246 offset:20480
    v_cvt_pk_bf16_f32 v170, v108, v109
    v_mfma_f32_16x16x32_bf16 v[156:159], a[212:215], v[76:79], v[156:159]
    buffer_load_dwordx4 v201, s[20:23], s43 offen offset:1024 nt lds
    v_mfma_f32_16x16x32_bf16 a[160:163], a[180:183], v[180:183], a[160:163]
    v_exp_f32 v111, v111
    v_mfma_f32_16x16x32_bf16 a[164:167], a[180:183], v[184:187], a[164:167]
    v_exp_f32 v92, v92
    v_mfma_f32_16x16x32_bf16 a[168:171], a[180:183], v[188:191], a[168:171]
    ds_read_b64_tr_b16 a[196:197], v247 offset:16384
    v_cvt_pk_bf16_f32 v171, v110, v111
    v_mfma_f32_16x16x32_bf16 a[172:175], a[180:183], v[192:195], a[172:175]
    v_exp_f32 v93, v93
    v_mfma_f32_16x16x32_bf16 a[176:179], a[180:183], v[196:199], a[176:179]
    s_waitcnt lgkmcnt(5)
    v_exp_f32 v94, v94
    v_mfma_f32_16x16x32_bf16 a[0:3], a[184:187], v[180:183], a[0:3]
    ds_read_b64_tr_b16 a[198:199], v247 offset:20480
    v_cvt_pk_bf16_f32 v172, v92, v93
    v_mfma_f32_16x16x32_bf16 a[4:7], a[184:187], v[184:187], a[4:7]
    v_exp_f32 v95, v95
    v_mfma_f32_16x16x32_bf16 a[8:11], a[184:187], v[188:191], a[8:11]
    buffer_load_dwordx4 v200, s[20:23], s43 offen offset:2048 nt lds
    v_mfma_f32_16x16x32_bf16 a[12:15], a[184:187], v[192:195], a[12:15]
    v_exp_f32 v112, v112
    v_mfma_f32_16x16x32_bf16 a[16:19], a[184:187], v[196:199], a[16:19]
    s_waitcnt lgkmcnt(4)
    ds_read_b64_tr_b16 a[200:201], v248 offset:16384
    v_cvt_pk_bf16_f32 v173, v94, v95
    v_mfma_f32_16x16x32_bf16 a[20:23], a[188:191], v[180:183], a[20:23]
    v_exp_f32 v113, v113
    v_mfma_f32_16x16x32_bf16 a[24:27], a[188:191], v[184:187], a[24:27]
    v_exp_f32 v114, v114
    v_mfma_f32_16x16x32_bf16 a[28:31], a[188:191], v[188:191], a[28:31]
    ds_read_b64_tr_b16 a[202:203], v248 offset:20480
    v_cvt_pk_bf16_f32 v174, v112, v113
    v_mfma_f32_16x16x32_bf16 a[32:35], a[188:191], v[192:195], a[32:35]
    v_exp_f32 v115, v115
    v_mfma_f32_16x16x32_bf16 a[36:39], a[188:191], v[196:199], a[36:39]
    s_waitcnt lgkmcnt(4)
    v_exp_f32 v96, v96
    v_mfma_f32_16x16x32_bf16 a[40:43], a[192:195], v[180:183], a[40:43]
    ds_read_b64_tr_b16 a[204:205], v249 offset:16384
    v_cvt_pk_bf16_f32 v175, v114, v115
    v_mfma_f32_16x16x32_bf16 a[44:47], a[192:195], v[184:187], a[44:47]
    buffer_load_dwordx4 v201, s[20:23], s43 offen offset:3072 nt lds
    v_mfma_f32_16x16x32_bf16 a[48:51], a[192:195], v[188:191], a[48:51]
    s_and_b32 s41, s41, 0xffff
    v_exp_f32 v97, v97
    v_mfma_f32_16x16x32_bf16 a[52:55], a[192:195], v[192:195], a[52:55]
    s_add_u32 s43, s43, 8192
    v_exp_f32 v98, v98
    v_mfma_f32_16x16x32_bf16 a[56:59], a[192:195], v[196:199], a[56:59]
    s_waitcnt lgkmcnt(3)
    ds_read_b64_tr_b16 a[206:207], v249 offset:20480
    v_cvt_pk_bf16_f32 v176, v96, v97
    v_mfma_f32_16x16x32_bf16 a[60:63], a[196:199], v[180:183], a[60:63]
    v_exp_f32 v99, v99
    v_mfma_f32_16x16x32_bf16 a[64:67], a[196:199], v[184:187], a[64:67]
    v_exp_f32 v116, v116
    v_mfma_f32_16x16x32_bf16 a[68:71], a[196:199], v[188:191], a[68:71]
    ds_read_b64_tr_b16 a[208:209], v250 offset:16384
    v_cvt_pk_bf16_f32 v177, v98, v99
    v_mfma_f32_16x16x32_bf16 a[72:75], a[196:199], v[192:195], a[72:75]
    v_exp_f32 v117, v117
    v_mfma_f32_16x16x32_bf16 a[76:79], a[196:199], v[196:199], a[76:79]
    s_waitcnt lgkmcnt(3)
    v_exp_f32 v118, v118
    v_mfma_f32_16x16x32_bf16 a[80:83], a[200:203], v[180:183], a[80:83]
    ds_read_b64_tr_b16 a[210:211], v250 offset:20480
    v_cvt_pk_bf16_f32 v178, v116, v117
    v_mfma_f32_16x16x32_bf16 a[84:87], a[200:203], v[184:187], a[84:87]
    v_exp_f32 v119, v119
    v_mfma_f32_16x16x32_bf16 a[88:91], a[200:203], v[188:191], a[88:91]
    s_nop 0
    ds_read_b64_tr_b16 a[212:213], v251 offset:16384
    v_cvt_pk_bf16_f32 v179, v118, v119
    v_mfma_f32_16x16x32_bf16 a[92:95], a[200:203], v[192:195], a[92:95]
    ds_read_b64_tr_b16 a[214:215], v251 offset:20480
    v_mfma_f32_16x16x32_bf16 a[96:99], a[200:203], v[196:199], a[96:99]
    s_waitcnt lgkmcnt(4)
    v_mfma_f32_16x16x32_bf16 a[100:103], a[204:207], v[180:183], a[100:103]
    v_mfma_f32_16x16x32_bf16 a[104:107], a[204:207], v[184:187], a[104:107]
    v_mfma_f32_16x16x32_bf16 a[108:111], a[204:207], v[188:191], a[108:111]
    v_mfma_f32_16x16x32_bf16 a[112:115], a[204:207], v[192:195], a[112:115]
    v_mfma_f32_16x16x32_bf16 a[116:119], a[204:207], v[196:199], a[116:119]
    s_waitcnt lgkmcnt(0)
    s_waitcnt vmcnt(16)
    s_barrier
    v_mfma_f32_16x16x32_bf16 a[120:123], a[208:211], v[180:183], a[120:123]
    v_xor_b32 v240, 0x8000, v240
    v_mfma_f32_16x16x32_bf16 a[124:127], a[208:211], v[184:187], a[124:127]
    v_xor_b32 v241, 0x8000, v241
    v_mfma_f32_16x16x32_bf16 a[128:131], a[208:211], v[188:191], a[128:131]
    v_xor_b32 v242, 0x8000, v242
    v_mfma_f32_16x16x32_bf16 a[132:135], a[208:211], v[192:195], a[132:135]
    v_xor_b32 v243, 0x8000, v243
    v_mfma_f32_16x16x32_bf16 a[136:139], a[208:211], v[196:199], a[136:139]
    ds_read_b128 a[184:187], v240 offset:0
    v_mfma_f32_16x16x32_bf16 a[140:143], a[212:215], v[180:183], a[140:143]
    ds_read_b128 a[188:191], v241 offset:0
    v_mfma_f32_16x16x32_bf16 a[144:147], a[212:215], v[184:187], a[144:147]
    ds_read_b128 a[192:195], v242 offset:0
    v_xor_b32 v244, 0x38000, v244
    v_mfma_f32_16x16x32_bf16 a[148:151], a[212:215], v[188:191], a[148:151]
    v_xor_b32 v245, 0x38000, v245
    v_mfma_f32_16x16x32_bf16 a[152:155], a[212:215], v[192:195], a[152:155]
    v_xor_b32 v246, 0x38000, v246
    v_mfma_f32_16x16x32_bf16 a[156:159], a[212:215], v[196:199], a[156:159]
    v_xor_b32 v247, 0x38000, v247
    v_xor_b32 v248, 0x38000, v248
    v_xor_b32 v249, 0x38000, v249
    v_xor_b32 v250, 0x38000, v250
    v_xor_b32 v251, 0x38000, v251
    v_lshrrev_b32 v202, 4, v207
    v_lshrrev_b32 v203, 4, v202
    v_and_b32 v204, 7, v202
    v_lshlrev_b32 v205, 1, v203
    v_xor_b32 v204, v204, v205
    v_lshlrev_b32 v204, 4, v204
    v_lshrrev_b32 v205, 3, v202
    v_lshl_add_u32 v232, v205, 10, v204
    v_add_u32 v233, 7168, v232
    v_add_u32 v234, 14336, v232
    v_add_u32 v235, 21504, v232
    v_bfe_u32 v204, v202, 2, 2
    v_lshl_add_u32 v204, v203, 2, v204
    v_lshrrev_b32 v205, 1, v204
    v_and_b32 v205, 3, v205
    v_lshlrev_b32 v204, 7, v204
    v_lshl_add_u32 v204, v205, 5, v204
    v_and_b32 v205, 3, v202
    v_lshl_add_u32 v204, v205, 3, v204
    s_lshl_b32 s3, s5, 13
    v_add_u32 v236, s3, v204
    v_xor_b32 v237, 32, v236
    v_xor_b32 v238, 64, v236
    v_xor_b32 v239, 0x60, v236
    s_mul_i32 s3, s4, 20480
    v_add_u32 v231, s3, v207
    s_mov_b32 s54, s39
    s_lshl_b32 s3, s6, 15
    s_lshl_b32 s7, s5, 9
    s_add_u32 s3, s3, s7
    s_lshl_b32 s7, s5, 17
    s_add_u32 s52, s3, s7
    s_xor_b32 s7, s7, 0x20000
    s_add_u32 s53, s3, s7
    s_cmp_eq_u32 s48, 0
    s_cselect_b32 s60, s98, s100
    s_cselect_b32 s61, s99, s101
    s_sub_u32 s3, s49, s5
    s_lshl_b32 s3, s3, 17
    s_add_u32 s28, s60, s3
    s_addc_u32 s29, s61, 0
    s_mov_b32 s30, 262144
    s_mov_b32 s31, 0x20000
    s_lshl_b32 s3, s48, 3
    s_add_u32 s3, s3, s47
    s_lshl_b32 s3, s3, 4
    s_lshr_b32 s7, s49, 1
    s_add_u32 s3, s3, s7
    s_lshl_b32 s3, s3, 2
    s_lshl_b32 s7, s6, 1
    s_add_u32 s3, s3, s7
    s_add_u32 s3, s3, s5
    s_mul_i32 s3, s3, 40960
    s_add_u32 s3, s3, 33554432
    s_add_u32 s24, s68, s3
    s_addc_u32 s25, s69, 0
    s_mov_b32 s26, 40960
    s_mov_b32 s27, 0x20000
    s_lshl_b32 s3, s46, 20
    s_add_u32 s56, s60, s3
    s_addc_u32 s57, s61, 0
    s_mov_b32 s58, 0x100000
    s_mov_b32 s59, 0x20000
    s_lshl_b32 s3, s45, 2
    s_add_u32 s3, s3, s4
    s_lshl_b32 s3, s3, 13
    v_lshlrev_b32 v202, 3, v207
    v_add_u32 v202, s3, v202
    s_mov_b32 s44, 0
L_loop_attn_kernel:
    s_waitcnt lgkmcnt(2)
    v_mfma_f32_16x16x32_bf16 v[80:83], a[184:187], v[0:3], v[208:211]
    s_mov_b32 m0, s40
    v_exp_f32 v120, v120
    v_mfma_f32_16x16x32_bf16 v[84:87], a[184:187], v[4:7], v[212:215]
    s_add_u32 s40, s40, 16384
    buffer_load_dwordx4 v252, s[16:19], s42 offen offset:0 nt lds
    v_mfma_f32_16x16x32_bf16 v[88:91], a[184:187], v[8:11], v[216:219]
    v_exp_f32 v121, v121
    v_mfma_f32_16x16x32_bf16 v[92:95], a[184:187], v[12:15], v[220:223]
    v_exp_f32 v122, v122
    v_mfma_f32_16x16x32_bf16 v[96:99], a[184:187], v[16:19], v[224:227]
    s_waitcnt lgkmcnt(1)
    ds_read_b128 a[196:199], v243 offset:0
    v_cvt_pk_bf16_f32 v180, v120, v121
    v_mfma_f32_16x16x32_bf16 v[80:83], a[188:191], v[20:23], v[80:83]
    v_exp_f32 v123, v123
    v_mfma_f32_16x16x32_bf16 v[84:87], a[188:191], v[24:27], v[84:87]
    v_exp_f32 v140, v140
    v_mfma_f32_16x16x32_bf16 v[88:91], a[188:191], v[28:31], v[88:91]
    ds_read_b128 a[200:203], v240 offset:4096
    v_cvt_pk_bf16_f32 v181, v122, v123
    v_mfma_f32_16x16x32_bf16 v[92:95], a[188:191], v[32:35], v[92:95]
    buffer_load_dwordx4 v253, s[16:19], s42 offen offset:1024 nt lds
    v_mfma_f32_16x16x32_bf16 v[96:99], a[188:191], v[36:39], v[96:99]
    s_waitcnt lgkmcnt(2)
    v_exp_f32 v141, v141
    v_mfma_f32_16x16x32_bf16 v[80:83], a[192:195], v[40:43], v[80:83]
    v_exp_f32 v142, v142
    v_mfma_f32_16x16x32_bf16 v[84:87], a[192:195], v[44:47], v[84:87]
    ds_read_b128 a[204:207], v241 offset:4096
    v_cvt_pk_bf16_f32 v182, v140, v141
    v_mfma_f32_16x16x32_bf16 v[88:91], a[192:195], v[48:51], v[88:91]
    v_exp_f32 v143, v143
    v_mfma_f32_16x16x32_bf16 v[92:95], a[192:195], v[52:55], v[92:95]
    v_exp_f32 v124, v124
    v_mfma_f32_16x16x32_bf16 v[96:99], a[192:195], v[56:59], v[96:99]
    s_waitcnt lgkmcnt(2)
    ds_read_b128 a[208:211], v242 offset:4096
    v_cvt_pk_bf16_f32 v183, v142, v143
    v_mfma_f32_16x16x32_bf16 v[80:83], a[196:199], v[60:63], v[80:83]
    buffer_load_dwordx4 v254, s[16:19], s42 offen offset:2048 nt lds
    v_mfma_f32_16x16x32_bf16 v[84:87], a[196:199], v[64:67], v[84:87]
    v_exp_f32 v125, v125
    v_mfma_f32_16x16x32_bf16 v[88:91], a[196:199], v[68:71], v[88:91]
    v_exp_f32 v126, v126
    v_mfma_f32_16x16x32_bf16 v[92:95], a[196:199], v[72:75], v[92:95]
    ds_read_b128 a[212:215], v243 offset:4096
    v_cvt_pk_bf16_f32 v184, v124, v125
    v_mfma_f32_16x16x32_bf16 v[96:99], a[196:199], v[76:79], v[96:99]
    s_waitcnt lgkmcnt(3)
    v_exp_f32 v127, v127
    v_mfma_f32_16x16x32_bf16 v[100:103], a[200:203], v[0:3], v[208:211]
    v_exp_f32 v144, v144
    v_mfma_f32_16x16x32_bf16 v[104:107], a[200:203], v[4:7], v[212:215]
    ds_read_b64_tr_b16 a[184:185], v244 offset:0
    v_cvt_pk_bf16_f32 v185, v126, v127
    v_mfma_f32_16x16x32_bf16 v[108:111], a[200:203], v[8:11], v[216:219]
    v_exp_f32 v145, v145
    v_mfma_f32_16x16x32_bf16 v[112:115], a[200:203], v[12:15], v[220:223]
    buffer_load_dwordx4 v255, s[16:19], s42 offen offset:3072 nt lds
    v_mfma_f32_16x16x32_bf16 v[116:119], a[200:203], v[16:19], v[224:227]
    s_waitcnt lgkmcnt(3)
    v_exp_f32 v146, v146
    v_mfma_f32_16x16x32_bf16 v[100:103], a[204:207], v[20:23], v[100:103]
    s_and_b32 s40, s40, 0xffff
    ds_read_b64_tr_b16 a[186:187], v244 offset:4096
    v_cvt_pk_bf16_f32 v186, v144, v145
    v_mfma_f32_16x16x32_bf16 v[104:107], a[204:207], v[24:27], v[104:107]
    s_add_u32 s42, s42, 8192
    v_exp_f32 v147, v147
    v_mfma_f32_16x16x32_bf16 v[108:111], a[204:207], v[28:31], v[108:111]
    s_add_u32 m0, s41, 98304
    v_exp_f32 v128, v128
    v_mfma_f32_16x16x32_bf16 v[112:115], a[204:207], v[32:35], v[112:115]
    s_add_u32 s41, s41, 16384
    ds_read_b64_tr_b16 a[188:189], v245 offset:0
    v_cvt_pk_bf16_f32 v187, v146, v147
    v_mfma_f32_16x16x32_bf16 v[116:119], a[204:207], v[36:39], v[116:119]
    s_waitcnt lgkmcnt(4)
    v_exp_f32 v129, v129
    v_mfma_f32_16x16x32_bf16 v[100:103], a[208:211], v[40:43], v[100:103]
    v_exp_f32 v130, v130
    v_mfma_f32_16x16x32_bf16 v[104:107], a[208:211], v[44:47], v[104:107]
    ds_read_b64_tr_b16 a[190:191], v245 offset:4096
    v_cvt_pk_bf16_f32 v188, v128, v129
    v_mfma_f32_16x16x32_bf16 v[108:111], a[208:211], v[48:51], v[108:111]
    buffer_load_dwordx4 v200, s[20:23], s43 offen offset:0 nt lds
    v_mfma_f32_16x16x32_bf16 v[112:115], a[208:211], v[52:55], v[112:115]
    v_exp_f32 v131, v131
    v_mfma_f32_16x16x32_bf16 v[116:119], a[208:211], v[56:59], v[116:119]
    s_waitcnt lgkmcnt(4)
    v_exp_f32 v148, v148
    v_mfma_f32_16x16x32_bf16 v[100:103], a[212:215], v[60:63], v[100:103]
    ds_read_b64_tr_b16 a[192:193], v246 offset:0
    v_cvt_pk_bf16_f32 v189, v130, v131
    v_mfma_f32_16x16x32_bf16 v[104:107], a[212:215], v[64:67], v[104:107]
    v_exp_f32 v149, v149
    v_mfma_f32_16x16x32_bf16 v[108:111], a[212:215], v[68:71], v[108:111]
    v_exp_f32 v150, v150
    v_mfma_f32_16x16x32_bf16 v[112:115], a[212:215], v[72:75], v[112:115]
    ds_read_b64_tr_b16 a[194:195], v246 offset:4096
    v_cvt_pk_bf16_f32 v190, v148, v149
    v_mfma_f32_16x16x32_bf16 v[116:119], a[212:215], v[76:79], v[116:119]
    buffer_load_dwordx4 v201, s[20:23], s43 offen offset:1024 nt lds
    v_mfma_f32_16x16x32_bf16 a[160:163], a[180:183], v[160:163], a[160:163]
    v_exp_f32 v151, v151
    v_mfma_f32_16x16x32_bf16 a[164:167], a[180:183], v[164:167], a[164:167]
    v_exp_f32 v132, v132
    v_mfma_f32_16x16x32_bf16 a[168:171], a[180:183], v[168:171], a[168:171]
    ds_read_b64_tr_b16 a[196:197], v247 offset:0
    v_cvt_pk_bf16_f32 v191, v150, v151
    v_mfma_f32_16x16x32_bf16 a[172:175], a[180:183], v[172:175], a[172:175]
    v_exp_f32 v133, v133
    v_mfma_f32_16x16x32_bf16 a[176:179], a[180:183], v[176:179], a[176:179]
    s_waitcnt lgkmcnt(5)
    v_exp_f32 v134, v134
    v_mfma_f32_16x16x32_bf16 a[0:3], a[184:187], v[160:163], a[0:3]
    ds_read_b64_tr_b16 a[198:199], v247 offset:4096
    v_cvt_pk_bf16_f32 v192, v132, v133
    v_mfma_f32_16x16x32_bf16 a[4:7], a[184:187], v[164:167], a[4:7]
    v_exp_f32 v135, v135
    v_mfma_f32_16x16x32_bf16 a[8:11], a[184:187], v[168:171], a[8:11]
    buffer_load_dwordx4 v200, s[20:23], s43 offen offset:2048 nt lds
    v_mfma_f32_16x16x32_bf16 a[12:15], a[184:187], v[172:175], a[12:15]
    v_exp_f32 v152, v152
    v_mfma_f32_16x16x32_bf16 a[16:19], a[184:187], v[176:179], a[16:19]
    s_waitcnt lgkmcnt(4)
    ds_read_b64_tr_b16 a[200:201], v248 offset:0
    v_cvt_pk_bf16_f32 v193, v134, v135
    v_mfma_f32_16x16x32_bf16 a[20:23], a[188:191], v[160:163], a[20:23]
    v_exp_f32 v153, v153
    v_mfma_f32_16x16x32_bf16 a[24:27], a[188:191], v[164:167], a[24:27]
    v_exp_f32 v154, v154
    v_mfma_f32_16x16x32_bf16 a[28:31], a[188:191], v[168:171], a[28:31]
    ds_read_b64_tr_b16 a[202:203], v248 offset:4096
    v_cvt_pk_bf16_f32 v194, v152, v153
    v_mfma_f32_16x16x32_bf16 a[32:35], a[188:191], v[172:175], a[32:35]
    v_exp_f32 v155, v155
    v_mfma_f32_16x16x32_bf16 a[36:39], a[188:191], v[176:179], a[36:39]
    s_waitcnt lgkmcnt(4)
    v_exp_f32 v136, v136
    v_mfma_f32_16x16x32_bf16 a[40:43], a[192:195], v[160:163], a[40:43]
    ds_read_b64_tr_b16 a[204:205], v249 offset:0
    v_cvt_pk_bf16_f32 v195, v154, v155
    v_mfma_f32_16x16x32_bf16 a[44:47], a[192:195], v[164:167], a[44:47]
    buffer_load_dwordx4 v201, s[20:23], s43 offen offset:3072 nt lds
    v_mfma_f32_16x16x32_bf16 a[48:51], a[192:195], v[168:171], a[48:51]
    s_and_b32 s41, s41, 0xffff
    v_exp_f32 v137, v137
    v_mfma_f32_16x16x32_bf16 a[52:55], a[192:195], v[172:175], a[52:55]
    s_add_u32 s43, s43, 8192
    v_exp_f32 v138, v138
    v_mfma_f32_16x16x32_bf16 a[56:59], a[192:195], v[176:179], a[56:59]
    s_waitcnt lgkmcnt(3)
    ds_read_b64_tr_b16 a[206:207], v249 offset:4096
    v_cvt_pk_bf16_f32 v196, v136, v137
    v_mfma_f32_16x16x32_bf16 a[60:63], a[196:199], v[160:163], a[60:63]
    v_exp_f32 v139, v139
    v_mfma_f32_16x16x32_bf16 a[64:67], a[196:199], v[164:167], a[64:67]
    v_exp_f32 v156, v156
    v_mfma_f32_16x16x32_bf16 a[68:71], a[196:199], v[168:171], a[68:71]
    ds_read_b64_tr_b16 a[208:209], v250 offset:0
    v_cvt_pk_bf16_f32 v197, v138, v139
    v_mfma_f32_16x16x32_bf16 a[72:75], a[196:199], v[172:175], a[72:75]
    v_exp_f32 v157, v157
    v_mfma_f32_16x16x32_bf16 a[76:79], a[196:199], v[176:179], a[76:79]
    s_waitcnt lgkmcnt(3)
    v_exp_f32 v158, v158
    v_mfma_f32_16x16x32_bf16 a[80:83], a[200:203], v[160:163], a[80:83]
    ds_read_b64_tr_b16 a[210:211], v250 offset:4096
    v_cvt_pk_bf16_f32 v198, v156, v157
    v_mfma_f32_16x16x32_bf16 a[84:87], a[200:203], v[164:167], a[84:87]
    v_exp_f32 v159, v159
    v_mfma_f32_16x16x32_bf16 a[88:91], a[200:203], v[168:171], a[88:91]
    s_nop 0
    ds_read_b64_tr_b16 a[212:213], v251 offset:0
    v_cvt_pk_bf16_f32 v199, v158, v159
    v_mfma_f32_16x16x32_bf16 a[92:95], a[200:203], v[172:175], a[92:95]
    ds_read_b64_tr_b16 a[214:215], v251 offset:4096
    v_mfma_f32_16x16x32_bf16 a[96:99], a[200:203], v[176:179], a[96:99]
    s_waitcnt lgkmcnt(4)
    v_mfma_f32_16x16x32_bf16 a[100:103], a[204:207], v[160:163], a[100:103]
    v_mfma_f32_16x16x32_bf16 a[104:107], a[204:207], v[164:167], a[104:107]
    v_mfma_f32_16x16x32_bf16 a[108:111], a[204:207], v[168:171], a[108:111]
    v_mfma_f32_16x16x32_bf16 a[112:115], a[204:207], v[172:175], a[112:115]
    v_mfma_f32_16x16x32_bf16 a[116:119], a[204:207], v[176:179], a[116:119]
    s_waitcnt lgkmcnt(0)
    s_waitcnt vmcnt(16)
    s_barrier
    v_mfma_f32_16x16x32_bf16 a[120:123], a[208:211], v[160:163], a[120:123]
    ds_read_b128 a[184:187], v240 offset:16384
    v_mfma_f32_16x16x32_bf16 a[124:127], a[208:211], v[164:167], a[124:127]
    ds_read_b128 a[188:191], v241 offset:16384
    v_mfma_f32_16x16x32_bf16 a[128:131], a[208:211], v[168:171], a[128:131]
    ds_read_b128 a[192:195], v242 offset:16384
    v_mfma_f32_16x16x32_bf16 a[132:135], a[208:211], v[172:175], a[132:135]
    v_mfma_f32_16x16x32_bf16 a[136:139], a[208:211], v[176:179], a[136:139]
    v_mfma_f32_16x16x32_bf16 a[140:143], a[212:215], v[160:163], a[140:143]
    v_mfma_f32_16x16x32_bf16 a[144:147], a[212:215], v[164:167], a[144:147]
    v_mfma_f32_16x16x32_bf16 a[148:151], a[212:215], v[168:171], a[148:151]
    v_mfma_f32_16x16x32_bf16 a[152:155], a[212:215], v[172:175], a[152:155]
    v_mfma_f32_16x16x32_bf16 a[156:159], a[212:215], v[176:179], a[156:159]
    s_sub_u32 s33, s39, 32768
    s_cmp_eq_u32 s44, 5
    s_cselect_b32 s41, s33, s41
    s_cmp_eq_u32 s44, 5
    s_cbranch_scc0 L_nowtb_attn_kernel
    buffer_load_dword v203, v202, s[56:59], 0 offen
L_nowtb_attn_kernel:
    s_waitcnt lgkmcnt(2)
    v_mfma_f32_16x16x32_bf16 v[120:123], a[184:187], v[0:3], v[208:211]
    s_mov_b32 m0, s40
    v_exp_f32 v80, v80
    v_mfma_f32_16x16x32_bf16 v[124:127], a[184:187], v[4:7], v[212:215]
    s_add_u32 s40, s40, 16384
    buffer_load_dwordx4 v252, s[16:19], s42 offen offset:0 nt lds
    v_mfma_f32_16x16x32_bf16 v[128:131], a[184:187], v[8:11], v[216:219]
    v_exp_f32 v81, v81
    v_mfma_f32_16x16x32_bf16 v[132:135], a[184:187], v[12:15], v[220:223]
    v_exp_f32 v82, v82
    v_mfma_f32_16x16x32_bf16 v[136:139], a[184:187], v[16:19], v[224:227]
    s_waitcnt lgkmcnt(1)
    ds_read_b128 a[196:199], v243 offset:16384
    v_cvt_pk_bf16_f32 v160, v80, v81
    v_mfma_f32_16x16x32_bf16 v[120:123], a[188:191], v[20:23], v[120:123]
    v_exp_f32 v83, v83
    v_mfma_f32_16x16x32_bf16 v[124:127], a[188:191], v[24:27], v[124:127]
    v_exp_f32 v100, v100
    v_mfma_f32_16x16x32_bf16 v[128:131], a[188:191], v[28:31], v[128:131]
    ds_read_b128 a[200:203], v240 offset:20480
    v_cvt_pk_bf16_f32 v161, v82, v83
    v_mfma_f32_16x16x32_bf16 v[132:135], a[188:191], v[32:35], v[132:135]
    buffer_load_dwordx4 v253, s[16:19], s42 offen offset:1024 nt lds
    v_mfma_f32_16x16x32_bf16 v[136:139], a[188:191], v[36:39], v[136:139]
    s_waitcnt lgkmcnt(2)
    v_exp_f32 v101, v101
    v_mfma_f32_16x16x32_bf16 v[120:123], a[192:195], v[40:43], v[120:123]
    v_exp_f32 v102, v102
    v_mfma_f32_16x16x32_bf16 v[124:127], a[192:195], v[44:47], v[124:127]
    ds_read_b128 a[204:207], v241 offset:20480
    v_cvt_pk_bf16_f32 v162, v100, v101
    v_mfma_f32_16x16x32_bf16 v[128:131], a[192:195], v[48:51], v[128:131]
    v_exp_f32 v103, v103
    v_mfma_f32_16x16x32_bf16 v[132:135], a[192:195], v[52:55], v[132:135]
    v_exp_f32 v84, v84
    v_mfma_f32_16x16x32_bf16 v[136:139], a[192:195], v[56:59], v[136:139]
    s_waitcnt lgkmcnt(2)
    ds_read_b128 a[208:211], v242 offset:20480
    v_cvt_pk_bf16_f32 v163, v102, v103
    v_mfma_f32_16x16x32_bf16 v[120:123], a[196:199], v[60:63], v[120:123]
    buffer_load_dwordx4 v254, s[16:19], s42 offen offset:2048 nt lds
    v_mfma_f32_16x16x32_bf16 v[124:127], a[196:199], v[64:67], v[124:127]
    v_exp_f32 v85, v85
    v_mfma_f32_16x16x32_bf16 v[128:131], a[196:199], v[68:71], v[128:131]
    v_exp_f32 v86, v86
    v_mfma_f32_16x16x32_bf16 v[132:135], a[196:199], v[72:75], v[132:135]
    ds_read_b128 a[212:215], v243 offset:20480
    v_cvt_pk_bf16_f32 v164, v84, v85
    v_mfma_f32_16x16x32_bf16 v[136:139], a[196:199], v[76:79], v[136:139]
    s_waitcnt lgkmcnt(3)
    v_exp_f32 v87, v87
    v_mfma_f32_16x16x32_bf16 v[140:143], a[200:203], v[0:3], v[208:211]
    v_exp_f32 v104, v104
    v_mfma_f32_16x16x32_bf16 v[144:147], a[200:203], v[4:7], v[212:215]
    ds_read_b64_tr_b16 a[184:185], v244 offset:16384
    v_cvt_pk_bf16_f32 v165, v86, v87
    v_mfma_f32_16x16x32_bf16 v[148:151], a[200:203], v[8:11], v[216:219]
    v_exp_f32 v105, v105
    v_mfma_f32_16x16x32_bf16 v[152:155], a[200:203], v[12:15], v[220:223]
    buffer_load_dwordx4 v255, s[16:19], s42 offen offset:3072 nt lds
    v_mfma_f32_16x16x32_bf16 v[156:159], a[200:203], v[16:19], v[224:227]
    s_waitcnt lgkmcnt(3)
    v_exp_f32 v106, v106
    v_mfma_f32_16x16x32_bf16 v[140:143], a[204:207], v[20:23], v[140:143]
    s_and_b32 s40, s40, 0xffff
    ds_read_b64_tr_b16 a[186:187], v244 offset:20480
    v_cvt_pk_bf16_f32 v166, v104, v105
    v_mfma_f32_16x16x32_bf16 v[144:147], a[204:207], v[24:27], v[144:147]
    s_add_u32 s42, s42, 8192
    v_exp_f32 v107, v107
    v_mfma_f32_16x16x32_bf16 v[148:151], a[204:207], v[28:31], v[148:151]
    s_add_u32 m0, s41, 98304
    v_exp_f32 v88, v88
    v_mfma_f32_16x16x32_bf16 v[152:155], a[204:207], v[32:35], v[152:155]
    s_add_u32 s41, s41, 16384
    ds_read_b64_tr_b16 a[188:189], v245 offset:16384
    v_cvt_pk_bf16_f32 v167, v106, v107
    v_mfma_f32_16x16x32_bf16 v[156:159], a[204:207], v[36:39], v[156:159]
    s_waitcnt lgkmcnt(4)
    v_exp_f32 v89, v89
    v_mfma_f32_16x16x32_bf16 v[140:143], a[208:211], v[40:43], v[140:143]
    v_exp_f32 v90, v90
    v_mfma_f32_16x16x32_bf16 v[144:147], a[208:211], v[44:47], v[144:147]
    ds_read_b64_tr_b16 a[190:191], v245 offset:20480
    v_cvt_pk_bf16_f32 v168, v88, v89
    v_mfma_f32_16x16x32_bf16 v[148:151], a[208:211], v[48:51], v[148:151]
    buffer_load_dwordx4 v200, s[20:23], s43 offen offset:0 nt lds
    v_mfma_f32_16x16x32_bf16 v[152:155], a[208:211], v[52:55], v[152:155]
    v_exp_f32 v91, v91
    v_mfma_f32_16x16x32_bf16 v[156:159], a[208:211], v[56:59], v[156:159]
    s_waitcnt lgkmcnt(4)
    v_exp_f32 v108, v108
    v_mfma_f32_16x16x32_bf16 v[140:143], a[212:215], v[60:63], v[140:143]
    ds_read_b64_tr_b16 a[192:193], v246 offset:16384
    v_cvt_pk_bf16_f32 v169, v90, v91
    v_mfma_f32_16x16x32_bf16 v[144:147], a[212:215], v[64:67], v[144:147]
    v_exp_f32 v109, v109
    v_mfma_f32_16x16x32_bf16 v[148:151], a[212:215], v[68:71], v[148:151]
    v_exp_f32 v110, v110
    v_mfma_f32_16x16x32_bf16 v[152:155], a[212:215], v[72:75], v[152:155]
    ds_read_b64_tr_b16 a[194:195], v246 offset:20480
    v_cvt_pk_bf16_f32 v170, v108, v109
    v_mfma_f32_16x16x32_bf16 v[156:159], a[212:215], v[76:79], v[156:159]
    buffer_load_dwordx4 v201, s[20:23], s43 offen offset:1024 nt lds
    v_mfma_f32_16x16x32_bf16 a[160:163], a[180:183], v[180:183], a[160:163]
    v_exp_f32 v111, v111
    v_mfma_f32_16x16x32_bf16 a[164:167], a[180:183], v[184:187], a[164:167]
    v_exp_f32 v92, v92
    v_mfma_f32_16x16x32_bf16 a[168:171], a[180:183], v[188:191], a[168:171]
    ds_read_b64_tr_b16 a[196:197], v247 offset:16384
    v_cvt_pk_bf16_f32 v171, v110, v111
    v_mfma_f32_16x16x32_bf16 a[172:175], a[180:183], v[192:195], a[172:175]
    v_exp_f32 v93, v93
    v_mfma_f32_16x16x32_bf16 a[176:179], a[180:183], v[196:199], a[176:179]
    s_waitcnt lgkmcnt(5)
    v_exp_f32 v94, v94
    v_mfma_f32_16x16x32_bf16 a[0:3], a[184:187], v[180:183], a[0:3]
    ds_read_b64_tr_b16 a[198:199], v247 offset:20480
    v_cvt_pk_bf16_f32 v172, v92, v93
    v_mfma_f32_16x16x32_bf16 a[4:7], a[184:187], v[184:187], a[4:7]
    v_exp_f32 v95, v95
    v_mfma_f32_16x16x32_bf16 a[8:11], a[184:187], v[188:191], a[8:11]
    buffer_load_dwordx4 v200, s[20:23], s43 offen offset:2048 nt lds
    v_mfma_f32_16x16x32_bf16 a[12:15], a[184:187], v[192:195], a[12:15]
    v_exp_f32 v112, v112
    v_mfma_f32_16x16x32_bf16 a[16:19], a[184:187], v[196:199], a[16:19]
    s_waitcnt lgkmcnt(4)
    ds_read_b64_tr_b16 a[200:201], v248 offset:16384
    v_cvt_pk_bf16_f32 v173, v94, v95
    v_mfma_f32_16x16x32_bf16 a[20:23], a[188:191], v[180:183], a[20:23]
    v_exp_f32 v113, v113
    v_mfma_f32_16x16x32_bf16 a[24:27], a[188:191], v[184:187], a[24:27]
    v_exp_f32 v114, v114
    v_mfma_f32_16x16x32_bf16 a[28:31], a[188:191], v[188:191], a[28:31]
    ds_read_b64_tr_b16 a[202:203], v248 offset:20480
    v_cvt_pk_bf16_f32 v174, v112, v113
    v_mfma_f32_16x16x32_bf16 a[32:35], a[188:191], v[192:195], a[32:35]
    v_exp_f32 v115, v115
    v_mfma_f32_16x16x32_bf16 a[36:39], a[188:191], v[196:199], a[36:39]
    s_waitcnt lgkmcnt(4)
    v_exp_f32 v96, v96
    v_mfma_f32_16x16x32_bf16 a[40:43], a[192:195], v[180:183], a[40:43]
    ds_read_b64_tr_b16 a[204:205], v249 offset:16384
    v_cvt_pk_bf16_f32 v175, v114, v115
    v_mfma_f32_16x16x32_bf16 a[44:47], a[192:195], v[184:187], a[44:47]
    buffer_load_dwordx4 v201, s[20:23], s43 offen offset:3072 nt lds
    v_mfma_f32_16x16x32_bf16 a[48:51], a[192:195], v[188:191], a[48:51]
    s_and_b32 s41, s41, 0xffff
    v_exp_f32 v97, v97
    v_mfma_f32_16x16x32_bf16 a[52:55], a[192:195], v[192:195], a[52:55]
    s_add_u32 s43, s43, 8192
    v_exp_f32 v98, v98
    v_mfma_f32_16x16x32_bf16 a[56:59], a[192:195], v[196:199], a[56:59]
    s_waitcnt lgkmcnt(3)
    ds_read_b64_tr_b16 a[206:207], v249 offset:20480
    v_cvt_pk_bf16_f32 v176, v96, v97
    v_mfma_f32_16x16x32_bf16 a[60:63], a[196:199], v[180:183], a[60:63]
    v_exp_f32 v99, v99
    v_mfma_f32_16x16x32_bf16 a[64:67], a[196:199], v[184:187], a[64:67]
    v_exp_f32 v116, v116
    v_mfma_f32_16x16x32_bf16 a[68:71], a[196:199], v[188:191], a[68:71]
    ds_read_b64_tr_b16 a[208:209], v250 offset:16384
    v_cvt_pk_bf16_f32 v177, v98, v99
    v_mfma_f32_16x16x32_bf16 a[72:75], a[196:199], v[192:195], a[72:75]
    v_exp_f32 v117, v117
    v_mfma_f32_16x16x32_bf16 a[76:79], a[196:199], v[196:199], a[76:79]
    s_waitcnt lgkmcnt(3)
    v_exp_f32 v118, v118
    v_mfma_f32_16x16x32_bf16 a[80:83], a[200:203], v[180:183], a[80:83]
    ds_read_b64_tr_b16 a[210:211], v250 offset:20480
    v_cvt_pk_bf16_f32 v178, v116, v117
    v_mfma_f32_16x16x32_bf16 a[84:87], a[200:203], v[184:187], a[84:87]
    v_exp_f32 v119, v119
    v_mfma_f32_16x16x32_bf16 a[88:91], a[200:203], v[188:191], a[88:91]
    s_nop 0
    ds_read_b64_tr_b16 a[212:213], v251 offset:16384
    v_cvt_pk_bf16_f32 v179, v118, v119
    v_mfma_f32_16x16x32_bf16 a[92:95], a[200:203], v[192:195], a[92:95]
    ds_read_b64_tr_b16 a[214:215], v251 offset:20480
    v_mfma_f32_16x16x32_bf16 a[96:99], a[200:203], v[196:199], a[96:99]
    s_waitcnt lgkmcnt(4)
    v_mfma_f32_16x16x32_bf16 a[100:103], a[204:207], v[180:183], a[100:103]
    v_mfma_f32_16x16x32_bf16 a[104:107], a[204:207], v[184:187], a[104:107]
    v_mfma_f32_16x16x32_bf16 a[108:111], a[204:207], v[188:191], a[108:111]
    v_mfma_f32_16x16x32_bf16 a[112:115], a[204:207], v[192:195], a[112:115]
    v_mfma_f32_16x16x32_bf16 a[116:119], a[204:207], v[196:199], a[116:119]
    s_waitcnt lgkmcnt(0)
    s_waitcnt vmcnt(16)
    s_barrier
    v_mfma_f32_16x16x32_bf16 a[120:123], a[208:211], v[180:183], a[120:123]
    v_xor_b32 v240, 0x8000, v240
    v_mfma_f32_16x16x32_bf16 a[124:127], a[208:211], v[184:187], a[124:127]
    v_xor_b32 v241, 0x8000, v241
    v_mfma_f32_16x16x32_bf16 a[128:131], a[208:211], v[188:191], a[128:131]
    v_xor_b32 v242, 0x8000, v242
    v_mfma_f32_16x16x32_bf16 a[132:135], a[208:211], v[192:195], a[132:135]
    v_xor_b32 v243, 0x8000, v243
    v_mfma_f32_16x16x32_bf16 a[136:139], a[208:211], v[196:199], a[136:139]
    ds_read_b128 a[184:187], v240 offset:0
    v_mfma_f32_16x16x32_bf16 a[140:143], a[212:215], v[180:183], a[140:143]
    ds_read_b128 a[188:191], v241 offset:0
    v_mfma_f32_16x16x32_bf16 a[144:147], a[212:215], v[184:187], a[144:147]
    ds_read_b128 a[192:195], v242 offset:0
    v_xor_b32 v244, 0x38000, v244
    v_mfma_f32_16x16x32_bf16 a[148:151], a[212:215], v[188:191], a[148:151]
    v_xor_b32 v245, 0x38000, v245
    v_mfma_f32_16x16x32_bf16 a[152:155], a[212:215], v[192:195], a[152:155]
    v_xor_b32 v246, 0x38000, v246
    v_mfma_f32_16x16x32_bf16 a[156:159], a[212:215], v[196:199], a[156:159]
    v_xor_b32 v247, 0x38000, v247
    v_xor_b32 v248, 0x38000, v248
    v_xor_b32 v249, 0x38000, v249
    v_xor_b32 v250, 0x38000, v250
    v_xor_b32 v251, 0x38000, v251
    s_add_u32 s44, s44, 1
    s_cmp_lt_u32 s44, 6
    s_cbranch_scc1 L_loop_attn_kernel
    s_waitcnt lgkmcnt(0)
    ds_read_b64_tr_b16 a[184:185], v244 offset:0
    ds_read_b64_tr_b16 a[186:187], v244 offset:4096
    v_mfma_f32_16x16x32_bf16 a[160:163], a[180:183], v[160:163], a[160:163]
    s_add_u32 m0, s54, 131072
    v_exp_f32 v120, v120
    v_mfma_f32_16x16x32_bf16 a[164:167], a[180:183], v[164:167], a[164:167]
    s_add_u32 s33, s52, 0
    buffer_load_dwordx4 v232, s[28:31], s33 offen offset:0  lds
    v_mfma_f32_16x16x32_bf16 a[168:171], a[180:183], v[168:171], a[168:171]
    ds_read_b64_tr_b16 a[188:189], v245 offset:0
    v_mfma_f32_16x16x32_bf16 a[172:175], a[180:183], v[172:175], a[172:175]
    ds_read_b64_tr_b16 a[190:191], v245 offset:4096
    v_mfma_f32_16x16x32_bf16 a[176:179], a[180:183], v[176:179], a[176:179]
    s_waitcnt lgkmcnt(2)
    buffer_load_dwordx4 v233, s[28:31], s33 offen offset:1024  lds
    v_mfma_f32_16x16x32_bf16 a[0:3], a[184:187], v[160:163], a[0:3]
    v_exp_f32 v121, v121
    v_mfma_f32_16x16x32_bf16 a[4:7], a[184:187], v[164:167], a[4:7]
    buffer_load_dwordx4 v234, s[28:31], s33 offen offset:2048  lds
    v_mfma_f32_16x16x32_bf16 a[8:11], a[184:187], v[168:171], a[8:11]
    ds_read_b64_tr_b16 a[192:193], v246 offset:0
    v_mfma_f32_16x16x32_bf16 a[12:15], a[184:187], v[172:175], a[12:15]
    ds_read_b64_tr_b16 a[194:195], v246 offset:4096
    v_mfma_f32_16x16x32_bf16 a[16:19], a[184:187], v[176:179], a[16:19]
    s_waitcnt lgkmcnt(2)
    buffer_load_dwordx4 v235, s[28:31], s33 offen offset:3072  lds
    v_mfma_f32_16x16x32_bf16 a[20:23], a[188:191], v[160:163], a[20:23]
    v_exp_f32 v122, v122
    v_mfma_f32_16x16x32_bf16 a[24:27], a[188:191], v[164:167], a[24:27]
    ds_read_b64_tr_b16 a[196:197], v247 offset:0
    v_cvt_pk_bf16_f32 v180, v120, v121
    v_mfma_f32_16x16x32_bf16 a[28:31], a[188:191], v[168:171], a[28:31]
    s_add_u32 m0, s54, 147456
    ds_read_b64_tr_b16 a[198:199], v247 offset:4096
    v_mfma_f32_16x16x32_bf16 a[32:35], a[188:191], v[172:175], a[32:35]
    s_add_u32 s33, s52, 65536
    buffer_load_dwordx4 v232, s[28:31], s33 offen offset:0  lds
    v_mfma_f32_16x16x32_bf16 a[36:39], a[188:191], v[176:179], a[36:39]
    s_waitcnt lgkmcnt(2)
    v_exp_f32 v123, v123
    v_mfma_f32_16x16x32_bf16 a[40:43], a[192:195], v[160:163], a[40:43]
    buffer_load_dwordx4 v233, s[28:31], s33 offen offset:1024  lds
    v_mfma_f32_16x16x32_bf16 a[44:47], a[192:195], v[164:167], a[44:47]
    v_exp_f32 v140, v140
    v_mfma_f32_16x16x32_bf16 a[48:51], a[192:195], v[168:171], a[48:51]
    ds_read_b64_tr_b16 a[200:201], v248 offset:0
    v_cvt_pk_bf16_f32 v181, v122, v123
    v_mfma_f32_16x16x32_bf16 a[52:55], a[192:195], v[172:175], a[52:55]
    ds_read_b64_tr_b16 a[202:203], v248 offset:4096
    v_mfma_f32_16x16x32_bf16 a[56:59], a[192:195], v[176:179], a[56:59]
    s_waitcnt lgkmcnt(2)
    buffer_load_dwordx4 v234, s[28:31], s33 offen offset:2048  lds
    v_mfma_f32_16x16x32_bf16 a[60:63], a[196:199], v[160:163], a[60:63]
    v_exp_f32 v141, v141
    v_mfma_f32_16x16x32_bf16 a[64:67], a[196:199], v[164:167], a[64:67]
    buffer_load_dwordx4 v235, s[28:31], s33 offen offset:3072  lds
    v_mfma_f32_16x16x32_bf16 a[68:71], a[196:199], v[168:171], a[68:71]
    ds_read_b64_tr_b16 a[204:205], v249 offset:0
    v_mfma_f32_16x16x32_bf16 a[72:75], a[196:199], v[172:175], a[72:75]
    ds_read_b64_tr_b16 a[206:207], v249 offset:4096
    v_mfma_f32_16x16x32_bf16 a[76:79], a[196:199], v[176:179], a[76:79]
    s_waitcnt lgkmcnt(2)
    v_exp_f32 v142, v142
    v_mfma_f32_16x16x32_bf16 a[80:83], a[200:203], v[160:163], a[80:83]
    s_add_u32 m0, s54, 81920
    ds_read_b64_tr_b16 a[208:209], v250 offset:0
    v_cvt_pk_bf16_f32 v182, v140, v141
    v_mfma_f32_16x16x32_bf16 a[84:87], a[200:203], v[164:167], a[84:87]
    s_add_u32 s33, s53, 65536
    buffer_load_dwordx4 v232, s[28:31], s33 offen offset:0  lds
    v_mfma_f32_16x16x32_bf16 a[88:91], a[200:203], v[168:171], a[88:91]
    ds_read_b64_tr_b16 a[210:211], v250 offset:4096
    v_mfma_f32_16x16x32_bf16 a[92:95], a[200:203], v[172:175], a[92:95]
    ds_read_b64_tr_b16 a[212:213], v251 offset:0
    v_mfma_f32_16x16x32_bf16 a[96:99], a[200:203], v[176:179], a[96:99]
    s_waitcnt lgkmcnt(3)
    ds_read_b64_tr_b16 a[214:215], v251 offset:4096
    v_mfma_f32_16x16x32_bf16 a[100:103], a[204:207], v[160:163], a[100:103]
    buffer_load_dwordx4 v233, s[28:31], s33 offen offset:1024  lds
    v_mfma_f32_16x16x32_bf16 a[104:107], a[204:207], v[164:167], a[104:107]
    buffer_load_dwordx4 v234, s[28:31], s33 offen offset:2048  lds
    v_mfma_f32_16x16x32_bf16 a[108:111], a[204:207], v[168:171], a[108:111]
    v_exp_f32 v143, v143
    v_mfma_f32_16x16x32_bf16 a[112:115], a[204:207], v[172:175], a[112:115]
    buffer_load_dwordx4 v235, s[28:31], s33 offen offset:3072  lds
    v_mfma_f32_16x16x32_bf16 a[116:119], a[204:207], v[176:179], a[116:119]
    v_exp_f32 v124, v124
    s_waitcnt lgkmcnt(0)
    s_waitcnt vmcnt(12)
    s_barrier
    v_mfma_f32_16x16x32_bf16 a[120:123], a[208:211], v[160:163], a[120:123]
    v_cvt_pk_bf16_f32 v183, v142, v143
    v_mfma_f32_16x16x32_bf16 a[124:127], a[208:211], v[164:167], a[124:127]
    v_exp_f32 v125, v125
    v_mfma_f32_16x16x32_bf16 a[128:131], a[208:211], v[168:171], a[128:131]
    v_exp_f32 v126, v126
    v_mfma_f32_16x16x32_bf16 a[132:135], a[208:211], v[172:175], a[132:135]
    v_cvt_pk_bf16_f32 v184, v124, v125
    v_mfma_f32_16x16x32_bf16 a[136:139], a[208:211], v[176:179], a[136:139]
    v_exp_f32 v127, v127
    v_mfma_f32_16x16x32_bf16 a[140:143], a[212:215], v[160:163], a[140:143]
    v_exp_f32 v144, v144
    v_mfma_f32_16x16x32_bf16 a[144:147], a[212:215], v[164:167], a[144:147]
    v_cvt_pk_bf16_f32 v185, v126, v127
    v_mfma_f32_16x16x32_bf16 a[148:151], a[212:215], v[168:171], a[148:151]
    v_exp_f32 v145, v145
    v_mfma_f32_16x16x32_bf16 a[152:155], a[212:215], v[172:175], a[152:155]
    v_exp_f32 v146, v146
    v_mfma_f32_16x16x32_bf16 a[156:159], a[212:215], v[176:179], a[156:159]
    v_cvt_pk_bf16_f32 v186, v144, v145
    v_exp_f32 v147, v147
    v_exp_f32 v128, v128
    v_cvt_pk_bf16_f32 v187, v146, v147
    v_exp_f32 v129, v129
    v_exp_f32 v130, v130
    v_cvt_pk_bf16_f32 v188, v128, v129
    v_exp_f32 v131, v131
    v_exp_f32 v148, v148
    v_cvt_pk_bf16_f32 v189, v130, v131
    v_exp_f32 v149, v149
    v_exp_f32 v150, v150
    v_cvt_pk_bf16_f32 v190, v148, v149
    v_exp_f32 v151, v151
    v_exp_f32 v132, v132
    v_cvt_pk_bf16_f32 v191, v150, v151
    v_exp_f32 v133, v133
    v_exp_f32 v134, v134
    v_cvt_pk_bf16_f32 v192, v132, v133
    v_exp_f32 v135, v135
    v_exp_f32 v152, v152
    v_cvt_pk_bf16_f32 v193, v134, v135
    v_exp_f32 v153, v153
    v_exp_f32 v154, v154
    v_cvt_pk_bf16_f32 v194, v152, v153
    v_exp_f32 v155, v155
    v_exp_f32 v136, v136
    v_cvt_pk_bf16_f32 v195, v154, v155
    v_exp_f32 v137, v137
    v_exp_f32 v138, v138
    v_cvt_pk_bf16_f32 v196, v136, v137
    v_exp_f32 v139, v139
    v_exp_f32 v156, v156
    v_cvt_pk_bf16_f32 v197, v138, v139
    v_exp_f32 v157, v157
    v_exp_f32 v158, v158
    v_cvt_pk_bf16_f32 v198, v156, v157
    v_exp_f32 v159, v159
    s_nop 0
    v_cvt_pk_bf16_f32 v199, v158, v159
    s_mov_b64 s[64:65], 0
    s_mov_b32 s66, 0x27800000
    v_mov_b32 v225, 0x4f800000
    v_add_u32 v160, 0, v236
    v_add_u32 v161, 0, v237
    v_add_u32 v162, 0, v238
    v_add_u32 v163, 0, v239
    v_add_u32 v164, 65536, v236
    v_add_u32 v165, 65536, v237
    v_add_u32 v166, 65536, v238
    v_add_u32 v167, 65536, v239
    v_add_u32 v168, 131072, v236
    v_add_u32 v169, 131072, v237
    v_add_u32 v170, 131072, v238
    v_add_u32 v171, 131072, v239
    s_lshl_b32 s32, s5, 1
    s_sub_u32 s32, 1, s32
    s_mul_i32 s32, s32, 40960
    s_mov_b32 s55, s32
    ds_read_b64_tr_b16 a[184:185], v244 offset:16384
    ds_read_b64_tr_b16 a[186:187], v244 offset:20480
    v_mfma_f32_16x16x32_bf16 a[160:163], a[180:183], v[180:183], a[160:163]
    s_add_u32 m0, s54, 98304
    ds_read_b64_tr_b16 a[188:189], v245 offset:16384
    v_mfma_f32_16x16x32_bf16 a[164:167], a[180:183], v[184:187], a[164:167]
    s_add_u32 s33, s53, 0
    ds_read_b64_tr_b16 a[190:191], v245 offset:20480
    v_mfma_f32_16x16x32_bf16 a[168:171], a[180:183], v[188:191], a[168:171]
    ds_read_b64_tr_b16 a[192:193], v246 offset:16384
    v_mfma_f32_16x16x32_bf16 a[172:175], a[180:183], v[192:195], a[172:175]
    ds_read_b64_tr_b16 a[194:195], v246 offset:20480
    v_mfma_f32_16x16x32_bf16 a[176:179], a[180:183], v[196:199], a[176:179]
    s_waitcnt lgkmcnt(4)
    ds_read_b64_tr_b16 a[196:197], v247 offset:16384
    v_mfma_f32_16x16x32_bf16 a[0:3], a[184:187], v[180:183], a[0:3]
    ds_read_b64_tr_b16 a[198:199], v247 offset:20480
    v_mfma_f32_16x16x32_bf16 a[4:7], a[184:187], v[184:187], a[4:7]
    ds_read_b64_tr_b16 a[200:201], v248 offset:16384
    v_mfma_f32_16x16x32_bf16 a[8:11], a[184:187], v[188:191], a[8:11]
    ds_read_b64_tr_b16 a[202:203], v248 offset:20480
    v_mfma_f32_16x16x32_bf16 a[12:15], a[184:187], v[192:195], a[12:15]
    buffer_load_dwordx4 v232, s[28:31], s33 offen offset:0  lds
    v_mfma_f32_16x16x32_bf16 a[16:19], a[184:187], v[196:199], a[16:19]
    s_waitcnt lgkmcnt(6)
    buffer_load_dwordx4 v233, s[28:31], s33 offen offset:1024  lds
    v_mfma_f32_16x16x32_bf16 a[20:23], a[188:191], v[180:183], a[20:23]
    ds_read_b64_tr_b16 a[204:205], v249 offset:16384
    v_mfma_f32_16x16x32_bf16 a[24:27], a[188:191], v[184:187], a[24:27]
    ds_read_b64_tr_b16 a[206:207], v249 offset:20480
    v_accvgpr_read_b32 v202, a160
    v_accvgpr_read_b32 v203, a164
    v_mfma_f32_16x16x32_bf16 a[28:31], a[188:191], v[188:191], a[28:31]
    buffer_load_dwordx4 v234, s[28:31], s33 offen offset:2048  lds
    v_mfma_f32_16x16x32_bf16 a[32:35], a[188:191], v[192:195], a[32:35]
    buffer_load_dwordx4 v235, s[28:31], s33 offen offset:3072  lds
    v_mfma_f32_16x16x32_bf16 a[36:39], a[188:191], v[196:199], a[36:39]
    s_waitcnt lgkmcnt(6)
    v_accvgpr_read_b32 v204, a168
    v_accvgpr_read_b32 v205, a172
    v_mfma_f32_16x16x32_bf16 a[40:43], a[192:195], v[180:183], a[40:43]
    ds_read_b64_tr_b16 a[208:209], v250 offset:16384
    v_accvgpr_read_b32 v206, a176
    v_mfma_f32_16x16x32_bf16 a[44:47], a[192:195], v[184:187], a[44:47]
    v_rcp_f32 v202, v202
    v_mfma_f32_16x16x32_bf16 a[48:51], a[192:195], v[188:191], a[48:51]
    v_rcp_f32 v203, v203
    v_mfma_f32_16x16x32_bf16 a[52:55], a[192:195], v[192:195], a[52:55]
    v_rcp_f32 v204, v204
    v_mfma_f32_16x16x32_bf16 a[56:59], a[192:195], v[196:199], a[56:59]
    s_waitcnt lgkmcnt(5)
    v_rcp_f32 v205, v205
    v_mfma_f32_16x16x32_bf16 a[60:63], a[196:199], v[180:183], a[60:63]
    v_rcp_f32 v206, v206
    v_mfma_f32_16x16x32_bf16 a[64:67], a[196:199], v[184:187], a[64:67]
    ds_read_b64_tr_b16 a[210:211], v250 offset:20480
    v_accvgpr_read_b32 v208, a0
    v_accvgpr_read_b32 v209, a1
    v_mfma_f32_16x16x32_bf16 a[68:71], a[196:199], v[188:191], a[68:71]
    ds_read_b64_tr_b16 a[212:213], v251 offset:16384
    v_accvgpr_read_b32 v210, a2
    v_accvgpr_read_b32 v211, a3
    v_mfma_f32_16x16x32_bf16 a[72:75], a[196:199], v[192:195], a[72:75]
    ds_read_b64_tr_b16 a[214:215], v251 offset:20480
    v_accvgpr_read_b32 v212, a20
    v_accvgpr_read_b32 v213, a21
    v_mfma_f32_16x16x32_bf16 a[76:79], a[196:199], v[196:199], a[76:79]
    s_waitcnt lgkmcnt(6)
    v_accvgpr_read_b32 v214, a22
    v_accvgpr_read_b32 v215, a23
    v_mfma_f32_16x16x32_bf16 a[80:83], a[200:203], v[180:183], a[80:83]
    v_mul_f32 v208, v208, v202
    v_mul_f32 v209, v209, v202
    v_mfma_f32_16x16x32_bf16 a[84:87], a[200:203], v[184:187], a[84:87]
    v_mul_f32 v210, v210, v202
    v_mul_f32 v211, v211, v202
    v_mfma_f32_16x16x32_bf16 a[88:91], a[200:203], v[188:191], a[88:91]
    v_mul_f32 v212, v212, v202
    v_mul_f32 v213, v213, v202
    v_mfma_f32_16x16x32_bf16 a[92:95], a[200:203], v[192:195], a[92:95]
    v_mul_f32 v214, v214, v202
    v_mul_f32 v215, v215, v202
    v_mfma_f32_16x16x32_bf16 a[96:99], a[200:203], v[196:199], a[96:99]
    s_waitcnt lgkmcnt(4)
    v_cvt_pk_bf16_f32 v0, v208, v209
    v_cvt_pk_bf16_f32 v1, v210, v211
    v_mfma_f32_16x16x32_bf16 a[100:103], a[204:207], v[180:183], a[100:103]
    v_cvt_pk_bf16_f32 v2, v212, v213
    v_cvt_pk_bf16_f32 v3, v214, v215
    v_mfma_f32_16x16x32_bf16 a[104:107], a[204:207], v[184:187], a[104:107]
    ds_write_b128 v231, v[0:3] offset:0
    v_accvgpr_read_b32 v216, a4
    v_accvgpr_read_b32 v217, a5
    v_mfma_f32_16x16x32_bf16 a[108:111], a[204:207], v[188:191], a[108:111]
    v_accvgpr_read_b32 v218, a6
    v_accvgpr_read_b32 v219, a7
    v_mfma_f32_16x16x32_bf16 a[112:115], a[204:207], v[192:195], a[112:115]
    v_accvgpr_read_b32 v220, a24
    v_accvgpr_read_b32 v221, a25
    v_mfma_f32_16x16x32_bf16 a[116:119], a[204:207], v[196:199], a[116:119]
    v_accvgpr_read_b32 v222, a26
    v_accvgpr_read_b32 v223, a27
    s_waitcnt lgkmcnt(0)
    s_waitcnt vmcnt(12)
    s_barrier
    v_mfma_f32_16x16x32_bf16 a[120:123], a[208:211], v[180:183], a[120:123]
    s_add_u32 m0, s54, 114688
    ds_read_b64_tr_b16 a[184:185], v168 offset:0
    v_mul_f32 v216, v216, v203
    v_mul_f32 v217, v217, v203
    v_mfma_f32_16x16x32_bf16 a[124:127], a[208:211], v[184:187], a[124:127]
    s_add_u32 s33, s52, 128
    ds_read_b64_tr_b16 a[186:187], v168 offset:2048
    v_mul_f32 v218, v218, v203
    v_mul_f32 v219, v219, v203
    v_mfma_f32_16x16x32_bf16 a[128:131], a[208:211], v[188:191], a[128:131]
    ds_read_b64_tr_b16 a[188:189], v169 offset:0
    v_mul_f32 v220, v220, v203
    v_mul_f32 v221, v221, v203
    v_mfma_f32_16x16x32_bf16 a[132:135], a[208:211], v[192:195], a[132:135]
    ds_read_b64_tr_b16 a[190:191], v169 offset:2048
    v_mul_f32 v222, v222, v203
    v_mul_f32 v223, v223, v203
    v_mfma_f32_16x16x32_bf16 a[136:139], a[208:211], v[196:199], a[136:139]
    ds_read_b64_tr_b16 a[192:193], v170 offset:0
    v_cvt_pk_bf16_f32 v4, v216, v217
    v_cvt_pk_bf16_f32 v5, v218, v219
    v_mfma_f32_16x16x32_bf16 a[140:143], a[212:215], v[180:183], a[140:143]
    ds_read_b64_tr_b16 a[194:195], v170 offset:2048
    v_cvt_pk_bf16_f32 v6, v220, v221
    v_cvt_pk_bf16_f32 v7, v222, v223
    v_mfma_f32_16x16x32_bf16 a[144:147], a[212:215], v[184:187], a[144:147]
    ds_write_b128 v231, v[4:7] offset:1024
    v_accvgpr_read_b32 v208, a8
    v_accvgpr_read_b32 v209, a9
    v_mfma_f32_16x16x32_bf16 a[148:151], a[212:215], v[188:191], a[148:151]
    buffer_load_dwordx4 v232, s[28:31], s33 offen offset:0  lds
    v_accvgpr_read_b32 v210, a10
    v_accvgpr_read_b32 v211, a11
    v_accvgpr_read_b32 v212, a28
    v_accvgpr_read_b32 v213, a29
    v_accvgpr_read_b32 v214, a30
    v_accvgpr_read_b32 v215, a31
    v_mul_f32 v208, v208, v204
    v_mul_f32 v209, v209, v204
    v_mul_f32 v210, v210, v204
    v_mul_f32 v211, v211, v204
    v_mul_f32 v212, v212, v204
    v_mul_f32 v213, v213, v204
    v_mul_f32 v214, v214, v204
    v_mul_f32 v215, v215, v204
    v_cvt_pk_bf16_f32 v8, v208, v209
    v_cvt_pk_bf16_f32 v9, v210, v211
    v_cvt_pk_bf16_f32 v10, v212, v213
    v_cvt_pk_bf16_f32 v11, v214, v215
    v_accvgpr_read_b32 v216, a12
    v_accvgpr_read_b32 v217, a13
    v_accvgpr_read_b32 v218, a14
    v_accvgpr_read_b32 v219, a15
    v_accvgpr_read_b32 v220, a32
    v_accvgpr_read_b32 v221, a33
    v_accvgpr_read_b32 v222, a34
    v_accvgpr_read_b32 v223, a35
    v_mul_f32 v216, v216, v205
    v_mul_f32 v217, v217, v205
    v_mul_f32 v218, v218, v205
    v_mul_f32 v219, v219, v205
    v_mul_f32 v220, v220, v205
    v_mul_f32 v221, v221, v205
    v_mul_f32 v222, v222, v205
    v_mul_f32 v223, v223, v205
    v_cvt_pk_bf16_f32 v12, v216, v217
    v_cvt_pk_bf16_f32 v13, v218, v219
    v_cvt_pk_bf16_f32 v14, v220, v221
    v_cvt_pk_bf16_f32 v15, v222, v223
    v_accvgpr_read_b32 v208, a16
    v_accvgpr_read_b32 v209, a17
    v_accvgpr_read_b32 v210, a18
    v_accvgpr_read_b32 v211, a19
    v_accvgpr_read_b32 v212, a36
    v_accvgpr_read_b32 v213, a37
    v_accvgpr_read_b32 v214, a38
    v_accvgpr_read_b32 v215, a39
    v_mul_f32 v208, v208, v206
    v_mul_f32 v209, v209, v206
    v_mul_f32 v210, v210, v206
    v_mul_f32 v211, v211, v206
    v_mul_f32 v212, v212, v206
    v_mul_f32 v213, v213, v206
    v_mul_f32 v214, v214, v206
    v_mul_f32 v215, v215, v206
    v_cvt_pk_bf16_f32 v16, v208, v209
    v_cvt_pk_bf16_f32 v17, v210, v211
    v_cvt_pk_bf16_f32 v18, v212, v213
    v_cvt_pk_bf16_f32 v19, v214, v215
    v_mfma_f32_16x16x32_bf16 a[152:155], a[212:215], v[192:195], a[152:155]
    ds_write_b128 v231, v[8:11] offset:2048
    v_accvgpr_read_b32 v216, a40
    v_accvgpr_read_b32 v217, a41
    v_mfma_f32_16x16x32_bf16 a[156:159], a[212:215], v[196:199], a[156:159]
    s_waitcnt lgkmcnt(6)
    ds_write_b128 v231, v[12:15] offset:3072
    v_accvgpr_read_b32 v218, a42
    v_accvgpr_read_b32 v219, a43
    v_mfma_f32_16x16x32_bf16 a[0:3], a[184:187], v[0:3], 0
    ds_read_b64_tr_b16 a[196:197], v171 offset:0
    v_accvgpr_read_b32 v220, a60
    v_accvgpr_read_b32 v221, a61
    v_mfma_f32_16x16x32_bf16 a[4:7], a[184:187], v[4:7], 0
    ds_read_b64_tr_b16 a[198:199], v171 offset:2048
    v_accvgpr_read_b32 v222, a62
    v_accvgpr_read_b32 v223, a63
    v_mfma_f32_16x16x32_bf16 a[8:11], a[184:187], v[8:11], 0
    ds_write_b128 v231, v[16:19] offset:4096
    v_mul_f32 v216, v216, v202
    v_mul_f32 v217, v217, v202
    v_mfma_f32_16x16x32_bf16 a[12:15], a[184:187], v[12:15], 0
    buffer_load_dwordx4 v233, s[28:31], s33 offen offset:1024  lds
    v_mfma_f32_16x16x32_bf16 a[16:19], a[184:187], v[16:19], 0
    s_waitcnt lgkmcnt(8)
    buffer_load_dwordx4 v234, s[28:31], s33 offen offset:2048  lds
    v_mfma_f32_16x16x32_bf16 a[20:23], a[188:191], v[0:3], 0
    ds_read_b64_tr_b16 a[200:201], v168 offset:4096
    v_mul_f32 v218, v218, v202
    v_mul_f32 v219, v219, v202
    v_mfma_f32_16x16x32_bf16 a[24:27], a[188:191], v[4:7], 0
    ds_read_b64_tr_b16 a[202:203], v168 offset:6144
    v_mul_f32 v220, v220, v202
    v_mul_f32 v221, v221, v202
    v_mfma_f32_16x16x32_bf16 a[28:31], a[188:191], v[8:11], 0
    buffer_load_dwordx4 v235, s[28:31], s33 offen offset:3072  lds
    v_mfma_f32_16x16x32_bf16 a[32:35], a[188:191], v[12:15], 0
    v_mul_f32 v222, v222, v202
    v_mul_f32 v223, v223, v202
    v_mfma_f32_16x16x32_bf16 a[36:39], a[188:191], v[16:19], 0
    s_waitcnt lgkmcnt(8)
    v_cvt_pk_bf16_f32 v20, v216, v217
    v_cvt_pk_bf16_f32 v21, v218, v219
    v_mfma_f32_16x16x32_bf16 a[216:219], a[192:195], v[0:3], 0
    ds_read_b64_tr_b16 a[204:205], v169 offset:4096
    v_cvt_pk_bf16_f32 v22, v220, v221
    v_cvt_pk_bf16_f32 v23, v222, v223
    v_mfma_f32_16x16x32_bf16 a[220:223], a[192:195], v[4:7], 0
    ds_read_b64_tr_b16 a[206:207], v169 offset:6144
    v_accvgpr_read_b32 v208, a44
    v_accvgpr_read_b32 v209, a45
    v_mfma_f32_16x16x32_bf16 a[224:227], a[192:195], v[8:11], 0
    ds_read_b64_tr_b16 a[208:209], v170 offset:4096
    v_accvgpr_read_b32 v210, a46
    v_accvgpr_read_b32 v211, a47
    v_mfma_f32_16x16x32_bf16 a[228:231], a[192:195], v[12:15], 0
    ds_read_b64_tr_b16 a[210:211], v170 offset:6144
    v_accvgpr_read_b32 v212, a64
    v_accvgpr_read_b32 v213, a65
    v_mfma_f32_16x16x32_bf16 a[232:235], a[192:195], v[16:19], 0
    s_waitcnt lgkmcnt(7)
    ds_read_b64_tr_b16 a[212:213], v171 offset:4096
    v_accvgpr_read_b32 v214, a66
    v_accvgpr_read_b32 v215, a67
    v_mfma_f32_16x16x32_bf16 a[236:239], a[196:199], v[0:3], 0
    ds_read_b64_tr_b16 a[214:215], v171 offset:6144
    v_mul_f32 v208, v208, v203
    v_mul_f32 v209, v209, v203
    v_mfma_f32_16x16x32_bf16 a[240:243], a[196:199], v[4:7], 0
    ds_write_b128 v231, v[20:23] offset:5120
    v_mul_f32 v210, v210, v203
    v_mul_f32 v211, v211, v203
    v_mfma_f32_16x16x32_bf16 a[244:247], a[196:199], v[8:11], 0
    v_mul_f32 v212, v212, v203
    v_mul_f32 v213, v213, v203
    v_mul_f32 v214, v214, v203
    v_mul_f32 v215, v215, v203
    v_cvt_pk_bf16_f32 v24, v208, v209
    v_cvt_pk_bf16_f32 v25, v210, v211
    v_cvt_pk_bf16_f32 v26, v212, v213
    v_cvt_pk_bf16_f32 v27, v214, v215
    v_accvgpr_read_b32 v216, a48
    v_accvgpr_read_b32 v217, a49
    v_accvgpr_read_b32 v218, a50
    v_accvgpr_read_b32 v219, a51
    v_accvgpr_read_b32 v220, a68
    v_accvgpr_read_b32 v221, a69
    v_accvgpr_read_b32 v222, a70
    v_accvgpr_read_b32 v223, a71
    v_mul_f32 v216, v216, v204
    v_mul_f32 v217, v217, v204
    v_mul_f32 v218, v218, v204
    v_mul_f32 v219, v219, v204
    v_mul_f32 v220, v220, v204
    v_mul_f32 v221, v221, v204
    v_mul_f32 v222, v222, v204
    v_mul_f32 v223, v223, v204
    v_cvt_pk_bf16_f32 v28, v216, v217
    v_cvt_pk_bf16_f32 v29, v218, v219
    v_cvt_pk_bf16_f32 v30, v220, v221
    v_cvt_pk_bf16_f32 v31, v222, v223
    v_accvgpr_read_b32 v208, a52
    v_accvgpr_read_b32 v209, a53
    v_accvgpr_read_b32 v210, a54
    v_accvgpr_read_b32 v211, a55
    v_accvgpr_read_b32 v212, a72
    v_accvgpr_read_b32 v213, a73
    v_accvgpr_read_b32 v214, a74
    v_accvgpr_read_b32 v215, a75
    v_mul_f32 v208, v208, v205
    v_mul_f32 v209, v209, v205
    v_mul_f32 v210, v210, v205
    v_mul_f32 v211, v211, v205
    v_mul_f32 v212, v212, v205
    v_mul_f32 v213, v213, v205
    v_mul_f32 v214, v214, v205
    v_mul_f32 v215, v215, v205
    v_cvt_pk_bf16_f32 v32, v208, v209
    v_cvt_pk_bf16_f32 v33, v210, v211
    v_cvt_pk_bf16_f32 v34, v212, v213
    v_cvt_pk_bf16_f32 v35, v214, v215
    v_accvgpr_read_b32 v216, a56
    v_accvgpr_read_b32 v217, a57
    v_accvgpr_read_b32 v218, a58
    v_accvgpr_read_b32 v219, a59
    v_accvgpr_read_b32 v220, a76
    v_accvgpr_read_b32 v221, a77
    v_accvgpr_read_b32 v222, a78
    v_accvgpr_read_b32 v223, a79
    v_mul_f32 v216, v216, v206
    v_mul_f32 v217, v217, v206
    v_mul_f32 v218, v218, v206
    v_mul_f32 v219, v219, v206
    v_mul_f32 v220, v220, v206
    v_mul_f32 v221, v221, v206
    v_mul_f32 v222, v222, v206
    v_mul_f32 v223, v223, v206
    v_cvt_pk_bf16_f32 v36, v216, v217
    v_cvt_pk_bf16_f32 v37, v218, v219
    v_cvt_pk_bf16_f32 v38, v220, v221
    v_cvt_pk_bf16_f32 v39, v222, v223
    v_mfma_f32_16x16x32_bf16 a[248:251], a[196:199], v[12:15], 0
    ds_write_b128 v231, v[24:27] offset:6144
    v_accvgpr_read_b32 v208, a80
    v_accvgpr_read_b32 v209, a81
    v_mfma_f32_16x16x32_bf16 a[252:255], a[196:199], v[16:19], 0
    s_waitcnt lgkmcnt(8)
    ds_write_b128 v231, v[28:31] offset:7168
    v_accvgpr_read_b32 v210, a82
    v_accvgpr_read_b32 v211, a83
    v_mfma_f32_16x16x32_bf16 a[0:3], a[200:203], v[20:23], a[0:3]
    ds_write_b128 v231, v[32:35] offset:8192
    v_accvgpr_read_b32 v212, a100
    v_accvgpr_read_b32 v213, a101
    v_mfma_f32_16x16x32_bf16 a[4:7], a[200:203], v[24:27], a[4:7]
    ds_write_b128 v231, v[36:39] offset:9216
    v_accvgpr_read_b32 v214, a102
    v_accvgpr_read_b32 v215, a103
    v_mfma_f32_16x16x32_bf16 a[8:11], a[200:203], v[28:31], a[8:11]
    v_mul_f32 v208, v208, v202
    v_mul_f32 v209, v209, v202
    v_mfma_f32_16x16x32_bf16 a[12:15], a[200:203], v[32:35], a[12:15]
    v_mul_f32 v210, v210, v202
    v_mul_f32 v211, v211, v202
    v_mfma_f32_16x16x32_bf16 a[16:19], a[200:203], v[36:39], a[16:19]
    v_mul_f32 v212, v212, v202
    v_mul_f32 v213, v213, v202
    s_waitcnt lgkmcnt(0)
    s_waitcnt vmcnt(12)
    s_barrier
    v_mfma_f32_16x16x32_bf16 a[20:23], a[204:207], v[20:23], a[20:23]
    s_add_u32 m0, s54, 131072
    ds_read_b64_tr_b16 a[184:185], v168 offset:16384
    v_mul_f32 v214, v214, v202
    v_mul_f32 v215, v215, v202
    v_mfma_f32_16x16x32_bf16 a[24:27], a[204:207], v[24:27], a[24:27]
    s_add_u32 s33, s53, 256
    ds_read_b64_tr_b16 a[186:187], v168 offset:18432
    v_cvt_pk_bf16_f32 v40, v208, v209
    v_cvt_pk_bf16_f32 v41, v210, v211
    v_mfma_f32_16x16x32_bf16 a[28:31], a[204:207], v[28:31], a[28:31]
    ds_read_b64_tr_b16 a[188:189], v169 offset:16384
    v_cvt_pk_bf16_f32 v42, v212, v213
    v_cvt_pk_bf16_f32 v43, v214, v215
    v_mfma_f32_16x16x32_bf16 a[32:35], a[204:207], v[32:35], a[32:35]
    ds_read_b64_tr_b16 a[190:191], v169 offset:18432
    v_accvgpr_read_b32 v216, a84
    v_accvgpr_read_b32 v217, a85
    v_mfma_f32_16x16x32_bf16 a[36:39], a[204:207], v[36:39], a[36:39]
    ds_read_b64_tr_b16 a[192:193], v170 offset:16384
    v_accvgpr_read_b32 v218, a86
    v_accvgpr_read_b32 v219, a87
    v_mfma_f32_16x16x32_bf16 a[216:219], a[208:211], v[20:23], a[216:219]
    ds_read_b64_tr_b16 a[194:195], v170 offset:18432
    v_accvgpr_read_b32 v220, a104
    v_accvgpr_read_b32 v221, a105
    v_mfma_f32_16x16x32_bf16 a[220:223], a[208:211], v[24:27], a[220:223]
    ds_write_b128 v231, v[40:43] offset:10240
    v_accvgpr_read_b32 v222, a106
    v_accvgpr_read_b32 v223, a107
    v_mfma_f32_16x16x32_bf16 a[224:227], a[208:211], v[28:31], a[224:227]
    buffer_load_dwordx4 v232, s[28:31], s33 offen offset:0  lds
    v_mfma_f32_16x16x32_bf16 a[228:231], a[208:211], v[32:35], a[228:231]
    buffer_load_dwordx4 v233, s[28:31], s33 offen offset:1024  lds
    v_mfma_f32_16x16x32_bf16 a[232:235], a[208:211], v[36:39], a[232:235]
    buffer_load_dwordx4 v234, s[28:31], s33 offen offset:2048  lds
    v_mfma_f32_16x16x32_bf16 a[236:239], a[212:215], v[20:23], a[236:239]
    buffer_load_dwordx4 v235, s[28:31], s33 offen offset:3072  lds
    v_mfma_f32_16x16x32_bf16 a[240:243], a[212:215], v[24:27], a[240:243]
    v_mul_f32 v216, v216, v203
    v_mul_f32 v217, v217, v203
    v_mfma_f32_16x16x32_bf16 a[244:247], a[212:215], v[28:31], a[244:247]
    v_mul_f32 v218, v218, v203
    v_mul_f32 v219, v219, v203
    v_mul_f32 v220, v220, v203
    v_mul_f32 v221, v221, v203
    v_mul_f32 v222, v222, v203
    v_mul_f32 v223, v223, v203
    v_cvt_pk_bf16_f32 v44, v216, v217
    v_cvt_pk_bf16_f32 v45, v218, v219
    v_cvt_pk_bf16_f32 v46, v220, v221
    v_cvt_pk_bf16_f32 v47, v222, v223
    v_accvgpr_read_b32 v208, a88
    v_accvgpr_read_b32 v209, a89
    v_accvgpr_read_b32 v210, a90
    v_accvgpr_read_b32 v211, a91
    v_accvgpr_read_b32 v212, a108
    v_accvgpr_read_b32 v213, a109
    v_accvgpr_read_b32 v214, a110
    v_accvgpr_read_b32 v215, a111
    v_mul_f32 v208, v208, v204
    v_mul_f32 v209, v209, v204
    v_mul_f32 v210, v210, v204
    v_mul_f32 v211, v211, v204
    v_mul_f32 v212, v212, v204
    v_mul_f32 v213, v213, v204
    v_mul_f32 v214, v214, v204
    v_mul_f32 v215, v215, v204
    v_cvt_pk_bf16_f32 v48, v208, v209
    v_cvt_pk_bf16_f32 v49, v210, v211
    v_cvt_pk_bf16_f32 v50, v212, v213
    v_cvt_pk_bf16_f32 v51, v214, v215
    v_accvgpr_read_b32 v216, a92
    v_accvgpr_read_b32 v217, a93
    v_accvgpr_read_b32 v218, a94
    v_accvgpr_read_b32 v219, a95
    v_accvgpr_read_b32 v220, a112
    v_accvgpr_read_b32 v221, a113
    v_accvgpr_read_b32 v222, a114
    v_accvgpr_read_b32 v223, a115
    v_mul_f32 v216, v216, v205
    v_mul_f32 v217, v217, v205
    v_mul_f32 v218, v218, v205
    v_mul_f32 v219, v219, v205
    v_mul_f32 v220, v220, v205
    v_mul_f32 v221, v221, v205
    v_mul_f32 v222, v222, v205
    v_mul_f32 v223, v223, v205
    v_cvt_pk_bf16_f32 v52, v216, v217
    v_cvt_pk_bf16_f32 v53, v218, v219
    v_cvt_pk_bf16_f32 v54, v220, v221
    v_cvt_pk_bf16_f32 v55, v222, v223
    v_accvgpr_read_b32 v208, a96
    v_accvgpr_read_b32 v209, a97
    v_accvgpr_read_b32 v210, a98
    v_accvgpr_read_b32 v211, a99
    v_accvgpr_read_b32 v212, a116
    v_accvgpr_read_b32 v213, a117
    v_accvgpr_read_b32 v214, a118
    v_accvgpr_read_b32 v215, a119
    v_mul_f32 v208, v208, v206
    v_mul_f32 v209, v209, v206
    v_mul_f32 v210, v210, v206
    v_mul_f32 v211, v211, v206
    v_mul_f32 v212, v212, v206
    v_mul_f32 v213, v213, v206
    v_mul_f32 v214, v214, v206
    v_mul_f32 v215, v215, v206
    v_cvt_pk_bf16_f32 v56, v208, v209
    v_cvt_pk_bf16_f32 v57, v210, v211
    v_cvt_pk_bf16_f32 v58, v212, v213
    v_cvt_pk_bf16_f32 v59, v214, v215
    v_mfma_f32_16x16x32_bf16 a[248:251], a[212:215], v[32:35], a[248:251]
    ds_write_b128 v231, v[44:47] offset:11264
    v_accvgpr_read_b32 v216, a120
    v_accvgpr_read_b32 v217, a121
    v_mfma_f32_16x16x32_bf16 a[252:255], a[212:215], v[36:39], a[252:255]
    s_waitcnt lgkmcnt(6)
    ds_write_b128 v231, v[48:51] offset:12288
    v_accvgpr_read_b32 v218, a122
    v_accvgpr_read_b32 v219, a123
    v_mfma_f32_16x16x32_bf16 a[0:3], a[184:187], v[40:43], a[0:3]
    ds_read_b64_tr_b16 a[196:197], v171 offset:16384
    v_accvgpr_read_b32 v220, a140
    v_accvgpr_read_b32 v221, a141
    v_mfma_f32_16x16x32_bf16 a[4:7], a[184:187], v[44:47], a[4:7]
    ds_read_b64_tr_b16 a[198:199], v171 offset:18432
    v_accvgpr_read_b32 v222, a142
    v_accvgpr_read_b32 v223, a143
    v_mfma_f32_16x16x32_bf16 a[8:11], a[184:187], v[48:51], a[8:11]
    ds_write_b128 v231, v[52:55] offset:13312
    v_mul_f32 v216, v216, v202
    v_mul_f32 v217, v217, v202
    v_mfma_f32_16x16x32_bf16 a[12:15], a[184:187], v[52:55], a[12:15]
    ds_write_b128 v231, v[56:59] offset:14336
    v_mul_f32 v218, v218, v202
    v_mul_f32 v219, v219, v202
    v_mfma_f32_16x16x32_bf16 a[16:19], a[184:187], v[56:59], a[16:19]
    s_waitcnt lgkmcnt(9)
    v_mul_f32 v220, v220, v202
    v_mul_f32 v221, v221, v202
    v_mfma_f32_16x16x32_bf16 a[20:23], a[188:191], v[40:43], a[20:23]
    ds_read_b64_tr_b16 a[200:201], v168 offset:20480
    v_mul_f32 v222, v222, v202
    v_mul_f32 v223, v223, v202
    v_mfma_f32_16x16x32_bf16 a[24:27], a[188:191], v[44:47], a[24:27]
    ds_read_b64_tr_b16 a[202:203], v168 offset:22528
    v_cvt_pk_bf16_f32 v60, v216, v217
    v_cvt_pk_bf16_f32 v61, v218, v219
    v_mfma_f32_16x16x32_bf16 a[28:31], a[188:191], v[48:51], a[28:31]
    v_cvt_pk_bf16_f32 v62, v220, v221
    v_cvt_pk_bf16_f32 v63, v222, v223
    v_mfma_f32_16x16x32_bf16 a[32:35], a[188:191], v[52:55], a[32:35]
    ds_write_b128 v231, v[60:63] offset:15360
    v_accvgpr_read_b32 v208, a124
    v_accvgpr_read_b32 v209, a125
    v_mfma_f32_16x16x32_bf16 a[36:39], a[188:191], v[56:59], a[36:39]
    s_waitcnt lgkmcnt(10)
    v_accvgpr_read_b32 v210, a126
    v_accvgpr_read_b32 v211, a127
    v_mfma_f32_16x16x32_bf16 a[216:219], a[192:195], v[40:43], a[216:219]
    ds_read_b64_tr_b16 a[204:205], v169 offset:20480
    v_accvgpr_read_b32 v212, a144
    v_accvgpr_read_b32 v213, a145
    v_mfma_f32_16x16x32_bf16 a[220:223], a[192:195], v[44:47], a[220:223]
    ds_read_b64_tr_b16 a[206:207], v169 offset:22528
    v_accvgpr_read_b32 v214, a146
    v_accvgpr_read_b32 v215, a147
    v_mfma_f32_16x16x32_bf16 a[224:227], a[192:195], v[48:51], a[224:227]
    ds_read_b64_tr_b16 a[208:209], v170 offset:20480
    v_mul_f32 v208, v208, v203
    v_mul_f32 v209, v209, v203
    v_mfma_f32_16x16x32_bf16 a[228:231], a[192:195], v[52:55], a[228:231]
    ds_read_b64_tr_b16 a[210:211], v170 offset:22528
    v_mul_f32 v210, v210, v203
    v_mul_f32 v211, v211, v203
    v_mfma_f32_16x16x32_bf16 a[232:235], a[192:195], v[56:59], a[232:235]
    s_waitcnt lgkmcnt(9)
    ds_read_b64_tr_b16 a[212:213], v171 offset:20480
    v_mul_f32 v212, v212, v203
    v_mul_f32 v213, v213, v203
    v_mfma_f32_16x16x32_bf16 a[236:239], a[196:199], v[40:43], a[236:239]
    ds_read_b64_tr_b16 a[214:215], v171 offset:22528
    v_mul_f32 v214, v214, v203
    v_mul_f32 v215, v215, v203
    v_mfma_f32_16x16x32_bf16 a[240:243], a[196:199], v[44:47], a[240:243]
    v_cvt_pk_bf16_f32 v64, v208, v209
    v_cvt_pk_bf16_f32 v65, v210, v211
    v_mfma_f32_16x16x32_bf16 a[244:247], a[196:199], v[48:51], a[244:247]
    v_cvt_pk_bf16_f32 v66, v212, v213
    v_cvt_pk_bf16_f32 v67, v214, v215
    v_accvgpr_read_b32 v216, a128
    v_accvgpr_read_b32 v217, a129
    v_accvgpr_read_b32 v218, a130
    v_accvgpr_read_b32 v219, a131
    v_accvgpr_read_b32 v220, a148
    v_accvgpr_read_b32 v221, a149
    v_accvgpr_read_b32 v222, a150
    v_accvgpr_read_b32 v223, a151
    v_mul_f32 v216, v216, v204
    v_mul_f32 v217, v217, v204
    v_mul_f32 v218, v218, v204
    v_mul_f32 v219, v219, v204
    v_mul_f32 v220, v220, v204
    v_mul_f32 v221, v221, v204
    v_mul_f32 v222, v222, v204
    v_mul_f32 v223, v223, v204
    v_cvt_pk_bf16_f32 v68, v216, v217
    v_cvt_pk_bf16_f32 v69, v218, v219
    v_cvt_pk_bf16_f32 v70, v220, v221
    v_cvt_pk_bf16_f32 v71, v222, v223
    v_accvgpr_read_b32 v208, a132
    v_accvgpr_read_b32 v209, a133
    v_accvgpr_read_b32 v210, a134
    v_accvgpr_read_b32 v211, a135
    v_accvgpr_read_b32 v212, a152
    v_accvgpr_read_b32 v213, a153
    v_accvgpr_read_b32 v214, a154
    v_accvgpr_read_b32 v215, a155
    v_mul_f32 v208, v208, v205
    v_mul_f32 v209, v209, v205
    v_mul_f32 v210, v210, v205
    v_mul_f32 v211, v211, v205
    v_mul_f32 v212, v212, v205
    v_mul_f32 v213, v213, v205
    v_mul_f32 v214, v214, v205
    v_mul_f32 v215, v215, v205
    v_cvt_pk_bf16_f32 v72, v208, v209
    v_cvt_pk_bf16_f32 v73, v210, v211
    v_cvt_pk_bf16_f32 v74, v212, v213
    v_cvt_pk_bf16_f32 v75, v214, v215
    v_accvgpr_read_b32 v216, a136
    v_accvgpr_read_b32 v217, a137
    v_accvgpr_read_b32 v218, a138
    v_accvgpr_read_b32 v219, a139
    v_accvgpr_read_b32 v220, a156
    v_accvgpr_read_b32 v221, a157
    v_accvgpr_read_b32 v222, a158
    v_accvgpr_read_b32 v223, a159
    v_mul_f32 v216, v216, v206
    v_mul_f32 v217, v217, v206
    v_mul_f32 v218, v218, v206
    v_mul_f32 v219, v219, v206
    v_mul_f32 v220, v220, v206
    v_mul_f32 v221, v221, v206
    v_mul_f32 v222, v222, v206
    v_mul_f32 v223, v223, v206
    v_cvt_pk_bf16_f32 v76, v216, v217
    v_cvt_pk_bf16_f32 v77, v218, v219
    v_cvt_pk_bf16_f32 v78, v220, v221
    v_cvt_pk_bf16_f32 v79, v222, v223
    v_mfma_f32_16x16x32_bf16 a[248:251], a[196:199], v[52:55], a[248:251]
    ds_write_b128 v231, v[64:67] offset:16384
    v_mfma_f32_16x16x32_bf16 a[252:255], a[196:199], v[56:59], a[252:255]
    s_waitcnt lgkmcnt(8)
    ds_write_b128 v231, v[68:71] offset:17408
    v_mfma_f32_16x16x32_bf16 a[0:3], a[200:203], v[60:63], a[0:3]
    ds_write_b128 v231, v[72:75] offset:18432
    v_mfma_f32_16x16x32_bf16 a[4:7], a[200:203], v[64:67], a[4:7]
    ds_write_b128 v231, v[76:79] offset:19456
    v_mfma_f32_16x16x32_bf16 a[8:11], a[200:203], v[68:71], a[8:11]
    v_mfma_f32_16x16x32_bf16 a[12:15], a[200:203], v[72:75], a[12:15]
    v_mfma_f32_16x16x32_bf16 a[16:19], a[200:203], v[76:79], a[16:19]
    s_waitcnt lgkmcnt(0)
    s_waitcnt vmcnt(8)
    s_barrier
    v_mfma_f32_16x16x32_bf16 a[20:23], a[204:207], v[60:63], a[20:23]
    s_add_u32 m0, s54, 147456
    ds_read_b64_tr_b16 a[184:185], v164 offset:32768
    v_add_u32 v231, s55, v231
    v_mfma_f32_16x16x32_bf16 a[24:27], a[204:207], v[64:67], a[24:27]
    s_add_u32 s33, s53, 65792
    ds_read_b64_tr_b16 a[186:187], v164 offset:34816
    v_mfma_f32_16x16x32_bf16 a[28:31], a[204:207], v[68:71], a[28:31]
    ds_read_b64_tr_b16 a[188:189], v165 offset:32768
    v_mfma_f32_16x16x32_bf16 a[32:35], a[204:207], v[72:75], a[32:35]
    ds_read_b64_tr_b16 a[190:191], v165 offset:34816
    v_mfma_f32_16x16x32_bf16 a[36:39], a[204:207], v[76:79], a[36:39]
    ds_read_b64_tr_b16 a[192:193], v166 offset:32768
    v_mfma_f32_16x16x32_bf16 a[216:219], a[208:211], v[60:63], a[216:219]
    ds_read_b64_tr_b16 a[194:195], v166 offset:34816
    v_mfma_f32_16x16x32_bf16 a[220:223], a[208:211], v[64:67], a[220:223]
    ds_read_b128 v[80:83], v231 offset:0
    v_mfma_f32_16x16x32_bf16 a[224:227], a[208:211], v[68:71], a[224:227]
    ds_read_b128 v[84:87], v231 offset:1024
    v_mfma_f32_16x16x32_bf16 a[228:231], a[208:211], v[72:75], a[228:231]
    ds_read_b128 v[88:91], v231 offset:2048
    ds_read_b128 v[92:95], v231 offset:3072
    ds_read_b128 v[96:99], v231 offset:4096
    ds_read_b128 v[100:103], v231 offset:5120
    ds_read_b128 v[104:107], v231 offset:6144
    ds_read_b128 v[108:111], v231 offset:7168
    ds_read_b128 v[112:115], v231 offset:8192
    ds_read_b128 v[116:119], v231 offset:9216
    v_mfma_f32_16x16x32_bf16 a[232:235], a[208:211], v[76:79], a[232:235]
    ds_read_b128 v[120:123], v231 offset:10240
    v_mfma_f32_16x16x32_bf16 a[236:239], a[212:215], v[60:63], a[236:239]
    ds_read_b128 v[124:127], v231 offset:11264
    v_mfma_f32_16x16x32_bf16 a[240:243], a[212:215], v[64:67], a[240:243]
    ds_read_b128 v[128:131], v231 offset:12288
    v_mfma_f32_16x16x32_bf16 a[244:247], a[212:215], v[68:71], a[244:247]
    ds_read_b128 v[132:135], v231 offset:13312
    v_mfma_f32_16x16x32_bf16 a[248:251], a[212:215], v[72:75], a[248:251]
    ds_read_b128 v[136:139], v231 offset:14336
    v_mfma_f32_16x16x32_bf16 a[252:255], a[212:215], v[76:79], a[252:255]
    s_waitcnt lgkmcnt(14)
    ds_read_b128 v[140:143], v231 offset:15360
    v_mfma_f32_16x16x32_bf16 a[0:3], a[184:187], v[80:83], a[0:3]
    s_waitcnt lgkmcnt(14)
    ds_read_b64_tr_b16 a[196:197], v167 offset:32768
    v_med3_f32 v224, v202, s66, v225
    v_mfma_f32_16x16x32_bf16 a[4:7], a[184:187], v[84:87], a[4:7]
    s_waitcnt lgkmcnt(14)
    ds_read_b64_tr_b16 a[198:199], v167 offset:34816
    v_cmp_neq_f32 s[62:63], v224, v202
    v_mfma_f32_16x16x32_bf16 a[8:11], a[184:187], v[88:91], a[8:11]
    s_waitcnt lgkmcnt(14)
    ds_read_b128 v[144:147], v231 offset:16384
    v_mfma_f32_16x16x32_bf16 a[12:15], a[184:187], v[92:95], a[12:15]
    s_waitcnt lgkmcnt(14)
    ds_read_b128 v[148:151], v231 offset:17408
    v_mfma_f32_16x16x32_bf16 a[16:19], a[184:187], v[96:99], a[16:19]
    s_nop 1
    ds_read_b128 v[152:155], v231 offset:18432
    v_mfma_f32_16x16x32_bf16 a[20:23], a[188:191], v[80:83], a[20:23]
    s_or_b64 s[64:65], s[64:65], s[62:63]
    ds_read_b64_tr_b16 a[200:201], v164 offset:36864
    v_med3_f32 v224, v203, s66, v225
    v_mfma_f32_16x16x32_bf16 a[24:27], a[188:191], v[84:87], a[24:27]
    ds_read_b64_tr_b16 a[202:203], v164 offset:38912
    v_cmp_neq_f32 s[62:63], v224, v203
    v_mfma_f32_16x16x32_bf16 a[28:31], a[188:191], v[88:91], a[28:31]
    s_nop 1
    ds_read_b128 v[156:159], v231 offset:19456
    v_mfma_f32_16x16x32_bf16 a[32:35], a[188:191], v[92:95], a[32:35]
    s_or_b64 s[64:65], s[64:65], s[62:63]
    buffer_load_dwordx4 v232, s[28:31], s33 offen offset:0  lds
    v_mfma_f32_16x16x32_bf16 a[36:39], a[188:191], v[96:99], a[36:39]
    buffer_load_dwordx4 v233, s[28:31], s33 offen offset:1024  lds
    v_mfma_f32_16x16x32_bf16 a[216:219], a[192:195], v[80:83], a[216:219]
    ds_read_b64_tr_b16 a[204:205], v165 offset:36864
    v_med3_f32 v224, v204, s66, v225
    v_mfma_f32_16x16x32_bf16 a[220:223], a[192:195], v[84:87], a[220:223]
    ds_read_b64_tr_b16 a[206:207], v165 offset:38912
    v_cmp_neq_f32 s[62:63], v224, v204
    v_mfma_f32_16x16x32_bf16 a[224:227], a[192:195], v[88:91], a[224:227]
    s_nop 1
    ds_read_b64_tr_b16 a[208:209], v166 offset:36864
    v_mfma_f32_16x16x32_bf16 a[228:231], a[192:195], v[92:95], a[228:231]
    s_or_b64 s[64:65], s[64:65], s[62:63]
    ds_read_b64_tr_b16 a[210:211], v166 offset:38912
    v_med3_f32 v224, v205, s66, v225
    v_mfma_f32_16x16x32_bf16 a[232:235], a[192:195], v[96:99], a[232:235]
    s_waitcnt lgkmcnt(10)
    ds_read_b64_tr_b16 a[212:213], v167 offset:36864
    v_cmp_neq_f32 s[62:63], v224, v205
    v_mfma_f32_16x16x32_bf16 a[236:239], a[196:199], v[80:83], a[236:239]
    s_nop 1
    ds_read_b64_tr_b16 a[214:215], v167 offset:38912
    v_mfma_f32_16x16x32_bf16 a[240:243], a[196:199], v[84:87], a[240:243]
    s_or_b64 s[64:65], s[64:65], s[62:63]
    buffer_load_dwordx4 v234, s[28:31], s33 offen offset:2048  lds
    v_mfma_f32_16x16x32_bf16 a[244:247], a[196:199], v[88:91], a[244:247]
    buffer_load_dwordx4 v235, s[28:31], s33 offen offset:3072  lds
    v_mfma_f32_16x16x32_bf16 a[248:251], a[196:199], v[92:95], a[248:251]
    v_med3_f32 v224, v206, s66, v225
    v_mfma_f32_16x16x32_bf16 a[252:255], a[196:199], v[96:99], a[252:255]
    s_waitcnt lgkmcnt(7)
    v_cmp_neq_f32 s[62:63], v224, v206
    v_mfma_f32_16x16x32_bf16 a[0:3], a[200:203], v[100:103], a[0:3]
    s_nop 1
    s_or_b64 s[64:65], s[64:65], s[62:63]
    v_mfma_f32_16x16x32_bf16 a[4:7], a[200:203], v[104:107], a[4:7]
    v_mfma_f32_16x16x32_bf16 a[8:11], a[200:203], v[108:111], a[8:11]
    v_mfma_f32_16x16x32_bf16 a[12:15], a[200:203], v[112:115], a[12:15]
    v_mfma_f32_16x16x32_bf16 a[16:19], a[200:203], v[116:119], a[16:19]
    s_waitcnt lgkmcnt(0)
    s_barrier
    v_mfma_f32_16x16x32_bf16 a[20:23], a[204:207], v[100:103], a[20:23]
    s_add_u32 m0, s54, 0
    ds_read_b64_tr_b16 a[184:185], v164 offset:16384
    v_mfma_f32_16x16x32_bf16 a[24:27], a[204:207], v[104:107], a[24:27]
    s_add_u32 s33, s52, 65664
    ds_read_b64_tr_b16 a[186:187], v164 offset:18432
    v_mfma_f32_16x16x32_bf16 a[28:31], a[204:207], v[108:111], a[28:31]
    ds_read_b64_tr_b16 a[188:189], v165 offset:16384
    v_mfma_f32_16x16x32_bf16 a[32:35], a[204:207], v[112:115], a[32:35]
    ds_read_b64_tr_b16 a[190:191], v165 offset:18432
    v_mfma_f32_16x16x32_bf16 a[36:39], a[204:207], v[116:119], a[36:39]
    ds_read_b64_tr_b16 a[192:193], v166 offset:16384
    v_mfma_f32_16x16x32_bf16 a[216:219], a[208:211], v[100:103], a[216:219]
    ds_read_b64_tr_b16 a[194:195], v166 offset:18432
    v_mfma_f32_16x16x32_bf16 a[220:223], a[208:211], v[104:107], a[220:223]
    buffer_load_dwordx4 v232, s[28:31], s33 offen offset:0  lds
    v_mfma_f32_16x16x32_bf16 a[224:227], a[208:211], v[108:111], a[224:227]
    buffer_load_dwordx4 v233, s[28:31], s33 offen offset:1024  lds
    v_mfma_f32_16x16x32_bf16 a[228:231], a[208:211], v[112:115], a[228:231]
    buffer_load_dwordx4 v234, s[28:31], s33 offen offset:2048  lds
    v_mfma_f32_16x16x32_bf16 a[232:235], a[208:211], v[116:119], a[232:235]
    buffer_load_dwordx4 v235, s[28:31], s33 offen offset:3072  lds
    v_mfma_f32_16x16x32_bf16 a[236:239], a[212:215], v[100:103], a[236:239]
    s_add_u32 m0, s54, 16384
    s_add_u32 s33, s53, 128
    v_mfma_f32_16x16x32_bf16 a[240:243], a[212:215], v[104:107], a[240:243]
    buffer_load_dwordx4 v232, s[28:31], s33 offen offset:0  lds
    v_mfma_f32_16x16x32_bf16 a[244:247], a[212:215], v[108:111], a[244:247]
    buffer_load_dwordx4 v233, s[28:31], s33 offen offset:1024  lds
    v_mfma_f32_16x16x32_bf16 a[248:251], a[212:215], v[112:115], a[248:251]
    buffer_load_dwordx4 v234, s[28:31], s33 offen offset:2048  lds
    v_mfma_f32_16x16x32_bf16 a[252:255], a[212:215], v[116:119], a[252:255]
    s_waitcnt lgkmcnt(4)
    buffer_load_dwordx4 v235, s[28:31], s33 offen offset:3072  lds
    v_mfma_f32_16x16x32_bf16 a[0:3], a[184:187], v[120:123], a[0:3]
    ds_read_b64_tr_b16 a[196:197], v167 offset:16384
    v_mfma_f32_16x16x32_bf16 a[4:7], a[184:187], v[124:127], a[4:7]
    s_add_u32 m0, s54, 32768
    ds_read_b64_tr_b16 a[198:199], v167 offset:18432
    v_mfma_f32_16x16x32_bf16 a[8:11], a[184:187], v[128:131], a[8:11]
    s_add_u32 s33, s53, 65664
    buffer_load_dwordx4 v232, s[28:31], s33 offen offset:0  lds
    v_mfma_f32_16x16x32_bf16 a[12:15], a[184:187], v[132:135], a[12:15]
    buffer_load_dwordx4 v233, s[28:31], s33 offen offset:1024  lds
    v_mfma_f32_16x16x32_bf16 a[16:19], a[184:187], v[136:139], a[16:19]
    s_waitcnt lgkmcnt(4)
    v_mfma_f32_16x16x32_bf16 a[20:23], a[188:191], v[120:123], a[20:23]
    ds_read_b64_tr_b16 a[200:201], v164 offset:20480
    v_mfma_f32_16x16x32_bf16 a[24:27], a[188:191], v[124:127], a[24:27]
    ds_read_b64_tr_b16 a[202:203], v164 offset:22528
    v_mfma_f32_16x16x32_bf16 a[28:31], a[188:191], v[128:131], a[28:31]
    buffer_load_dwordx4 v234, s[28:31], s33 offen offset:2048  lds
    v_mfma_f32_16x16x32_bf16 a[32:35], a[188:191], v[132:135], a[32:35]
    buffer_load_dwordx4 v235, s[28:31], s33 offen offset:3072  lds
    v_mfma_f32_16x16x32_bf16 a[36:39], a[188:191], v[136:139], a[36:39]
    s_waitcnt lgkmcnt(4)
    s_add_u32 m0, s54, 49152
    s_add_u32 s33, s52, 256
    v_mfma_f32_16x16x32_bf16 a[216:219], a[192:195], v[120:123], a[216:219]
    ds_read_b64_tr_b16 a[204:205], v165 offset:20480
    v_mfma_f32_16x16x32_bf16 a[220:223], a[192:195], v[124:127], a[220:223]
    ds_read_b64_tr_b16 a[206:207], v165 offset:22528
    v_mfma_f32_16x16x32_bf16 a[224:227], a[192:195], v[128:131], a[224:227]
    ds_read_b64_tr_b16 a[208:209], v166 offset:20480
    v_mfma_f32_16x16x32_bf16 a[228:231], a[192:195], v[132:135], a[228:231]
    ds_read_b64_tr_b16 a[210:211], v166 offset:22528
    v_mfma_f32_16x16x32_bf16 a[232:235], a[192:195], v[136:139], a[232:235]
    s_waitcnt lgkmcnt(6)
    ds_read_b64_tr_b16 a[212:213], v167 offset:20480
    v_mfma_f32_16x16x32_bf16 a[236:239], a[196:199], v[120:123], a[236:239]
    ds_read_b64_tr_b16 a[214:215], v167 offset:22528
    v_mfma_f32_16x16x32_bf16 a[240:243], a[196:199], v[124:127], a[240:243]
    buffer_load_dwordx4 v232, s[28:31], s33 offen offset:0  lds
    v_mfma_f32_16x16x32_bf16 a[244:247], a[196:199], v[128:131], a[244:247]
    buffer_load_dwordx4 v233, s[28:31], s33 offen offset:1024  lds
    v_mfma_f32_16x16x32_bf16 a[248:251], a[196:199], v[132:135], a[248:251]
    buffer_load_dwordx4 v234, s[28:31], s33 offen offset:2048  lds
    v_mfma_f32_16x16x32_bf16 a[252:255], a[196:199], v[136:139], a[252:255]
    s_waitcnt lgkmcnt(6)
    buffer_load_dwordx4 v235, s[28:31], s33 offen offset:3072  lds
    v_mfma_f32_16x16x32_bf16 a[0:3], a[200:203], v[140:143], a[0:3]
    s_add_u32 m0, s54, 65536
    s_add_u32 s33, s52, 65792
    v_mfma_f32_16x16x32_bf16 a[4:7], a[200:203], v[144:147], a[4:7]
    buffer_load_dwordx4 v232, s[28:31], s33 offen offset:0  lds
    v_mfma_f32_16x16x32_bf16 a[8:11], a[200:203], v[148:151], a[8:11]
    buffer_load_dwordx4 v233, s[28:31], s33 offen offset:1024  lds
    v_mfma_f32_16x16x32_bf16 a[12:15], a[200:203], v[152:155], a[12:15]
    buffer_load_dwordx4 v234, s[28:31], s33 offen offset:2048  lds
    v_mfma_f32_16x16x32_bf16 a[16:19], a[200:203], v[156:159], a[16:19]
    buffer_load_dwordx4 v235, s[28:31], s33 offen offset:3072  lds
    s_waitcnt lgkmcnt(0)
    s_waitcnt vmcnt(28)
    s_barrier
    v_mfma_f32_16x16x32_bf16 a[20:23], a[204:207], v[140:143], a[20:23]
    s_add_u32 m0, s54, 98304
    ds_read_b64_tr_b16 a[184:185], v164 offset:49152
    v_mfma_f32_16x16x32_bf16 a[24:27], a[204:207], v[144:147], a[24:27]
    s_add_u32 s33, s52, 384
    ds_read_b64_tr_b16 a[186:187], v164 offset:51200
    v_mfma_f32_16x16x32_bf16 a[28:31], a[204:207], v[148:151], a[28:31]
    ds_read_b64_tr_b16 a[188:189], v165 offset:49152
    v_mfma_f32_16x16x32_bf16 a[32:35], a[204:207], v[152:155], a[32:35]
    ds_read_b64_tr_b16 a[190:191], v165 offset:51200
    v_mfma_f32_16x16x32_bf16 a[36:39], a[204:207], v[156:159], a[36:39]
    ds_read_b64_tr_b16 a[192:193], v166 offset:49152
    v_mfma_f32_16x16x32_bf16 a[216:219], a[208:211], v[140:143], a[216:219]
    ds_read_b64_tr_b16 a[194:195], v166 offset:51200
    v_mfma_f32_16x16x32_bf16 a[220:223], a[208:211], v[144:147], a[220:223]
    buffer_load_dwordx4 v232, s[28:31], s33 offen offset:0  lds
    v_mfma_f32_16x16x32_bf16 a[224:227], a[208:211], v[148:151], a[224:227]
    buffer_load_dwordx4 v233, s[28:31], s33 offen offset:1024  lds
    v_mfma_f32_16x16x32_bf16 a[228:231], a[208:211], v[152:155], a[228:231]
    buffer_load_dwordx4 v234, s[28:31], s33 offen offset:2048  lds
    v_mfma_f32_16x16x32_bf16 a[232:235], a[208:211], v[156:159], a[232:235]
    buffer_load_dwordx4 v235, s[28:31], s33 offen offset:3072  lds
    v_mfma_f32_16x16x32_bf16 a[236:239], a[212:215], v[140:143], a[236:239]
    s_add_u32 m0, s54, 81920
    s_add_u32 s33, s52, 65920
    v_mfma_f32_16x16x32_bf16 a[240:243], a[212:215], v[144:147], a[240:243]
    buffer_load_dwordx4 v232, s[28:31], s33 offen offset:0  lds
    v_mfma_f32_16x16x32_bf16 a[244:247], a[212:215], v[148:151], a[244:247]
    buffer_load_dwordx4 v233, s[28:31], s33 offen offset:1024  lds
    v_mfma_f32_16x16x32_bf16 a[248:251], a[212:215], v[152:155], a[248:251]
    buffer_load_dwordx4 v234, s[28:31], s33 offen offset:2048  lds
    v_mfma_f32_16x16x32_bf16 a[252:255], a[212:215], v[156:159], a[252:255]
    s_waitcnt lgkmcnt(4)
    buffer_load_dwordx4 v235, s[28:31], s33 offen offset:3072  lds
    v_mfma_f32_16x16x32_bf16 a[80:83], a[184:187], v[0:3], 0
    ds_read_b64_tr_b16 a[196:197], v167 offset:49152
    v_mfma_f32_16x16x32_bf16 a[84:87], a[184:187], v[4:7], 0
    ds_read_b64_tr_b16 a[198:199], v167 offset:51200
    v_mfma_f32_16x16x32_bf16 a[88:91], a[184:187], v[8:11], 0
    v_mfma_f32_16x16x32_bf16 a[92:95], a[184:187], v[12:15], 0
    v_mfma_f32_16x16x32_bf16 a[96:99], a[184:187], v[16:19], 0
    s_waitcnt lgkmcnt(4)
    v_mfma_f32_16x16x32_bf16 a[100:103], a[188:191], v[0:3], 0
    ds_read_b64_tr_b16 a[200:201], v164 offset:53248
    v_mfma_f32_16x16x32_bf16 a[104:107], a[188:191], v[4:7], 0
    ds_read_b64_tr_b16 a[202:203], v164 offset:55296
    v_accvgpr_read_b32 v208, a0
    v_mfma_f32_16x16x32_bf16 a[108:111], a[188:191], v[8:11], 0
    v_accvgpr_read_b32 v209, a1
    v_mfma_f32_16x16x32_bf16 a[112:115], a[188:191], v[12:15], 0
    v_accvgpr_read_b32 v210, a2
    v_mfma_f32_16x16x32_bf16 a[116:119], a[188:191], v[16:19], 0
    s_waitcnt lgkmcnt(4)
    v_accvgpr_read_b32 v211, a3
    v_mfma_f32_16x16x32_bf16 a[120:123], a[192:195], v[0:3], 0
    ds_read_b64_tr_b16 a[204:205], v165 offset:53248
    v_accvgpr_read_b32 v212, a20
    v_mfma_f32_16x16x32_bf16 a[124:127], a[192:195], v[4:7], 0
    ds_read_b64_tr_b16 a[206:207], v165 offset:55296
    v_accvgpr_read_b32 v213, a21
    v_mfma_f32_16x16x32_bf16 a[128:131], a[192:195], v[8:11], 0
    ds_read_b64_tr_b16 a[208:209], v166 offset:53248
    v_accvgpr_read_b32 v214, a22
    v_mfma_f32_16x16x32_bf16 a[132:135], a[192:195], v[12:15], 0
    ds_read_b64_tr_b16 a[210:211], v166 offset:55296
    v_accvgpr_read_b32 v215, a23
    v_mfma_f32_16x16x32_bf16 a[136:139], a[192:195], v[16:19], 0
    s_waitcnt lgkmcnt(6)
    ds_read_b64_tr_b16 a[212:213], v167 offset:53248
    v_cvt_pk_bf16_f32 v216, v208, v209
    v_mfma_f32_16x16x32_bf16 a[140:143], a[196:199], v[0:3], 0
    ds_read_b64_tr_b16 a[214:215], v167 offset:55296
    v_cvt_pk_bf16_f32 v217, v210, v211
    v_mfma_f32_16x16x32_bf16 a[144:147], a[196:199], v[4:7], 0
    v_cvt_pk_bf16_f32 v218, v212, v213
    v_mfma_f32_16x16x32_bf16 a[148:151], a[196:199], v[8:11], 0
    v_cvt_pk_bf16_f32 v219, v214, v215
    v_mfma_f32_16x16x32_bf16 a[152:155], a[196:199], v[12:15], 0
    s_mov_b32 s32, 0
    buffer_store_dwordx4 v[216:219], v207, s[24:27], s32 offen sc1
    v_mfma_f32_16x16x32_bf16 a[156:159], a[196:199], v[16:19], 0
    s_waitcnt lgkmcnt(6)
    v_accvgpr_read_b32 v220, a4
    v_mfma_f32_16x16x32_bf16 a[80:83], a[200:203], v[20:23], a[80:83]
    v_accvgpr_read_b32 v221, a5
    v_mfma_f32_16x16x32_bf16 a[84:87], a[200:203], v[24:27], a[84:87]
    v_accvgpr_read_b32 v222, a6
    v_mfma_f32_16x16x32_bf16 a[88:91], a[200:203], v[28:31], a[88:91]
    v_accvgpr_read_b32 v223, a7
    v_mfma_f32_16x16x32_bf16 a[92:95], a[200:203], v[32:35], a[92:95]
    v_accvgpr_read_b32 v224, a24
    v_mfma_f32_16x16x32_bf16 a[96:99], a[200:203], v[36:39], a[96:99]
    v_accvgpr_read_b32 v225, a25
    s_waitcnt lgkmcnt(0)
    s_waitcnt vmcnt(25)
    s_barrier
    v_mfma_f32_16x16x32_bf16 a[100:103], a[204:207], v[20:23], a[100:103]
    s_add_u32 m0, s54, 114688
    ds_read_b64_tr_b16 a[184:185], v160 offset:0
    v_accvgpr_read_b32 v226, a26
    v_mfma_f32_16x16x32_bf16 a[104:107], a[204:207], v[24:27], a[104:107]
    s_add_u32 s33, s53, 384
    ds_read_b64_tr_b16 a[186:187], v160 offset:2048
    v_accvgpr_read_b32 v227, a27
    v_mfma_f32_16x16x32_bf16 a[108:111], a[204:207], v[28:31], a[108:111]
    ds_read_b64_tr_b16 a[188:189], v161 offset:0
    v_cvt_pk_bf16_f32 v228, v220, v221
    v_mfma_f32_16x16x32_bf16 a[112:115], a[204:207], v[32:35], a[112:115]
    ds_read_b64_tr_b16 a[190:191], v161 offset:2048
    v_cvt_pk_bf16_f32 v229, v222, v223
    v_mfma_f32_16x16x32_bf16 a[116:119], a[204:207], v[36:39], a[116:119]
    ds_read_b64_tr_b16 a[192:193], v162 offset:0
    v_cvt_pk_bf16_f32 v230, v224, v225
    v_mfma_f32_16x16x32_bf16 a[120:123], a[208:211], v[20:23], a[120:123]
    ds_read_b64_tr_b16 a[194:195], v162 offset:2048
    v_cvt_pk_bf16_f32 v231, v226, v227
    v_mfma_f32_16x16x32_bf16 a[124:127], a[208:211], v[24:27], a[124:127]
    s_mov_b32 s32, 1024
    buffer_load_dwordx4 v232, s[28:31], s33 offen offset:0  lds
    v_mfma_f32_16x16x32_bf16 a[128:131], a[208:211], v[28:31], a[128:131]
    buffer_load_dwordx4 v233, s[28:31], s33 offen offset:1024  lds
    v_mfma_f32_16x16x32_bf16 a[132:135], a[208:211], v[32:35], a[132:135]
    buffer_load_dwordx4 v234, s[28:31], s33 offen offset:2048  lds
    v_mfma_f32_16x16x32_bf16 a[136:139], a[208:211], v[36:39], a[136:139]
    buffer_load_dwordx4 v235, s[28:31], s33 offen offset:3072  lds
    v_mfma_f32_16x16x32_bf16 a[140:143], a[212:215], v[20:23], a[140:143]
    buffer_store_dwordx4 v[228:231], v207, s[24:27], s32 offen sc1
    v_mfma_f32_16x16x32_bf16 a[144:147], a[212:215], v[24:27], a[144:147]
    v_accvgpr_read_b32 v208, a8
    v_mfma_f32_16x16x32_bf16 a[148:151], a[212:215], v[28:31], a[148:151]
    v_accvgpr_read_b32 v209, a9
    v_mfma_f32_16x16x32_bf16 a[152:155], a[212:215], v[32:35], a[152:155]
    v_accvgpr_read_b32 v210, a10
    v_mfma_f32_16x16x32_bf16 a[156:159], a[212:215], v[36:39], a[156:159]
    s_waitcnt lgkmcnt(4)
    v_accvgpr_read_b32 v211, a11
    v_mfma_f32_16x16x32_bf16 a[80:83], a[184:187], v[40:43], a[80:83]
    ds_read_b64_tr_b16 a[196:197], v163 offset:0
    v_accvgpr_read_b32 v212, a28
    v_mfma_f32_16x16x32_bf16 a[84:87], a[184:187], v[44:47], a[84:87]
    ds_read_b64_tr_b16 a[198:199], v163 offset:2048
    v_accvgpr_read_b32 v213, a29
    v_mfma_f32_16x16x32_bf16 a[88:91], a[184:187], v[48:51], a[88:91]
    v_accvgpr_read_b32 v214, a30
    v_mfma_f32_16x16x32_bf16 a[92:95], a[184:187], v[52:55], a[92:95]
    v_accvgpr_read_b32 v215, a31
    v_mfma_f32_16x16x32_bf16 a[96:99], a[184:187], v[56:59], a[96:99]
    s_waitcnt lgkmcnt(4)
    v_cvt_pk_bf16_f32 v216, v208, v209
    v_mfma_f32_16x16x32_bf16 a[100:103], a[188:191], v[40:43], a[100:103]
    ds_read_b64_tr_b16 a[200:201], v160 offset:4096
    v_cvt_pk_bf16_f32 v217, v210, v211
    v_mfma_f32_16x16x32_bf16 a[104:107], a[188:191], v[44:47], a[104:107]
    ds_read_b64_tr_b16 a[202:203], v160 offset:6144
    v_cvt_pk_bf16_f32 v218, v212, v213
    v_mfma_f32_16x16x32_bf16 a[108:111], a[188:191], v[48:51], a[108:111]
    v_cvt_pk_bf16_f32 v219, v214, v215
    v_mfma_f32_16x16x32_bf16 a[112:115], a[188:191], v[52:55], a[112:115]
    s_mov_b32 s32, 2048
    buffer_store_dwordx4 v[216:219], v207, s[24:27], s32 offen sc1
    v_mfma_f32_16x16x32_bf16 a[116:119], a[188:191], v[56:59], a[116:119]
    s_waitcnt lgkmcnt(4)
    v_accvgpr_read_b32 v220, a12
    v_mfma_f32_16x16x32_bf16 a[120:123], a[192:195], v[40:43], a[120:123]
    ds_read_b64_tr_b16 a[204:205], v161 offset:4096
    v_accvgpr_read_b32 v221, a13
    v_mfma_f32_16x16x32_bf16 a[124:127], a[192:195], v[44:47], a[124:127]
    ds_read_b64_tr_b16 a[206:207], v161 offset:6144
    v_accvgpr_read_b32 v222, a14
    v_mfma_f32_16x16x32_bf16 a[128:131], a[192:195], v[48:51], a[128:131]
    ds_read_b64_tr_b16 a[208:209], v162 offset:4096
    v_accvgpr_read_b32 v223, a15
    v_mfma_f32_16x16x32_bf16 a[132:135], a[192:195], v[52:55], a[132:135]
    ds_read_b64_tr_b16 a[210:211], v162 offset:6144
    v_accvgpr_read_b32 v224, a32
    v_mfma_f32_16x16x32_bf16 a[136:139], a[192:195], v[56:59], a[136:139]
    s_waitcnt lgkmcnt(6)
    ds_read_b64_tr_b16 a[212:213], v163 offset:4096
    v_accvgpr_read_b32 v225, a33
    v_mfma_f32_16x16x32_bf16 a[140:143], a[196:199], v[40:43], a[140:143]
    ds_read_b64_tr_b16 a[214:215], v163 offset:6144
    v_accvgpr_read_b32 v226, a34
    v_mfma_f32_16x16x32_bf16 a[144:147], a[196:199], v[44:47], a[144:147]
    v_accvgpr_read_b32 v227, a35
    v_mfma_f32_16x16x32_bf16 a[148:151], a[196:199], v[48:51], a[148:151]
    v_cvt_pk_bf16_f32 v228, v220, v221
    v_mfma_f32_16x16x32_bf16 a[152:155], a[196:199], v[52:55], a[152:155]
    v_cvt_pk_bf16_f32 v229, v222, v223
    v_mfma_f32_16x16x32_bf16 a[156:159], a[196:199], v[56:59], a[156:159]
    s_waitcnt lgkmcnt(6)
    v_cvt_pk_bf16_f32 v230, v224, v225
    v_mfma_f32_16x16x32_bf16 a[80:83], a[200:203], v[60:63], a[80:83]
    v_cvt_pk_bf16_f32 v231, v226, v227
    v_mfma_f32_16x16x32_bf16 a[84:87], a[200:203], v[64:67], a[84:87]
    s_mov_b32 s32, 3072
    buffer_store_dwordx4 v[228:231], v207, s[24:27], s32 offen sc1
    v_mfma_f32_16x16x32_bf16 a[88:91], a[200:203], v[68:71], a[88:91]
    v_accvgpr_read_b32 v208, a16
    v_mfma_f32_16x16x32_bf16 a[92:95], a[200:203], v[72:75], a[92:95]
    v_accvgpr_read_b32 v209, a17
    v_mfma_f32_16x16x32_bf16 a[96:99], a[200:203], v[76:79], a[96:99]
    v_accvgpr_read_b32 v210, a18
    s_waitcnt lgkmcnt(0)
    s_waitcnt vmcnt(16)
    s_barrier
    v_mfma_f32_16x16x32_bf16 a[100:103], a[204:207], v[60:63], a[100:103]
    s_add_u32 m0, s54, 0
    ds_read_b64_tr_b16 a[184:185], v160 offset:16384
    v_accvgpr_read_b32 v211, a19
    v_mfma_f32_16x16x32_bf16 a[104:107], a[204:207], v[64:67], a[104:107]
    s_add_u32 s33, s53, 65920
    ds_read_b64_tr_b16 a[186:187], v160 offset:18432
    v_accvgpr_read_b32 v212, a36
    v_mfma_f32_16x16x32_bf16 a[108:111], a[204:207], v[68:71], a[108:111]
    ds_read_b64_tr_b16 a[188:189], v161 offset:16384
    v_accvgpr_read_b32 v213, a37
    v_mfma_f32_16x16x32_bf16 a[112:115], a[204:207], v[72:75], a[112:115]
    ds_read_b64_tr_b16 a[190:191], v161 offset:18432
    v_accvgpr_read_b32 v214, a38
    v_mfma_f32_16x16x32_bf16 a[116:119], a[204:207], v[76:79], a[116:119]
    ds_read_b64_tr_b16 a[192:193], v162 offset:16384
    v_accvgpr_read_b32 v215, a39
    v_mfma_f32_16x16x32_bf16 a[120:123], a[208:211], v[60:63], a[120:123]
    ds_read_b64_tr_b16 a[194:195], v162 offset:18432
    v_cvt_pk_bf16_f32 v216, v208, v209
    v_mfma_f32_16x16x32_bf16 a[124:127], a[208:211], v[64:67], a[124:127]
    buffer_load_dwordx4 v232, s[28:31], s33 offen offset:0  lds
    v_mfma_f32_16x16x32_bf16 a[128:131], a[208:211], v[68:71], a[128:131]
    buffer_load_dwordx4 v233, s[28:31], s33 offen offset:1024  lds
    v_mfma_f32_16x16x32_bf16 a[132:135], a[208:211], v[72:75], a[132:135]
    buffer_load_dwordx4 v234, s[28:31], s33 offen offset:2048  lds
    v_mfma_f32_16x16x32_bf16 a[136:139], a[208:211], v[76:79], a[136:139]
    buffer_load_dwordx4 v235, s[28:31], s33 offen offset:3072  lds
    v_mfma_f32_16x16x32_bf16 a[140:143], a[212:215], v[60:63], a[140:143]
    v_cvt_pk_bf16_f32 v217, v210, v211
    v_mfma_f32_16x16x32_bf16 a[144:147], a[212:215], v[64:67], a[144:147]
    v_cvt_pk_bf16_f32 v218, v212, v213
    v_mfma_f32_16x16x32_bf16 a[148:151], a[212:215], v[68:71], a[148:151]
    v_cvt_pk_bf16_f32 v219, v214, v215
    v_mfma_f32_16x16x32_bf16 a[152:155], a[212:215], v[72:75], a[152:155]
    s_mov_b32 s32, 4096
    buffer_store_dwordx4 v[216:219], v207, s[24:27], s32 offen sc1
    v_mfma_f32_16x16x32_bf16 a[156:159], a[212:215], v[76:79], a[156:159]
    s_waitcnt lgkmcnt(4)
    v_accvgpr_read_b32 v220, a216
    v_mfma_f32_16x16x32_bf16 a[80:83], a[184:187], v[80:83], a[80:83]
    ds_read_b64_tr_b16 a[196:197], v163 offset:16384
    v_accvgpr_read_b32 v221, a217
    v_mfma_f32_16x16x32_bf16 a[84:87], a[184:187], v[84:87], a[84:87]
    ds_read_b64_tr_b16 a[198:199], v163 offset:18432
    v_accvgpr_read_b32 v222, a218
    v_mfma_f32_16x16x32_bf16 a[88:91], a[184:187], v[88:91], a[88:91]
    v_accvgpr_read_b32 v223, a219
    v_mfma_f32_16x16x32_bf16 a[92:95], a[184:187], v[92:95], a[92:95]
    v_accvgpr_read_b32 v224, a236
    v_mfma_f32_16x16x32_bf16 a[96:99], a[184:187], v[96:99], a[96:99]
    s_waitcnt lgkmcnt(4)
    v_accvgpr_read_b32 v225, a237
    v_mfma_f32_16x16x32_bf16 a[100:103], a[188:191], v[80:83], a[100:103]
    ds_read_b64_tr_b16 a[200:201], v160 offset:20480
    v_accvgpr_read_b32 v226, a238
    v_mfma_f32_16x16x32_bf16 a[104:107], a[188:191], v[84:87], a[104:107]
    ds_read_b64_tr_b16 a[202:203], v160 offset:22528
    v_accvgpr_read_b32 v227, a239
    v_mfma_f32_16x16x32_bf16 a[108:111], a[188:191], v[88:91], a[108:111]
    v_cvt_pk_bf16_f32 v228, v220, v221
    v_mfma_f32_16x16x32_bf16 a[112:115], a[188:191], v[92:95], a[112:115]
    v_cvt_pk_bf16_f32 v229, v222, v223
    v_mfma_f32_16x16x32_bf16 a[116:119], a[188:191], v[96:99], a[116:119]
    s_waitcnt lgkmcnt(4)
    v_cvt_pk_bf16_f32 v230, v224, v225
    v_mfma_f32_16x16x32_bf16 a[120:123], a[192:195], v[80:83], a[120:123]
    ds_read_b64_tr_b16 a[204:205], v161 offset:20480
    v_cvt_pk_bf16_f32 v231, v226, v227
    v_mfma_f32_16x16x32_bf16 a[124:127], a[192:195], v[84:87], a[124:127]
    s_mov_b32 s32, 5120
    ds_read_b64_tr_b16 a[206:207], v161 offset:22528
    v_mfma_f32_16x16x32_bf16 a[128:131], a[192:195], v[88:91], a[128:131]
    ds_read_b64_tr_b16 a[208:209], v162 offset:20480
    v_mfma_f32_16x16x32_bf16 a[132:135], a[192:195], v[92:95], a[132:135]
    ds_read_b64_tr_b16 a[210:211], v162 offset:22528
    v_mfma_f32_16x16x32_bf16 a[136:139], a[192:195], v[96:99], a[136:139]
    s_waitcnt lgkmcnt(6)
    ds_read_b64_tr_b16 a[212:213], v163 offset:20480
    v_mfma_f32_16x16x32_bf16 a[140:143], a[196:199], v[80:83], a[140:143]
    ds_read_b64_tr_b16 a[214:215], v163 offset:22528
    v_mfma_f32_16x16x32_bf16 a[144:147], a[196:199], v[84:87], a[144:147]
    buffer_store_dwordx4 v[228:231], v207, s[24:27], s32 offen sc1
    v_mfma_f32_16x16x32_bf16 a[148:151], a[196:199], v[88:91], a[148:151]
    v_accvgpr_read_b32 v208, a220
    v_mfma_f32_16x16x32_bf16 a[152:155], a[196:199], v[92:95], a[152:155]
    v_accvgpr_read_b32 v209, a221
    v_mfma_f32_16x16x32_bf16 a[156:159], a[196:199], v[96:99], a[156:159]
    s_waitcnt lgkmcnt(6)
    v_accvgpr_read_b32 v210, a222
    v_mfma_f32_16x16x32_bf16 a[80:83], a[200:203], v[100:103], a[80:83]
    v_accvgpr_read_b32 v211, a223
    v_mfma_f32_16x16x32_bf16 a[84:87], a[200:203], v[104:107], a[84:87]
    v_accvgpr_read_b32 v212, a240
    v_mfma_f32_16x16x32_bf16 a[88:91], a[200:203], v[108:111], a[88:91]
    v_accvgpr_read_b32 v213, a241
    v_mfma_f32_16x16x32_bf16 a[92:95], a[200:203], v[112:115], a[92:95]
    v_accvgpr_read_b32 v214, a242
    v_mfma_f32_16x16x32_bf16 a[96:99], a[200:203], v[116:119], a[96:99]
    v_accvgpr_read_b32 v215, a243
    s_waitcnt lgkmcnt(4)
    v_mfma_f32_16x16x32_bf16 a[100:103], a[204:207], v[100:103], a[100:103]
    ds_read_b64_tr_b16 a[184:185], v160 offset:32768
    v_cvt_pk_bf16_f32 v216, v208, v209
    v_mfma_f32_16x16x32_bf16 a[104:107], a[204:207], v[104:107], a[104:107]
    ds_read_b64_tr_b16 a[186:187], v160 offset:34816
    v_cvt_pk_bf16_f32 v217, v210, v211
    v_mfma_f32_16x16x32_bf16 a[108:111], a[204:207], v[108:111], a[108:111]
    ds_read_b64_tr_b16 a[188:189], v161 offset:32768
    v_cvt_pk_bf16_f32 v218, v212, v213
    v_mfma_f32_16x16x32_bf16 a[112:115], a[204:207], v[112:115], a[112:115]
    ds_read_b64_tr_b16 a[190:191], v161 offset:34816
    v_cvt_pk_bf16_f32 v219, v214, v215
    v_mfma_f32_16x16x32_bf16 a[116:119], a[204:207], v[116:119], a[116:119]
    s_waitcnt lgkmcnt(6)
    ds_read_b64_tr_b16 a[192:193], v162 offset:32768
    v_mfma_f32_16x16x32_bf16 a[120:123], a[208:211], v[100:103], a[120:123]
    s_mov_b32 s32, 6144
    ds_read_b64_tr_b16 a[194:195], v162 offset:34816
    v_mfma_f32_16x16x32_bf16 a[124:127], a[208:211], v[104:107], a[124:127]
    buffer_store_dwordx4 v[216:219], v207, s[24:27], s32 offen sc1
    v_mfma_f32_16x16x32_bf16 a[128:131], a[208:211], v[108:111], a[128:131]
    v_accvgpr_read_b32 v220, a224
    v_mfma_f32_16x16x32_bf16 a[132:135], a[208:211], v[112:115], a[132:135]
    v_accvgpr_read_b32 v221, a225
    v_mfma_f32_16x16x32_bf16 a[136:139], a[208:211], v[116:119], a[136:139]
    s_waitcnt lgkmcnt(6)
    v_accvgpr_read_b32 v222, a226
    v_mfma_f32_16x16x32_bf16 a[140:143], a[212:215], v[100:103], a[140:143]
    v_accvgpr_read_b32 v223, a227
    v_mfma_f32_16x16x32_bf16 a[144:147], a[212:215], v[104:107], a[144:147]
    v_accvgpr_read_b32 v224, a244
    v_mfma_f32_16x16x32_bf16 a[148:151], a[212:215], v[108:111], a[148:151]
    v_accvgpr_read_b32 v225, a245
    v_mfma_f32_16x16x32_bf16 a[152:155], a[212:215], v[112:115], a[152:155]
    v_accvgpr_read_b32 v226, a246
    v_mfma_f32_16x16x32_bf16 a[156:159], a[212:215], v[116:119], a[156:159]
    s_waitcnt lgkmcnt(4)
    v_accvgpr_read_b32 v227, a247
    v_cvt_pk_bf16_f32 v228, v220, v221
    v_cvt_pk_bf16_f32 v229, v222, v223
    v_cvt_pk_bf16_f32 v230, v224, v225
    v_cvt_pk_bf16_f32 v231, v226, v227
    s_mov_b32 s32, 7168
    buffer_store_dwordx4 v[228:231], v207, s[24:27], s32 offen sc1
    v_accvgpr_read_b32 v208, a228
    v_accvgpr_read_b32 v209, a229
    v_accvgpr_read_b32 v210, a230
    v_accvgpr_read_b32 v211, a231
    v_accvgpr_read_b32 v212, a248
    v_accvgpr_read_b32 v213, a249
    v_accvgpr_read_b32 v214, a250
    v_accvgpr_read_b32 v215, a251
    v_cvt_pk_bf16_f32 v216, v208, v209
    v_cvt_pk_bf16_f32 v217, v210, v211
    v_cvt_pk_bf16_f32 v218, v212, v213
    v_cvt_pk_bf16_f32 v219, v214, v215
    s_mov_b32 s32, 8192
    buffer_store_dwordx4 v[216:219], v207, s[24:27], s32 offen sc1
    v_accvgpr_read_b32 v220, a232
    v_accvgpr_read_b32 v221, a233
    v_accvgpr_read_b32 v222, a234
    v_accvgpr_read_b32 v223, a235
    v_accvgpr_read_b32 v224, a252
    v_accvgpr_read_b32 v225, a253
    v_accvgpr_read_b32 v226, a254
    v_accvgpr_read_b32 v227, a255
    v_cvt_pk_bf16_f32 v228, v220, v221
    v_cvt_pk_bf16_f32 v229, v222, v223
    v_cvt_pk_bf16_f32 v230, v224, v225
    v_cvt_pk_bf16_f32 v231, v226, v227
    s_mov_b32 s32, 9216
    buffer_store_dwordx4 v[228:231], v207, s[24:27], s32 offen sc1
    v_mfma_f32_16x16x32_bf16 a[80:83], a[184:187], v[120:123], a[80:83]
    ds_read_b64_tr_b16 a[196:197], v163 offset:32768
    v_mfma_f32_16x16x32_bf16 a[84:87], a[184:187], v[124:127], a[84:87]
    ds_read_b64_tr_b16 a[198:199], v163 offset:34816
    v_mfma_f32_16x16x32_bf16 a[88:91], a[184:187], v[128:131], a[88:91]
    v_mfma_f32_16x16x32_bf16 a[92:95], a[184:187], v[132:135], a[92:95]
    v_mfma_f32_16x16x32_bf16 a[96:99], a[184:187], v[136:139], a[96:99]
    s_waitcnt lgkmcnt(4)
    v_mfma_f32_16x16x32_bf16 a[100:103], a[188:191], v[120:123], a[100:103]
    ds_read_b64_tr_b16 a[200:201], v160 offset:36864
    v_mfma_f32_16x16x32_bf16 a[104:107], a[188:191], v[124:127], a[104:107]
    ds_read_b64_tr_b16 a[202:203], v160 offset:38912
    v_mfma_f32_16x16x32_bf16 a[108:111], a[188:191], v[128:131], a[108:111]
    v_mfma_f32_16x16x32_bf16 a[112:115], a[188:191], v[132:135], a[112:115]
    v_mfma_f32_16x16x32_bf16 a[116:119], a[188:191], v[136:139], a[116:119]
    s_waitcnt lgkmcnt(4)
    v_mfma_f32_16x16x32_bf16 a[120:123], a[192:195], v[120:123], a[120:123]
    ds_read_b64_tr_b16 a[204:205], v161 offset:36864
    v_mfma_f32_16x16x32_bf16 a[124:127], a[192:195], v[124:127], a[124:127]
    ds_read_b64_tr_b16 a[206:207], v161 offset:38912
    v_mfma_f32_16x16x32_bf16 a[128:131], a[192:195], v[128:131], a[128:131]
    ds_read_b64_tr_b16 a[208:209], v162 offset:36864
    v_mfma_f32_16x16x32_bf16 a[132:135], a[192:195], v[132:135], a[132:135]
    ds_read_b64_tr_b16 a[210:211], v162 offset:38912
    v_mfma_f32_16x16x32_bf16 a[136:139], a[192:195], v[136:139], a[136:139]
    s_waitcnt lgkmcnt(6)
    ds_read_b64_tr_b16 a[212:213], v163 offset:36864
    v_mfma_f32_16x16x32_bf16 a[140:143], a[196:199], v[120:123], a[140:143]
    ds_read_b64_tr_b16 a[214:215], v163 offset:38912
    v_mfma_f32_16x16x32_bf16 a[144:147], a[196:199], v[124:127], a[144:147]
    v_mfma_f32_16x16x32_bf16 a[148:151], a[196:199], v[128:131], a[148:151]
    v_mfma_f32_16x16x32_bf16 a[152:155], a[196:199], v[132:135], a[152:155]
    v_mfma_f32_16x16x32_bf16 a[156:159], a[196:199], v[136:139], a[156:159]
    s_waitcnt lgkmcnt(6)
    v_mfma_f32_16x16x32_bf16 a[80:83], a[200:203], v[140:143], a[80:83]
    v_mfma_f32_16x16x32_bf16 a[84:87], a[200:203], v[144:147], a[84:87]
    v_mfma_f32_16x16x32_bf16 a[88:91], a[200:203], v[148:151], a[88:91]
    v_mfma_f32_16x16x32_bf16 a[92:95], a[200:203], v[152:155], a[92:95]
    v_mfma_f32_16x16x32_bf16 a[96:99], a[200:203], v[156:159], a[96:99]
    s_waitcnt lgkmcnt(4)
    v_mfma_f32_16x16x32_bf16 a[100:103], a[204:207], v[140:143], a[100:103]
    ds_read_b64_tr_b16 a[184:185], v160 offset:49152
    v_mfma_f32_16x16x32_bf16 a[104:107], a[204:207], v[144:147], a[104:107]
    ds_read_b64_tr_b16 a[186:187], v160 offset:51200
    v_mfma_f32_16x16x32_bf16 a[108:111], a[204:207], v[148:151], a[108:111]
    ds_read_b64_tr_b16 a[188:189], v161 offset:49152
    v_mfma_f32_16x16x32_bf16 a[112:115], a[204:207], v[152:155], a[112:115]
    ds_read_b64_tr_b16 a[190:191], v161 offset:51200
    v_mfma_f32_16x16x32_bf16 a[116:119], a[204:207], v[156:159], a[116:119]
    s_waitcnt lgkmcnt(6)
    ds_read_b64_tr_b16 a[192:193], v162 offset:49152
    v_mfma_f32_16x16x32_bf16 a[120:123], a[208:211], v[140:143], a[120:123]
    ds_read_b64_tr_b16 a[194:195], v162 offset:51200
    v_mfma_f32_16x16x32_bf16 a[124:127], a[208:211], v[144:147], a[124:127]
    v_mfma_f32_16x16x32_bf16 a[128:131], a[208:211], v[148:151], a[128:131]
    v_mfma_f32_16x16x32_bf16 a[132:135], a[208:211], v[152:155], a[132:135]
    v_mfma_f32_16x16x32_bf16 a[136:139], a[208:211], v[156:159], a[136:139]
    s_waitcnt lgkmcnt(6)
    v_mfma_f32_16x16x32_bf16 a[140:143], a[212:215], v[140:143], a[140:143]
    v_mfma_f32_16x16x32_bf16 a[144:147], a[212:215], v[144:147], a[144:147]
    v_mfma_f32_16x16x32_bf16 a[148:151], a[212:215], v[148:151], a[148:151]
    v_mfma_f32_16x16x32_bf16 a[152:155], a[212:215], v[152:155], a[152:155]
    v_mfma_f32_16x16x32_bf16 a[156:159], a[212:215], v[156:159], a[156:159]
    s_waitcnt lgkmcnt(4)
    v_mfma_f32_16x16x32_bf16 a[0:3], a[184:187], v[0:3], 0
    ds_read_b64_tr_b16 a[196:197], v163 offset:49152
    v_mfma_f32_16x16x32_bf16 a[4:7], a[184:187], v[4:7], 0
    ds_read_b64_tr_b16 a[198:199], v163 offset:51200
    v_mfma_f32_16x16x32_bf16 a[8:11], a[184:187], v[8:11], 0
    v_mfma_f32_16x16x32_bf16 a[12:15], a[184:187], v[12:15], 0
    v_mfma_f32_16x16x32_bf16 a[16:19], a[184:187], v[16:19], 0
    s_waitcnt lgkmcnt(4)
    v_mfma_f32_16x16x32_bf16 a[20:23], a[188:191], v[0:3], 0
    ds_read_b64_tr_b16 a[200:201], v160 offset:53248
    v_mfma_f32_16x16x32_bf16 a[24:27], a[188:191], v[4:7], 0
    ds_read_b64_tr_b16 a[202:203], v160 offset:55296
    v_accvgpr_read_b32 v208, a80
    v_mfma_f32_16x16x32_bf16 a[28:31], a[188:191], v[8:11], 0
    v_accvgpr_read_b32 v209, a81
    v_mfma_f32_16x16x32_bf16 a[32:35], a[188:191], v[12:15], 0
    v_accvgpr_read_b32 v210, a82
    v_mfma_f32_16x16x32_bf16 a[36:39], a[188:191], v[16:19], 0
    s_waitcnt lgkmcnt(4)
    v_accvgpr_read_b32 v211, a83
    v_mfma_f32_16x16x32_bf16 a[216:219], a[192:195], v[0:3], 0
    ds_read_b64_tr_b16 a[204:205], v161 offset:53248
    v_accvgpr_read_b32 v212, a100
    v_mfma_f32_16x16x32_bf16 a[220:223], a[192:195], v[4:7], 0
    ds_read_b64_tr_b16 a[206:207], v161 offset:55296
    v_accvgpr_read_b32 v213, a101
    v_mfma_f32_16x16x32_bf16 a[224:227], a[192:195], v[8:11], 0
    ds_read_b64_tr_b16 a[208:209], v162 offset:53248
    v_accvgpr_read_b32 v214, a102
    v_mfma_f32_16x16x32_bf16 a[228:231], a[192:195], v[12:15], 0
    ds_read_b64_tr_b16 a[210:211], v162 offset:55296
    v_accvgpr_read_b32 v215, a103
    v_mfma_f32_16x16x32_bf16 a[232:235], a[192:195], v[16:19], 0
    s_waitcnt lgkmcnt(6)
    ds_read_b64_tr_b16 a[212:213], v163 offset:53248
    v_cvt_pk_bf16_f32 v216, v208, v209
    v_mfma_f32_16x16x32_bf16 a[236:239], a[196:199], v[0:3], 0
    ds_read_b64_tr_b16 a[214:215], v163 offset:55296
    v_cvt_pk_bf16_f32 v217, v210, v211
    v_mfma_f32_16x16x32_bf16 a[240:243], a[196:199], v[4:7], 0
    v_cvt_pk_bf16_f32 v218, v212, v213
    v_mfma_f32_16x16x32_bf16 a[244:247], a[196:199], v[8:11], 0
    v_cvt_pk_bf16_f32 v219, v214, v215
    v_mfma_f32_16x16x32_bf16 a[248:251], a[196:199], v[12:15], 0
    s_mov_b32 s32, 10240
    buffer_store_dwordx4 v[216:219], v207, s[24:27], s32 offen sc1
    v_mfma_f32_16x16x32_bf16 a[252:255], a[196:199], v[16:19], 0
    s_waitcnt lgkmcnt(6)
    v_accvgpr_read_b32 v220, a84
    v_mfma_f32_16x16x32_bf16 a[0:3], a[200:203], v[20:23], a[0:3]
    v_accvgpr_read_b32 v221, a85
    v_mfma_f32_16x16x32_bf16 a[4:7], a[200:203], v[24:27], a[4:7]
    v_accvgpr_read_b32 v222, a86
    v_mfma_f32_16x16x32_bf16 a[8:11], a[200:203], v[28:31], a[8:11]
    v_accvgpr_read_b32 v223, a87
    v_mfma_f32_16x16x32_bf16 a[12:15], a[200:203], v[32:35], a[12:15]
    v_accvgpr_read_b32 v224, a104
    v_mfma_f32_16x16x32_bf16 a[16:19], a[200:203], v[36:39], a[16:19]
    v_accvgpr_read_b32 v225, a105
    s_waitcnt lgkmcnt(4)
    v_mfma_f32_16x16x32_bf16 a[20:23], a[204:207], v[20:23], a[20:23]
    ds_read_b64_tr_b16 a[184:185], v164 offset:0
    v_accvgpr_read_b32 v226, a106
    v_mfma_f32_16x16x32_bf16 a[24:27], a[204:207], v[24:27], a[24:27]
    ds_read_b64_tr_b16 a[186:187], v164 offset:2048
    v_accvgpr_read_b32 v227, a107
    v_mfma_f32_16x16x32_bf16 a[28:31], a[204:207], v[28:31], a[28:31]
    ds_read_b64_tr_b16 a[188:189], v165 offset:0
    v_cvt_pk_bf16_f32 v228, v220, v221
    v_mfma_f32_16x16x32_bf16 a[32:35], a[204:207], v[32:35], a[32:35]
    ds_read_b64_tr_b16 a[190:191], v165 offset:2048
    v_cvt_pk_bf16_f32 v229, v222, v223
    v_mfma_f32_16x16x32_bf16 a[36:39], a[204:207], v[36:39], a[36:39]
    s_waitcnt lgkmcnt(6)
    ds_read_b64_tr_b16 a[192:193], v166 offset:0
    v_cvt_pk_bf16_f32 v230, v224, v225
    v_mfma_f32_16x16x32_bf16 a[216:219], a[208:211], v[20:23], a[216:219]
    ds_read_b64_tr_b16 a[194:195], v166 offset:2048
    v_cvt_pk_bf16_f32 v231, v226, v227
    v_mfma_f32_16x16x32_bf16 a[220:223], a[208:211], v[24:27], a[220:223]
    s_mov_b32 s32, 11264
    buffer_store_dwordx4 v[228:231], v207, s[24:27], s32 offen sc1
    v_mfma_f32_16x16x32_bf16 a[224:227], a[208:211], v[28:31], a[224:227]
    v_accvgpr_read_b32 v208, a88
    v_mfma_f32_16x16x32_bf16 a[228:231], a[208:211], v[32:35], a[228:231]
    v_accvgpr_read_b32 v209, a89
    v_mfma_f32_16x16x32_bf16 a[232:235], a[208:211], v[36:39], a[232:235]
    s_waitcnt lgkmcnt(6)
    v_accvgpr_read_b32 v210, a90
    v_mfma_f32_16x16x32_bf16 a[236:239], a[212:215], v[20:23], a[236:239]
    v_accvgpr_read_b32 v211, a91
    v_mfma_f32_16x16x32_bf16 a[240:243], a[212:215], v[24:27], a[240:243]
    v_accvgpr_read_b32 v212, a108
    v_mfma_f32_16x16x32_bf16 a[244:247], a[212:215], v[28:31], a[244:247]
    v_accvgpr_read_b32 v213, a109
    v_mfma_f32_16x16x32_bf16 a[248:251], a[212:215], v[32:35], a[248:251]
    v_accvgpr_read_b32 v214, a110
    v_mfma_f32_16x16x32_bf16 a[252:255], a[212:215], v[36:39], a[252:255]
    s_waitcnt lgkmcnt(4)
    v_accvgpr_read_b32 v215, a111
    v_mfma_f32_16x16x32_bf16 a[0:3], a[184:187], v[40:43], a[0:3]
    ds_read_b64_tr_b16 a[196:197], v167 offset:0
    v_cvt_pk_bf16_f32 v216, v208, v209
    v_mfma_f32_16x16x32_bf16 a[4:7], a[184:187], v[44:47], a[4:7]
    ds_read_b64_tr_b16 a[198:199], v167 offset:2048
    v_cvt_pk_bf16_f32 v217, v210, v211
    v_mfma_f32_16x16x32_bf16 a[8:11], a[184:187], v[48:51], a[8:11]
    v_cvt_pk_bf16_f32 v218, v212, v213
    v_mfma_f32_16x16x32_bf16 a[12:15], a[184:187], v[52:55], a[12:15]
    v_cvt_pk_bf16_f32 v219, v214, v215
    v_mfma_f32_16x16x32_bf16 a[16:19], a[184:187], v[56:59], a[16:19]
    s_waitcnt lgkmcnt(4)
    s_mov_b32 s32, 12288
    v_mfma_f32_16x16x32_bf16 a[20:23], a[188:191], v[40:43], a[20:23]
    ds_read_b64_tr_b16 a[200:201], v164 offset:4096
    v_mfma_f32_16x16x32_bf16 a[24:27], a[188:191], v[44:47], a[24:27]
    ds_read_b64_tr_b16 a[202:203], v164 offset:6144
    v_mfma_f32_16x16x32_bf16 a[28:31], a[188:191], v[48:51], a[28:31]
    buffer_store_dwordx4 v[216:219], v207, s[24:27], s32 offen sc1
    v_mfma_f32_16x16x32_bf16 a[32:35], a[188:191], v[52:55], a[32:35]
    v_accvgpr_read_b32 v220, a92
    v_mfma_f32_16x16x32_bf16 a[36:39], a[188:191], v[56:59], a[36:39]
    s_waitcnt lgkmcnt(4)
    v_accvgpr_read_b32 v221, a93
    v_mfma_f32_16x16x32_bf16 a[216:219], a[192:195], v[40:43], a[216:219]
    ds_read_b64_tr_b16 a[204:205], v165 offset:4096
    v_accvgpr_read_b32 v222, a94
    v_mfma_f32_16x16x32_bf16 a[220:223], a[192:195], v[44:47], a[220:223]
    ds_read_b64_tr_b16 a[206:207], v165 offset:6144
    v_accvgpr_read_b32 v223, a95
    v_mfma_f32_16x16x32_bf16 a[224:227], a[192:195], v[48:51], a[224:227]
    ds_read_b64_tr_b16 a[208:209], v166 offset:4096
    v_accvgpr_read_b32 v224, a112
    v_mfma_f32_16x16x32_bf16 a[228:231], a[192:195], v[52:55], a[228:231]
    ds_read_b64_tr_b16 a[210:211], v166 offset:6144
    v_accvgpr_read_b32 v225, a113
    v_mfma_f32_16x16x32_bf16 a[232:235], a[192:195], v[56:59], a[232:235]
    s_waitcnt lgkmcnt(6)
    ds_read_b64_tr_b16 a[212:213], v167 offset:4096
    v_accvgpr_read_b32 v226, a114
    v_mfma_f32_16x16x32_bf16 a[236:239], a[196:199], v[40:43], a[236:239]
    ds_read_b64_tr_b16 a[214:215], v167 offset:6144
    v_accvgpr_read_b32 v227, a115
    v_mfma_f32_16x16x32_bf16 a[240:243], a[196:199], v[44:47], a[240:243]
    v_cvt_pk_bf16_f32 v228, v220, v221
    v_mfma_f32_16x16x32_bf16 a[244:247], a[196:199], v[48:51], a[244:247]
    v_cvt_pk_bf16_f32 v229, v222, v223
    v_mfma_f32_16x16x32_bf16 a[248:251], a[196:199], v[52:55], a[248:251]
    v_cvt_pk_bf16_f32 v230, v224, v225
    v_mfma_f32_16x16x32_bf16 a[252:255], a[196:199], v[56:59], a[252:255]
    s_waitcnt lgkmcnt(6)
    v_cvt_pk_bf16_f32 v231, v226, v227
    v_mfma_f32_16x16x32_bf16 a[0:3], a[200:203], v[60:63], a[0:3]
    s_mov_b32 s32, 13312
    buffer_store_dwordx4 v[228:231], v207, s[24:27], s32 offen sc1
    v_mfma_f32_16x16x32_bf16 a[4:7], a[200:203], v[64:67], a[4:7]
    v_accvgpr_read_b32 v208, a96
    v_mfma_f32_16x16x32_bf16 a[8:11], a[200:203], v[68:71], a[8:11]
    v_accvgpr_read_b32 v209, a97
    v_mfma_f32_16x16x32_bf16 a[12:15], a[200:203], v[72:75], a[12:15]
    v_accvgpr_read_b32 v210, a98
    v_mfma_f32_16x16x32_bf16 a[16:19], a[200:203], v[76:79], a[16:19]
    v_accvgpr_read_b32 v211, a99
    s_waitcnt lgkmcnt(4)
    v_mfma_f32_16x16x32_bf16 a[20:23], a[204:207], v[60:63], a[20:23]
    ds_read_b64_tr_b16 a[184:185], v168 offset:0
    v_accvgpr_read_b32 v212, a116
    v_mfma_f32_16x16x32_bf16 a[24:27], a[204:207], v[64:67], a[24:27]
    ds_read_b64_tr_b16 a[186:187], v168 offset:2048
    v_accvgpr_read_b32 v213, a117
    v_mfma_f32_16x16x32_bf16 a[28:31], a[204:207], v[68:71], a[28:31]
    ds_read_b64_tr_b16 a[188:189], v169 offset:0
    v_accvgpr_read_b32 v214, a118
    v_mfma_f32_16x16x32_bf16 a[32:35], a[204:207], v[72:75], a[32:35]
    ds_read_b64_tr_b16 a[190:191], v169 offset:2048
    v_accvgpr_read_b32 v215, a119
    v_mfma_f32_16x16x32_bf16 a[36:39], a[204:207], v[76:79], a[36:39]
    s_waitcnt lgkmcnt(6)
    ds_read_b64_tr_b16 a[192:193], v170 offset:0
    v_cvt_pk_bf16_f32 v216, v208, v209
    v_mfma_f32_16x16x32_bf16 a[216:219], a[208:211], v[60:63], a[216:219]
    ds_read_b64_tr_b16 a[194:195], v170 offset:2048
    v_cvt_pk_bf16_f32 v217, v210, v211
    v_mfma_f32_16x16x32_bf16 a[220:223], a[208:211], v[64:67], a[220:223]
    v_cvt_pk_bf16_f32 v218, v212, v213
    v_mfma_f32_16x16x32_bf16 a[224:227], a[208:211], v[68:71], a[224:227]
    v_cvt_pk_bf16_f32 v219, v214, v215
    v_mfma_f32_16x16x32_bf16 a[228:231], a[208:211], v[72:75], a[228:231]
    s_mov_b32 s32, 14336
    buffer_store_dwordx4 v[216:219], v207, s[24:27], s32 offen sc1
    v_mfma_f32_16x16x32_bf16 a[232:235], a[208:211], v[76:79], a[232:235]
    s_waitcnt lgkmcnt(6)
    v_accvgpr_read_b32 v220, a120
    v_mfma_f32_16x16x32_bf16 a[236:239], a[212:215], v[60:63], a[236:239]
    v_accvgpr_read_b32 v221, a121
    v_mfma_f32_16x16x32_bf16 a[240:243], a[212:215], v[64:67], a[240:243]
    v_accvgpr_read_b32 v222, a122
    v_mfma_f32_16x16x32_bf16 a[244:247], a[212:215], v[68:71], a[244:247]
    v_accvgpr_read_b32 v223, a123
    v_mfma_f32_16x16x32_bf16 a[248:251], a[212:215], v[72:75], a[248:251]
    v_accvgpr_read_b32 v224, a140
    v_mfma_f32_16x16x32_bf16 a[252:255], a[212:215], v[76:79], a[252:255]
    s_waitcnt lgkmcnt(4)
    v_accvgpr_read_b32 v225, a141
    v_mfma_f32_16x16x32_bf16 a[0:3], a[184:187], v[80:83], a[0:3]
    ds_read_b64_tr_b16 a[196:197], v171 offset:0
    v_accvgpr_read_b32 v226, a142
    v_mfma_f32_16x16x32_bf16 a[4:7], a[184:187], v[84:87], a[4:7]
    ds_read_b64_tr_b16 a[198:199], v171 offset:2048
    v_accvgpr_read_b32 v227, a143
    v_mfma_f32_16x16x32_bf16 a[8:11], a[184:187], v[88:91], a[8:11]
    v_cvt_pk_bf16_f32 v228, v220, v221
    v_mfma_f32_16x16x32_bf16 a[12:15], a[184:187], v[92:95], a[12:15]
    v_cvt_pk_bf16_f32 v229, v222, v223
    v_mfma_f32_16x16x32_bf16 a[16:19], a[184:187], v[96:99], a[16:19]
    s_waitcnt lgkmcnt(4)
    v_cvt_pk_bf16_f32 v230, v224, v225
    v_mfma_f32_16x16x32_bf16 a[20:23], a[188:191], v[80:83], a[20:23]
    ds_read_b64_tr_b16 a[200:201], v168 offset:4096
    v_cvt_pk_bf16_f32 v231, v226, v227
    v_mfma_f32_16x16x32_bf16 a[24:27], a[188:191], v[84:87], a[24:27]
    s_mov_b32 s32, 15360
    ds_read_b64_tr_b16 a[202:203], v168 offset:6144
    v_mfma_f32_16x16x32_bf16 a[28:31], a[188:191], v[88:91], a[28:31]
    buffer_store_dwordx4 v[228:231], v207, s[24:27], s32 offen sc1
    v_mfma_f32_16x16x32_bf16 a[32:35], a[188:191], v[92:95], a[32:35]
    v_accvgpr_read_b32 v208, a124
    v_mfma_f32_16x16x32_bf16 a[36:39], a[188:191], v[96:99], a[36:39]
    s_waitcnt lgkmcnt(4)
    v_accvgpr_read_b32 v209, a125
    v_mfma_f32_16x16x32_bf16 a[216:219], a[192:195], v[80:83], a[216:219]
    ds_read_b64_tr_b16 a[204:205], v169 offset:4096
    v_accvgpr_read_b32 v210, a126
    v_mfma_f32_16x16x32_bf16 a[220:223], a[192:195], v[84:87], a[220:223]
    ds_read_b64_tr_b16 a[206:207], v169 offset:6144
    v_accvgpr_read_b32 v211, a127
    v_mfma_f32_16x16x32_bf16 a[224:227], a[192:195], v[88:91], a[224:227]
    ds_read_b64_tr_b16 a[208:209], v170 offset:4096
    v_accvgpr_read_b32 v212, a144
    v_mfma_f32_16x16x32_bf16 a[228:231], a[192:195], v[92:95], a[228:231]
    ds_read_b64_tr_b16 a[210:211], v170 offset:6144
    v_accvgpr_read_b32 v213, a145
    v_mfma_f32_16x16x32_bf16 a[232:235], a[192:195], v[96:99], a[232:235]
    s_waitcnt lgkmcnt(6)
    ds_read_b64_tr_b16 a[212:213], v171 offset:4096
    v_accvgpr_read_b32 v214, a146
    v_mfma_f32_16x16x32_bf16 a[236:239], a[196:199], v[80:83], a[236:239]
    ds_read_b64_tr_b16 a[214:215], v171 offset:6144
    v_accvgpr_read_b32 v215, a147
    v_mfma_f32_16x16x32_bf16 a[240:243], a[196:199], v[84:87], a[240:243]
    v_cvt_pk_bf16_f32 v216, v208, v209
    v_mfma_f32_16x16x32_bf16 a[244:247], a[196:199], v[88:91], a[244:247]
    v_cvt_pk_bf16_f32 v217, v210, v211
    v_mfma_f32_16x16x32_bf16 a[248:251], a[196:199], v[92:95], a[248:251]
    v_cvt_pk_bf16_f32 v218, v212, v213
    v_mfma_f32_16x16x32_bf16 a[252:255], a[196:199], v[96:99], a[252:255]
    s_waitcnt lgkmcnt(6)
    v_cvt_pk_bf16_f32 v219, v214, v215
    v_mfma_f32_16x16x32_bf16 a[0:3], a[200:203], v[100:103], a[0:3]
    s_mov_b32 s32, 16384
    buffer_store_dwordx4 v[216:219], v207, s[24:27], s32 offen sc1
    v_mfma_f32_16x16x32_bf16 a[4:7], a[200:203], v[104:107], a[4:7]
    v_accvgpr_read_b32 v220, a128
    v_mfma_f32_16x16x32_bf16 a[8:11], a[200:203], v[108:111], a[8:11]
    v_accvgpr_read_b32 v221, a129
    v_mfma_f32_16x16x32_bf16 a[12:15], a[200:203], v[112:115], a[12:15]
    v_accvgpr_read_b32 v222, a130
    v_mfma_f32_16x16x32_bf16 a[16:19], a[200:203], v[116:119], a[16:19]
    v_accvgpr_read_b32 v223, a131
    s_waitcnt lgkmcnt(0)
    s_waitcnt vmcnt(13)
    s_barrier
    v_mfma_f32_16x16x32_bf16 a[20:23], a[204:207], v[100:103], a[20:23]
    ds_read_b64_tr_b16 a[184:185], v168 offset:16384
    v_accvgpr_read_b32 v224, a148
    v_mfma_f32_16x16x32_bf16 a[24:27], a[204:207], v[104:107], a[24:27]
    ds_read_b64_tr_b16 a[186:187], v168 offset:18432
    v_accvgpr_read_b32 v225, a149
    v_mfma_f32_16x16x32_bf16 a[28:31], a[204:207], v[108:111], a[28:31]
    ds_read_b64_tr_b16 a[188:189], v169 offset:16384
    v_accvgpr_read_b32 v226, a150
    v_mfma_f32_16x16x32_bf16 a[32:35], a[204:207], v[112:115], a[32:35]
    ds_read_b64_tr_b16 a[190:191], v169 offset:18432
    v_accvgpr_read_b32 v227, a151
    v_mfma_f32_16x16x32_bf16 a[36:39], a[204:207], v[116:119], a[36:39]
    ds_read_b64_tr_b16 a[192:193], v170 offset:16384
    v_cvt_pk_bf16_f32 v228, v220, v221
    v_mfma_f32_16x16x32_bf16 a[216:219], a[208:211], v[100:103], a[216:219]
    ds_read_b64_tr_b16 a[194:195], v170 offset:18432
    v_cvt_pk_bf16_f32 v229, v222, v223
    v_mfma_f32_16x16x32_bf16 a[220:223], a[208:211], v[104:107], a[220:223]
    v_cvt_pk_bf16_f32 v230, v224, v225
    v_mfma_f32_16x16x32_bf16 a[224:227], a[208:211], v[108:111], a[224:227]
    v_cvt_pk_bf16_f32 v231, v226, v227
    v_mfma_f32_16x16x32_bf16 a[228:231], a[208:211], v[112:115], a[228:231]
    s_mov_b32 s32, 17408
    buffer_store_dwordx4 v[228:231], v207, s[24:27], s32 offen sc1
    v_mfma_f32_16x16x32_bf16 a[232:235], a[208:211], v[116:119], a[232:235]
    v_accvgpr_read_b32 v208, a132
    v_mfma_f32_16x16x32_bf16 a[236:239], a[212:215], v[100:103], a[236:239]
    v_accvgpr_read_b32 v209, a133
    v_mfma_f32_16x16x32_bf16 a[240:243], a[212:215], v[104:107], a[240:243]
    v_accvgpr_read_b32 v210, a134
    v_mfma_f32_16x16x32_bf16 a[244:247], a[212:215], v[108:111], a[244:247]
    v_accvgpr_read_b32 v211, a135
    v_mfma_f32_16x16x32_bf16 a[248:251], a[212:215], v[112:115], a[248:251]
    v_accvgpr_read_b32 v212, a152
    v_mfma_f32_16x16x32_bf16 a[252:255], a[212:215], v[116:119], a[252:255]
    s_waitcnt lgkmcnt(4)
    v_accvgpr_read_b32 v213, a153
    v_accvgpr_read_b32 v214, a154
    v_accvgpr_read_b32 v215, a155
    v_cvt_pk_bf16_f32 v216, v208, v209
    v_cvt_pk_bf16_f32 v217, v210, v211
    v_cvt_pk_bf16_f32 v218, v212, v213
    v_cvt_pk_bf16_f32 v219, v214, v215
    s_mov_b32 s32, 18432
    buffer_store_dwordx4 v[216:219], v207, s[24:27], s32 offen sc1
    v_accvgpr_read_b32 v220, a136
    v_accvgpr_read_b32 v221, a137
    v_accvgpr_read_b32 v222, a138
    v_accvgpr_read_b32 v223, a139
    v_accvgpr_read_b32 v224, a156
    v_accvgpr_read_b32 v225, a157
    v_accvgpr_read_b32 v226, a158
    v_accvgpr_read_b32 v227, a159
    v_cvt_pk_bf16_f32 v228, v220, v221
    v_cvt_pk_bf16_f32 v229, v222, v223
    v_cvt_pk_bf16_f32 v230, v224, v225
    v_cvt_pk_bf16_f32 v231, v226, v227
    s_mov_b32 s32, 19456
    buffer_store_dwordx4 v[228:231], v207, s[24:27], s32 offen sc1
    v_mfma_f32_16x16x32_bf16 a[0:3], a[184:187], v[120:123], a[0:3]
    ds_read_b64_tr_b16 a[196:197], v171 offset:16384
    v_mfma_f32_16x16x32_bf16 a[4:7], a[184:187], v[124:127], a[4:7]
    ds_read_b64_tr_b16 a[198:199], v171 offset:18432
    v_mfma_f32_16x16x32_bf16 a[8:11], a[184:187], v[128:131], a[8:11]
    v_mfma_f32_16x16x32_bf16 a[12:15], a[184:187], v[132:135], a[12:15]
    v_mfma_f32_16x16x32_bf16 a[16:19], a[184:187], v[136:139], a[16:19]
    s_waitcnt lgkmcnt(4)
    v_mfma_f32_16x16x32_bf16 a[20:23], a[188:191], v[120:123], a[20:23]
    ds_read_b64_tr_b16 a[200:201], v168 offset:20480
    v_mfma_f32_16x16x32_bf16 a[24:27], a[188:191], v[124:127], a[24:27]
    ds_read_b64_tr_b16 a[202:203], v168 offset:22528
    v_mfma_f32_16x16x32_bf16 a[28:31], a[188:191], v[128:131], a[28:31]
    v_mfma_f32_16x16x32_bf16 a[32:35], a[188:191], v[132:135], a[32:35]
    v_mfma_f32_16x16x32_bf16 a[36:39], a[188:191], v[136:139], a[36:39]
    s_waitcnt lgkmcnt(4)
    v_mfma_f32_16x16x32_bf16 a[216:219], a[192:195], v[120:123], a[216:219]
    ds_read_b64_tr_b16 a[204:205], v169 offset:20480
    v_mfma_f32_16x16x32_bf16 a[220:223], a[192:195], v[124:127], a[220:223]
    ds_read_b64_tr_b16 a[206:207], v169 offset:22528
    v_mfma_f32_16x16x32_bf16 a[224:227], a[192:195], v[128:131], a[224:227]
    ds_read_b64_tr_b16 a[208:209], v170 offset:20480
    v_mfma_f32_16x16x32_bf16 a[228:231], a[192:195], v[132:135], a[228:231]
    ds_read_b64_tr_b16 a[210:211], v170 offset:22528
    v_mfma_f32_16x16x32_bf16 a[232:235], a[192:195], v[136:139], a[232:235]
    s_waitcnt lgkmcnt(6)
    ds_read_b64_tr_b16 a[212:213], v171 offset:20480
    v_mfma_f32_16x16x32_bf16 a[236:239], a[196:199], v[120:123], a[236:239]
    ds_read_b64_tr_b16 a[214:215], v171 offset:22528
    v_mfma_f32_16x16x32_bf16 a[240:243], a[196:199], v[124:127], a[240:243]
    v_mfma_f32_16x16x32_bf16 a[244:247], a[196:199], v[128:131], a[244:247]
    v_mfma_f32_16x16x32_bf16 a[248:251], a[196:199], v[132:135], a[248:251]
    v_mfma_f32_16x16x32_bf16 a[252:255], a[196:199], v[136:139], a[252:255]
    s_waitcnt lgkmcnt(6)
    v_mfma_f32_16x16x32_bf16 a[0:3], a[200:203], v[140:143], a[0:3]
    v_mfma_f32_16x16x32_bf16 a[4:7], a[200:203], v[144:147], a[4:7]
    v_mfma_f32_16x16x32_bf16 a[8:11], a[200:203], v[148:151], a[8:11]
    v_mfma_f32_16x16x32_bf16 a[12:15], a[200:203], v[152:155], a[12:15]
    v_mfma_f32_16x16x32_bf16 a[16:19], a[200:203], v[156:159], a[16:19]
    s_waitcnt lgkmcnt(4)
    v_mfma_f32_16x16x32_bf16 a[20:23], a[204:207], v[140:143], a[20:23]
    ds_read_b64_tr_b16 a[184:185], v164 offset:32768
    v_mfma_f32_16x16x32_bf16 a[24:27], a[204:207], v[144:147], a[24:27]
    ds_read_b64_tr_b16 a[186:187], v164 offset:34816
    v_mfma_f32_16x16x32_bf16 a[28:31], a[204:207], v[148:151], a[28:31]
    ds_read_b64_tr_b16 a[188:189], v165 offset:32768
    v_mfma_f32_16x16x32_bf16 a[32:35], a[204:207], v[152:155], a[32:35]
    ds_read_b64_tr_b16 a[190:191], v165 offset:34816
    v_mfma_f32_16x16x32_bf16 a[36:39], a[204:207], v[156:159], a[36:39]
    s_waitcnt lgkmcnt(6)
    ds_read_b64_tr_b16 a[192:193], v166 offset:32768
    v_mfma_f32_16x16x32_bf16 a[216:219], a[208:211], v[140:143], a[216:219]
    ds_read_b64_tr_b16 a[194:195], v166 offset:34816
    v_mfma_f32_16x16x32_bf16 a[220:223], a[208:211], v[144:147], a[220:223]
    v_mfma_f32_16x16x32_bf16 a[224:227], a[208:211], v[148:151], a[224:227]
    v_mfma_f32_16x16x32_bf16 a[228:231], a[208:211], v[152:155], a[228:231]
    v_mfma_f32_16x16x32_bf16 a[232:235], a[208:211], v[156:159], a[232:235]
    s_waitcnt lgkmcnt(6)
    v_mfma_f32_16x16x32_bf16 a[236:239], a[212:215], v[140:143], a[236:239]
    v_mfma_f32_16x16x32_bf16 a[240:243], a[212:215], v[144:147], a[240:243]
    v_mfma_f32_16x16x32_bf16 a[244:247], a[212:215], v[148:151], a[244:247]
    v_mfma_f32_16x16x32_bf16 a[248:251], a[212:215], v[152:155], a[248:251]
    v_mfma_f32_16x16x32_bf16 a[252:255], a[212:215], v[156:159], a[252:255]
    s_waitcnt lgkmcnt(4)
    v_mfma_f32_16x16x32_bf16 a[80:83], a[184:187], v[0:3], 0
    ds_read_b64_tr_b16 a[196:197], v167 offset:32768
    v_mfma_f32_16x16x32_bf16 a[84:87], a[184:187], v[4:7], 0
    ds_read_b64_tr_b16 a[198:199], v167 offset:34816
    v_mfma_f32_16x16x32_bf16 a[88:91], a[184:187], v[8:11], 0
    v_mfma_f32_16x16x32_bf16 a[92:95], a[184:187], v[12:15], 0
    v_mfma_f32_16x16x32_bf16 a[96:99], a[184:187], v[16:19], 0
    s_waitcnt lgkmcnt(4)
    v_mfma_f32_16x16x32_bf16 a[100:103], a[188:191], v[0:3], 0
    ds_read_b64_tr_b16 a[200:201], v164 offset:36864
    v_mfma_f32_16x16x32_bf16 a[104:107], a[188:191], v[4:7], 0
    ds_read_b64_tr_b16 a[202:203], v164 offset:38912
    v_accvgpr_read_b32 v208, a0
    v_mfma_f32_16x16x32_bf16 a[108:111], a[188:191], v[8:11], 0
    v_accvgpr_read_b32 v209, a1
    v_mfma_f32_16x16x32_bf16 a[112:115], a[188:191], v[12:15], 0
    v_accvgpr_read_b32 v210, a2
    v_mfma_f32_16x16x32_bf16 a[116:119], a[188:191], v[16:19], 0
    s_waitcnt lgkmcnt(4)
    v_accvgpr_read_b32 v211, a3
    v_mfma_f32_16x16x32_bf16 a[120:123], a[192:195], v[0:3], 0
    ds_read_b64_tr_b16 a[204:205], v165 offset:36864
    v_accvgpr_read_b32 v212, a20
    v_mfma_f32_16x16x32_bf16 a[124:127], a[192:195], v[4:7], 0
    ds_read_b64_tr_b16 a[206:207], v165 offset:38912
    v_accvgpr_read_b32 v213, a21
    v_mfma_f32_16x16x32_bf16 a[128:131], a[192:195], v[8:11], 0
    ds_read_b64_tr_b16 a[208:209], v166 offset:36864
    v_accvgpr_read_b32 v214, a22
    v_mfma_f32_16x16x32_bf16 a[132:135], a[192:195], v[12:15], 0
    ds_read_b64_tr_b16 a[210:211], v166 offset:38912
    v_accvgpr_read_b32 v215, a23
    v_mfma_f32_16x16x32_bf16 a[136:139], a[192:195], v[16:19], 0
    s_waitcnt lgkmcnt(6)
    ds_read_b64_tr_b16 a[212:213], v167 offset:36864
    v_cvt_pk_bf16_f32 v216, v208, v209
    v_mfma_f32_16x16x32_bf16 a[140:143], a[196:199], v[0:3], 0
    ds_read_b64_tr_b16 a[214:215], v167 offset:38912
    v_cvt_pk_bf16_f32 v217, v210, v211
    v_mfma_f32_16x16x32_bf16 a[144:147], a[196:199], v[4:7], 0
    v_cvt_pk_bf16_f32 v218, v212, v213
    v_mfma_f32_16x16x32_bf16 a[148:151], a[196:199], v[8:11], 0
    v_cvt_pk_bf16_f32 v219, v214, v215
    v_mfma_f32_16x16x32_bf16 a[152:155], a[196:199], v[12:15], 0
    s_mov_b32 s32, 20480
    buffer_store_dwordx4 v[216:219], v207, s[24:27], s32 offen sc1
    v_mfma_f32_16x16x32_bf16 a[156:159], a[196:199], v[16:19], 0
    s_waitcnt lgkmcnt(6)
    v_accvgpr_read_b32 v220, a4
    v_mfma_f32_16x16x32_bf16 a[80:83], a[200:203], v[20:23], a[80:83]
    v_accvgpr_read_b32 v221, a5
    v_mfma_f32_16x16x32_bf16 a[84:87], a[200:203], v[24:27], a[84:87]
    v_accvgpr_read_b32 v222, a6
    v_mfma_f32_16x16x32_bf16 a[88:91], a[200:203], v[28:31], a[88:91]
    v_accvgpr_read_b32 v223, a7
    v_mfma_f32_16x16x32_bf16 a[92:95], a[200:203], v[32:35], a[92:95]
    v_accvgpr_read_b32 v224, a24
    v_mfma_f32_16x16x32_bf16 a[96:99], a[200:203], v[36:39], a[96:99]
    v_accvgpr_read_b32 v225, a25
    s_waitcnt lgkmcnt(4)
    v_mfma_f32_16x16x32_bf16 a[100:103], a[204:207], v[20:23], a[100:103]
    ds_read_b64_tr_b16 a[184:185], v164 offset:16384
    v_accvgpr_read_b32 v226, a26
    v_mfma_f32_16x16x32_bf16 a[104:107], a[204:207], v[24:27], a[104:107]
    ds_read_b64_tr_b16 a[186:187], v164 offset:18432
    v_accvgpr_read_b32 v227, a27
    v_mfma_f32_16x16x32_bf16 a[108:111], a[204:207], v[28:31], a[108:111]
    ds_read_b64_tr_b16 a[188:189], v165 offset:16384
    v_cvt_pk_bf16_f32 v228, v220, v221
    v_mfma_f32_16x16x32_bf16 a[112:115], a[204:207], v[32:35], a[112:115]
    ds_read_b64_tr_b16 a[190:191], v165 offset:18432
    v_cvt_pk_bf16_f32 v229, v222, v223
    v_mfma_f32_16x16x32_bf16 a[116:119], a[204:207], v[36:39], a[116:119]
    s_waitcnt lgkmcnt(6)
    ds_read_b64_tr_b16 a[192:193], v166 offset:16384
    v_cvt_pk_bf16_f32 v230, v224, v225
    v_mfma_f32_16x16x32_bf16 a[120:123], a[208:211], v[20:23], a[120:123]
    ds_read_b64_tr_b16 a[194:195], v166 offset:18432
    v_cvt_pk_bf16_f32 v231, v226, v227
    v_mfma_f32_16x16x32_bf16 a[124:127], a[208:211], v[24:27], a[124:127]
    s_mov_b32 s32, 21504
    buffer_store_dwordx4 v[228:231], v207, s[24:27], s32 offen sc1
    v_mfma_f32_16x16x32_bf16 a[128:131], a[208:211], v[28:31], a[128:131]
    v_accvgpr_read_b32 v208, a8
    v_mfma_f32_16x16x32_bf16 a[132:135], a[208:211], v[32:35], a[132:135]
    v_accvgpr_read_b32 v209, a9
    v_mfma_f32_16x16x32_bf16 a[136:139], a[208:211], v[36:39], a[136:139]
    s_waitcnt lgkmcnt(6)
    v_accvgpr_read_b32 v210, a10
    v_mfma_f32_16x16x32_bf16 a[140:143], a[212:215], v[20:23], a[140:143]
    v_accvgpr_read_b32 v211, a11
    v_mfma_f32_16x16x32_bf16 a[144:147], a[212:215], v[24:27], a[144:147]
    v_accvgpr_read_b32 v212, a28
    v_mfma_f32_16x16x32_bf16 a[148:151], a[212:215], v[28:31], a[148:151]
    v_accvgpr_read_b32 v213, a29
    v_mfma_f32_16x16x32_bf16 a[152:155], a[212:215], v[32:35], a[152:155]
    v_accvgpr_read_b32 v214, a30
    v_mfma_f32_16x16x32_bf16 a[156:159], a[212:215], v[36:39], a[156:159]
    s_waitcnt lgkmcnt(4)
    v_accvgpr_read_b32 v215, a31
    v_mfma_f32_16x16x32_bf16 a[80:83], a[184:187], v[40:43], a[80:83]
    ds_read_b64_tr_b16 a[196:197], v167 offset:16384
    v_cvt_pk_bf16_f32 v216, v208, v209
    v_mfma_f32_16x16x32_bf16 a[84:87], a[184:187], v[44:47], a[84:87]
    ds_read_b64_tr_b16 a[198:199], v167 offset:18432
    v_cvt_pk_bf16_f32 v217, v210, v211
    v_mfma_f32_16x16x32_bf16 a[88:91], a[184:187], v[48:51], a[88:91]
    v_cvt_pk_bf16_f32 v218, v212, v213
    v_mfma_f32_16x16x32_bf16 a[92:95], a[184:187], v[52:55], a[92:95]
    v_cvt_pk_bf16_f32 v219, v214, v215
    v_mfma_f32_16x16x32_bf16 a[96:99], a[184:187], v[56:59], a[96:99]
    s_waitcnt lgkmcnt(4)
    s_mov_b32 s32, 22528
    v_mfma_f32_16x16x32_bf16 a[100:103], a[188:191], v[40:43], a[100:103]
    ds_read_b64_tr_b16 a[200:201], v164 offset:20480
    v_mfma_f32_16x16x32_bf16 a[104:107], a[188:191], v[44:47], a[104:107]
    ds_read_b64_tr_b16 a[202:203], v164 offset:22528
    v_mfma_f32_16x16x32_bf16 a[108:111], a[188:191], v[48:51], a[108:111]
    buffer_store_dwordx4 v[216:219], v207, s[24:27], s32 offen sc1
    v_mfma_f32_16x16x32_bf16 a[112:115], a[188:191], v[52:55], a[112:115]
    v_accvgpr_read_b32 v220, a12
    v_mfma_f32_16x16x32_bf16 a[116:119], a[188:191], v[56:59], a[116:119]
    s_waitcnt lgkmcnt(4)
    v_accvgpr_read_b32 v221, a13
    v_mfma_f32_16x16x32_bf16 a[120:123], a[192:195], v[40:43], a[120:123]
    ds_read_b64_tr_b16 a[204:205], v165 offset:20480
    v_accvgpr_read_b32 v222, a14
    v_mfma_f32_16x16x32_bf16 a[124:127], a[192:195], v[44:47], a[124:127]
    ds_read_b64_tr_b16 a[206:207], v165 offset:22528
    v_accvgpr_read_b32 v223, a15
    v_mfma_f32_16x16x32_bf16 a[128:131], a[192:195], v[48:51], a[128:131]
    ds_read_b64_tr_b16 a[208:209], v166 offset:20480
    v_accvgpr_read_b32 v224, a32
    v_mfma_f32_16x16x32_bf16 a[132:135], a[192:195], v[52:55], a[132:135]
    ds_read_b64_tr_b16 a[210:211], v166 offset:22528
    v_accvgpr_read_b32 v225, a33
    v_mfma_f32_16x16x32_bf16 a[136:139], a[192:195], v[56:59], a[136:139]
    s_waitcnt lgkmcnt(6)
    ds_read_b64_tr_b16 a[212:213], v167 offset:20480
    v_accvgpr_read_b32 v226, a34
    v_mfma_f32_16x16x32_bf16 a[140:143], a[196:199], v[40:43], a[140:143]
    ds_read_b64_tr_b16 a[214:215], v167 offset:22528
    v_accvgpr_read_b32 v227, a35
    v_mfma_f32_16x16x32_bf16 a[144:147], a[196:199], v[44:47], a[144:147]
    v_cvt_pk_bf16_f32 v228, v220, v221
    v_mfma_f32_16x16x32_bf16 a[148:151], a[196:199], v[48:51], a[148:151]
    v_cvt_pk_bf16_f32 v229, v222, v223
    v_mfma_f32_16x16x32_bf16 a[152:155], a[196:199], v[52:55], a[152:155]
    v_cvt_pk_bf16_f32 v230, v224, v225
    v_mfma_f32_16x16x32_bf16 a[156:159], a[196:199], v[56:59], a[156:159]
    s_waitcnt lgkmcnt(6)
    v_cvt_pk_bf16_f32 v231, v226, v227
    v_mfma_f32_16x16x32_bf16 a[80:83], a[200:203], v[60:63], a[80:83]
    s_mov_b32 s32, 23552
    buffer_store_dwordx4 v[228:231], v207, s[24:27], s32 offen sc1
    v_mfma_f32_16x16x32_bf16 a[84:87], a[200:203], v[64:67], a[84:87]
    v_accvgpr_read_b32 v208, a16
    v_mfma_f32_16x16x32_bf16 a[88:91], a[200:203], v[68:71], a[88:91]
    v_accvgpr_read_b32 v209, a17
    v_mfma_f32_16x16x32_bf16 a[92:95], a[200:203], v[72:75], a[92:95]
    v_accvgpr_read_b32 v210, a18
    v_mfma_f32_16x16x32_bf16 a[96:99], a[200:203], v[76:79], a[96:99]
    v_accvgpr_read_b32 v211, a19
    s_waitcnt lgkmcnt(4)
    v_mfma_f32_16x16x32_bf16 a[100:103], a[204:207], v[60:63], a[100:103]
    ds_read_b64_tr_b16 a[184:185], v164 offset:49152
    v_accvgpr_read_b32 v212, a36
    v_mfma_f32_16x16x32_bf16 a[104:107], a[204:207], v[64:67], a[104:107]
    ds_read_b64_tr_b16 a[186:187], v164 offset:51200
    v_accvgpr_read_b32 v213, a37
    v_mfma_f32_16x16x32_bf16 a[108:111], a[204:207], v[68:71], a[108:111]
    ds_read_b64_tr_b16 a[188:189], v165 offset:49152
    v_accvgpr_read_b32 v214, a38
    v_mfma_f32_16x16x32_bf16 a[112:115], a[204:207], v[72:75], a[112:115]
    ds_read_b64_tr_b16 a[190:191], v165 offset:51200
    v_accvgpr_read_b32 v215, a39
    v_mfma_f32_16x16x32_bf16 a[116:119], a[204:207], v[76:79], a[116:119]
    s_waitcnt lgkmcnt(6)
    ds_read_b64_tr_b16 a[192:193], v166 offset:49152
    v_cvt_pk_bf16_f32 v216, v208, v209
    v_mfma_f32_16x16x32_bf16 a[120:123], a[208:211], v[60:63], a[120:123]
    ds_read_b64_tr_b16 a[194:195], v166 offset:51200
    v_cvt_pk_bf16_f32 v217, v210, v211
    v_mfma_f32_16x16x32_bf16 a[124:127], a[208:211], v[64:67], a[124:127]
    v_cvt_pk_bf16_f32 v218, v212, v213
    v_mfma_f32_16x16x32_bf16 a[128:131], a[208:211], v[68:71], a[128:131]
    v_cvt_pk_bf16_f32 v219, v214, v215
    v_mfma_f32_16x16x32_bf16 a[132:135], a[208:211], v[72:75], a[132:135]
    s_mov_b32 s32, 24576
    buffer_store_dwordx4 v[216:219], v207, s[24:27], s32 offen sc1
    v_mfma_f32_16x16x32_bf16 a[136:139], a[208:211], v[76:79], a[136:139]
    s_waitcnt lgkmcnt(6)
    v_accvgpr_read_b32 v220, a216
    v_mfma_f32_16x16x32_bf16 a[140:143], a[212:215], v[60:63], a[140:143]
    v_accvgpr_read_b32 v221, a217
    v_mfma_f32_16x16x32_bf16 a[144:147], a[212:215], v[64:67], a[144:147]
    v_accvgpr_read_b32 v222, a218
    v_mfma_f32_16x16x32_bf16 a[148:151], a[212:215], v[68:71], a[148:151]
    v_accvgpr_read_b32 v223, a219
    v_mfma_f32_16x16x32_bf16 a[152:155], a[212:215], v[72:75], a[152:155]
    v_accvgpr_read_b32 v224, a236
    v_mfma_f32_16x16x32_bf16 a[156:159], a[212:215], v[76:79], a[156:159]
    s_waitcnt lgkmcnt(4)
    v_accvgpr_read_b32 v225, a237
    v_mfma_f32_16x16x32_bf16 a[80:83], a[184:187], v[80:83], a[80:83]
    ds_read_b64_tr_b16 a[196:197], v167 offset:49152
    v_accvgpr_read_b32 v226, a238
    v_mfma_f32_16x16x32_bf16 a[84:87], a[184:187], v[84:87], a[84:87]
    ds_read_b64_tr_b16 a[198:199], v167 offset:51200
    v_accvgpr_read_b32 v227, a239
    v_mfma_f32_16x16x32_bf16 a[88:91], a[184:187], v[88:91], a[88:91]
    v_cvt_pk_bf16_f32 v228, v220, v221
    v_mfma_f32_16x16x32_bf16 a[92:95], a[184:187], v[92:95], a[92:95]
    v_cvt_pk_bf16_f32 v229, v222, v223
    v_mfma_f32_16x16x32_bf16 a[96:99], a[184:187], v[96:99], a[96:99]
    s_waitcnt lgkmcnt(4)
    v_cvt_pk_bf16_f32 v230, v224, v225
    v_mfma_f32_16x16x32_bf16 a[100:103], a[188:191], v[80:83], a[100:103]
    ds_read_b64_tr_b16 a[200:201], v164 offset:53248
    v_cvt_pk_bf16_f32 v231, v226, v227
    v_mfma_f32_16x16x32_bf16 a[104:107], a[188:191], v[84:87], a[104:107]
    s_mov_b32 s32, 25600
    ds_read_b64_tr_b16 a[202:203], v164 offset:55296
    v_mfma_f32_16x16x32_bf16 a[108:111], a[188:191], v[88:91], a[108:111]
    buffer_store_dwordx4 v[228:231], v207, s[24:27], s32 offen sc1
    v_mfma_f32_16x16x32_bf16 a[112:115], a[188:191], v[92:95], a[112:115]
    v_accvgpr_read_b32 v208, a220
    v_mfma_f32_16x16x32_bf16 a[116:119], a[188:191], v[96:99], a[116:119]
    s_waitcnt lgkmcnt(4)
    v_accvgpr_read_b32 v209, a221
    v_mfma_f32_16x16x32_bf16 a[120:123], a[192:195], v[80:83], a[120:123]
    ds_read_b64_tr_b16 a[204:205], v165 offset:53248
    v_accvgpr_read_b32 v210, a222
    v_mfma_f32_16x16x32_bf16 a[124:127], a[192:195], v[84:87], a[124:127]
    ds_read_b64_tr_b16 a[206:207], v165 offset:55296
    v_accvgpr_read_b32 v211, a223
    v_mfma_f32_16x16x32_bf16 a[128:131], a[192:195], v[88:91], a[128:131]
    ds_read_b64_tr_b16 a[208:209], v166 offset:53248
    v_accvgpr_read_b32 v212, a240
    v_mfma_f32_16x16x32_bf16 a[132:135], a[192:195], v[92:95], a[132:135]
    ds_read_b64_tr_b16 a[210:211], v166 offset:55296
    v_accvgpr_read_b32 v213, a241
    v_mfma_f32_16x16x32_bf16 a[136:139], a[192:195], v[96:99], a[136:139]
    s_waitcnt lgkmcnt(6)
    ds_read_b64_tr_b16 a[212:213], v167 offset:53248
    v_accvgpr_read_b32 v214, a242
    v_mfma_f32_16x16x32_bf16 a[140:143], a[196:199], v[80:83], a[140:143]
    ds_read_b64_tr_b16 a[214:215], v167 offset:55296
    v_accvgpr_read_b32 v215, a243
    v_mfma_f32_16x16x32_bf16 a[144:147], a[196:199], v[84:87], a[144:147]
    v_cvt_pk_bf16_f32 v216, v208, v209
    v_mfma_f32_16x16x32_bf16 a[148:151], a[196:199], v[88:91], a[148:151]
    v_cvt_pk_bf16_f32 v217, v210, v211
    v_mfma_f32_16x16x32_bf16 a[152:155], a[196:199], v[92:95], a[152:155]
    v_cvt_pk_bf16_f32 v218, v212, v213
    v_mfma_f32_16x16x32_bf16 a[156:159], a[196:199], v[96:99], a[156:159]
    s_waitcnt lgkmcnt(6)
    v_cvt_pk_bf16_f32 v219, v214, v215
    v_mfma_f32_16x16x32_bf16 a[80:83], a[200:203], v[100:103], a[80:83]
    s_mov_b32 s32, 26624
    buffer_store_dwordx4 v[216:219], v207, s[24:27], s32 offen sc1
    v_mfma_f32_16x16x32_bf16 a[84:87], a[200:203], v[104:107], a[84:87]
    v_accvgpr_read_b32 v220, a224
    v_mfma_f32_16x16x32_bf16 a[88:91], a[200:203], v[108:111], a[88:91]
    v_accvgpr_read_b32 v221, a225
    v_mfma_f32_16x16x32_bf16 a[92:95], a[200:203], v[112:115], a[92:95]
    v_accvgpr_read_b32 v222, a226
    v_mfma_f32_16x16x32_bf16 a[96:99], a[200:203], v[116:119], a[96:99]
    v_accvgpr_read_b32 v223, a227
    s_waitcnt lgkmcnt(4)
    v_mfma_f32_16x16x32_bf16 a[100:103], a[204:207], v[100:103], a[100:103]
    ds_read_b64_tr_b16 a[184:185], v160 offset:0
    v_accvgpr_read_b32 v224, a244
    v_mfma_f32_16x16x32_bf16 a[104:107], a[204:207], v[104:107], a[104:107]
    ds_read_b64_tr_b16 a[186:187], v160 offset:2048
    v_accvgpr_read_b32 v225, a245
    v_mfma_f32_16x16x32_bf16 a[108:111], a[204:207], v[108:111], a[108:111]
    ds_read_b64_tr_b16 a[188:189], v161 offset:0
    v_accvgpr_read_b32 v226, a246
    v_mfma_f32_16x16x32_bf16 a[112:115], a[204:207], v[112:115], a[112:115]
    ds_read_b64_tr_b16 a[190:191], v161 offset:2048
    v_accvgpr_read_b32 v227, a247
    v_mfma_f32_16x16x32_bf16 a[116:119], a[204:207], v[116:119], a[116:119]
    s_waitcnt lgkmcnt(6)
    ds_read_b64_tr_b16 a[192:193], v162 offset:0
    v_cvt_pk_bf16_f32 v228, v220, v221
    v_mfma_f32_16x16x32_bf16 a[120:123], a[208:211], v[100:103], a[120:123]
    ds_read_b64_tr_b16 a[194:195], v162 offset:2048
    v_cvt_pk_bf16_f32 v229, v222, v223
    v_mfma_f32_16x16x32_bf16 a[124:127], a[208:211], v[104:107], a[124:127]
    v_cvt_pk_bf16_f32 v230, v224, v225
    v_mfma_f32_16x16x32_bf16 a[128:131], a[208:211], v[108:111], a[128:131]
    v_cvt_pk_bf16_f32 v231, v226, v227
    v_mfma_f32_16x16x32_bf16 a[132:135], a[208:211], v[112:115], a[132:135]
    s_mov_b32 s32, 27648
    buffer_store_dwordx4 v[228:231], v207, s[24:27], s32 offen sc1
    v_mfma_f32_16x16x32_bf16 a[136:139], a[208:211], v[116:119], a[136:139]
    s_waitcnt lgkmcnt(6)
    v_accvgpr_read_b32 v208, a228
    v_mfma_f32_16x16x32_bf16 a[140:143], a[212:215], v[100:103], a[140:143]
    v_accvgpr_read_b32 v209, a229
    v_mfma_f32_16x16x32_bf16 a[144:147], a[212:215], v[104:107], a[144:147]
    v_accvgpr_read_b32 v210, a230
    v_mfma_f32_16x16x32_bf16 a[148:151], a[212:215], v[108:111], a[148:151]
    v_accvgpr_read_b32 v211, a231
    v_mfma_f32_16x16x32_bf16 a[152:155], a[212:215], v[112:115], a[152:155]
    v_accvgpr_read_b32 v212, a248
    v_mfma_f32_16x16x32_bf16 a[156:159], a[212:215], v[116:119], a[156:159]
    s_waitcnt lgkmcnt(4)
    v_accvgpr_read_b32 v213, a249
    v_mfma_f32_16x16x32_bf16 a[80:83], a[184:187], v[120:123], a[80:83]
    ds_read_b64_tr_b16 a[196:197], v163 offset:0
    v_accvgpr_read_b32 v214, a250
    v_mfma_f32_16x16x32_bf16 a[84:87], a[184:187], v[124:127], a[84:87]
    ds_read_b64_tr_b16 a[198:199], v163 offset:2048
    v_accvgpr_read_b32 v215, a251
    v_mfma_f32_16x16x32_bf16 a[88:91], a[184:187], v[128:131], a[88:91]
    v_cvt_pk_bf16_f32 v216, v208, v209
    v_mfma_f32_16x16x32_bf16 a[92:95], a[184:187], v[132:135], a[92:95]
    v_cvt_pk_bf16_f32 v217, v210, v211
    v_mfma_f32_16x16x32_bf16 a[96:99], a[184:187], v[136:139], a[96:99]
    s_waitcnt lgkmcnt(4)
    v_cvt_pk_bf16_f32 v218, v212, v213
    v_mfma_f32_16x16x32_bf16 a[100:103], a[188:191], v[120:123], a[100:103]
    ds_read_b64_tr_b16 a[200:201], v160 offset:4096
    v_cvt_pk_bf16_f32 v219, v214, v215
    v_mfma_f32_16x16x32_bf16 a[104:107], a[188:191], v[124:127], a[104:107]
    s_mov_b32 s32, 28672
    ds_read_b64_tr_b16 a[202:203], v160 offset:6144
    v_mfma_f32_16x16x32_bf16 a[108:111], a[188:191], v[128:131], a[108:111]
    buffer_store_dwordx4 v[216:219], v207, s[24:27], s32 offen sc1
    v_mfma_f32_16x16x32_bf16 a[112:115], a[188:191], v[132:135], a[112:115]
    v_accvgpr_read_b32 v220, a232
    v_mfma_f32_16x16x32_bf16 a[116:119], a[188:191], v[136:139], a[116:119]
    s_waitcnt lgkmcnt(4)
    v_accvgpr_read_b32 v221, a233
    v_mfma_f32_16x16x32_bf16 a[120:123], a[192:195], v[120:123], a[120:123]
    ds_read_b64_tr_b16 a[204:205], v161 offset:4096
    v_accvgpr_read_b32 v222, a234
    v_mfma_f32_16x16x32_bf16 a[124:127], a[192:195], v[124:127], a[124:127]
    ds_read_b64_tr_b16 a[206:207], v161 offset:6144
    v_accvgpr_read_b32 v223, a235
    v_mfma_f32_16x16x32_bf16 a[128:131], a[192:195], v[128:131], a[128:131]
    ds_read_b64_tr_b16 a[208:209], v162 offset:4096
    v_accvgpr_read_b32 v224, a252
    v_mfma_f32_16x16x32_bf16 a[132:135], a[192:195], v[132:135], a[132:135]
    ds_read_b64_tr_b16 a[210:211], v162 offset:6144
    v_accvgpr_read_b32 v225, a253
    v_mfma_f32_16x16x32_bf16 a[136:139], a[192:195], v[136:139], a[136:139]
    s_waitcnt lgkmcnt(6)
    ds_read_b64_tr_b16 a[212:213], v163 offset:4096
    v_accvgpr_read_b32 v226, a254
    v_mfma_f32_16x16x32_bf16 a[140:143], a[196:199], v[120:123], a[140:143]
    ds_read_b64_tr_b16 a[214:215], v163 offset:6144
    v_accvgpr_read_b32 v227, a255
    v_mfma_f32_16x16x32_bf16 a[144:147], a[196:199], v[124:127], a[144:147]
    v_cvt_pk_bf16_f32 v228, v220, v221
    v_mfma_f32_16x16x32_bf16 a[148:151], a[196:199], v[128:131], a[148:151]
    v_cvt_pk_bf16_f32 v229, v222, v223
    v_mfma_f32_16x16x32_bf16 a[152:155], a[196:199], v[132:135], a[152:155]
    v_cvt_pk_bf16_f32 v230, v224, v225
    v_mfma_f32_16x16x32_bf16 a[156:159], a[196:199], v[136:139], a[156:159]
    s_waitcnt lgkmcnt(6)
    v_cvt_pk_bf16_f32 v231, v226, v227
    v_mfma_f32_16x16x32_bf16 a[80:83], a[200:203], v[140:143], a[80:83]
    s_mov_b32 s32, 29696
    buffer_store_dwordx4 v[228:231], v207, s[24:27], s32 offen sc1
    v_mfma_f32_16x16x32_bf16 a[84:87], a[200:203], v[144:147], a[84:87]
    v_mfma_f32_16x16x32_bf16 a[88:91], a[200:203], v[148:151], a[88:91]
    v_mfma_f32_16x16x32_bf16 a[92:95], a[200:203], v[152:155], a[92:95]
    v_mfma_f32_16x16x32_bf16 a[96:99], a[200:203], v[156:159], a[96:99]
    s_waitcnt lgkmcnt(4)
    v_mfma_f32_16x16x32_bf16 a[100:103], a[204:207], v[140:143], a[100:103]
    v_mfma_f32_16x16x32_bf16 a[104:107], a[204:207], v[144:147], a[104:107]
    v_mfma_f32_16x16x32_bf16 a[108:111], a[204:207], v[148:151], a[108:111]
    v_mfma_f32_16x16x32_bf16 a[112:115], a[204:207], v[152:155], a[112:115]
    v_mfma_f32_16x16x32_bf16 a[116:119], a[204:207], v[156:159], a[116:119]
    s_waitcnt lgkmcnt(2)
    v_mfma_f32_16x16x32_bf16 a[120:123], a[208:211], v[140:143], a[120:123]
    v_mfma_f32_16x16x32_bf16 a[124:127], a[208:211], v[144:147], a[124:127]
    v_mfma_f32_16x16x32_bf16 a[128:131], a[208:211], v[148:151], a[128:131]
    v_mfma_f32_16x16x32_bf16 a[132:135], a[208:211], v[152:155], a[132:135]
    v_mfma_f32_16x16x32_bf16 a[136:139], a[208:211], v[156:159], a[136:139]
    s_waitcnt lgkmcnt(0)
    v_mfma_f32_16x16x32_bf16 a[140:143], a[212:215], v[140:143], a[140:143]
    v_mfma_f32_16x16x32_bf16 a[144:147], a[212:215], v[144:147], a[144:147]
    v_mfma_f32_16x16x32_bf16 a[148:151], a[212:215], v[148:151], a[148:151]
    v_mfma_f32_16x16x32_bf16 a[152:155], a[212:215], v[152:155], a[152:155]
    v_mfma_f32_16x16x32_bf16 a[156:159], a[212:215], v[156:159], a[156:159]
    s_nop 7
    v_accvgpr_read_b32 v208, a80
    v_accvgpr_read_b32 v209, a81
    v_accvgpr_read_b32 v210, a82
    v_accvgpr_read_b32 v211, a83
    v_accvgpr_read_b32 v212, a100
    v_accvgpr_read_b32 v213, a101
    v_accvgpr_read_b32 v214, a102
    v_accvgpr_read_b32 v215, a103
    v_cvt_pk_bf16_f32 v216, v208, v209
    v_cvt_pk_bf16_f32 v217, v210, v211
    v_cvt_pk_bf16_f32 v218, v212, v213
    v_cvt_pk_bf16_f32 v219, v214, v215
    s_mov_b32 s32, 30720
    buffer_store_dwordx4 v[216:219], v207, s[24:27], s32 offen sc1
    v_accvgpr_read_b32 v220, a84
    v_accvgpr_read_b32 v221, a85
    v_accvgpr_read_b32 v222, a86
    v_accvgpr_read_b32 v223, a87
    v_accvgpr_read_b32 v224, a104
    v_accvgpr_read_b32 v225, a105
    v_accvgpr_read_b32 v226, a106
    v_accvgpr_read_b32 v227, a107
    v_cvt_pk_bf16_f32 v228, v220, v221
    v_cvt_pk_bf16_f32 v229, v222, v223
    v_cvt_pk_bf16_f32 v230, v224, v225
    v_cvt_pk_bf16_f32 v231, v226, v227
    s_mov_b32 s32, 31744
    buffer_store_dwordx4 v[228:231], v207, s[24:27], s32 offen sc1
    v_accvgpr_read_b32 v208, a88
    v_accvgpr_read_b32 v209, a89
    v_accvgpr_read_b32 v210, a90
    v_accvgpr_read_b32 v211, a91
    v_accvgpr_read_b32 v212, a108
    v_accvgpr_read_b32 v213, a109
    v_accvgpr_read_b32 v214, a110
    v_accvgpr_read_b32 v215, a111
    v_cvt_pk_bf16_f32 v216, v208, v209
    v_cvt_pk_bf16_f32 v217, v210, v211
    v_cvt_pk_bf16_f32 v218, v212, v213
    v_cvt_pk_bf16_f32 v219, v214, v215
    s_mov_b32 s32, 32768
    buffer_store_dwordx4 v[216:219], v207, s[24:27], s32 offen sc1
    v_accvgpr_read_b32 v220, a92
    v_accvgpr_read_b32 v221, a93
    v_accvgpr_read_b32 v222, a94
    v_accvgpr_read_b32 v223, a95
    v_accvgpr_read_b32 v224, a112
    v_accvgpr_read_b32 v225, a113
    v_accvgpr_read_b32 v226, a114
    v_accvgpr_read_b32 v227, a115
    v_cvt_pk_bf16_f32 v228, v220, v221
    v_cvt_pk_bf16_f32 v229, v222, v223
    v_cvt_pk_bf16_f32 v230, v224, v225
    v_cvt_pk_bf16_f32 v231, v226, v227
    s_mov_b32 s32, 33792
    buffer_store_dwordx4 v[228:231], v207, s[24:27], s32 offen sc1
    v_accvgpr_read_b32 v208, a96
    v_accvgpr_read_b32 v209, a97
    v_accvgpr_read_b32 v210, a98
    v_accvgpr_read_b32 v211, a99
    v_accvgpr_read_b32 v212, a116
    v_accvgpr_read_b32 v213, a117
    v_accvgpr_read_b32 v214, a118
    v_accvgpr_read_b32 v215, a119
    v_cvt_pk_bf16_f32 v216, v208, v209
    v_cvt_pk_bf16_f32 v217, v210, v211
    v_cvt_pk_bf16_f32 v218, v212, v213
    v_cvt_pk_bf16_f32 v219, v214, v215
    s_mov_b32 s32, 34816
    buffer_store_dwordx4 v[216:219], v207, s[24:27], s32 offen sc1
    v_accvgpr_read_b32 v220, a120
    v_accvgpr_read_b32 v221, a121
    v_accvgpr_read_b32 v222, a122
    v_accvgpr_read_b32 v223, a123
    v_accvgpr_read_b32 v224, a140
    v_accvgpr_read_b32 v225, a141
    v_accvgpr_read_b32 v226, a142
    v_accvgpr_read_b32 v227, a143
    v_cvt_pk_bf16_f32 v228, v220, v221
    v_cvt_pk_bf16_f32 v229, v222, v223
    v_cvt_pk_bf16_f32 v230, v224, v225
    v_cvt_pk_bf16_f32 v231, v226, v227
    s_mov_b32 s32, 35840
    buffer_store_dwordx4 v[228:231], v207, s[24:27], s32 offen sc1
    v_accvgpr_read_b32 v208, a124
    v_accvgpr_read_b32 v209, a125
    v_accvgpr_read_b32 v210, a126
    v_accvgpr_read_b32 v211, a127
    v_accvgpr_read_b32 v212, a144
    v_accvgpr_read_b32 v213, a145
    v_accvgpr_read_b32 v214, a146
    v_accvgpr_read_b32 v215, a147
    v_cvt_pk_bf16_f32 v216, v208, v209
    v_cvt_pk_bf16_f32 v217, v210, v211
    v_cvt_pk_bf16_f32 v218, v212, v213
    v_cvt_pk_bf16_f32 v219, v214, v215
    s_mov_b32 s32, 36864
    buffer_store_dwordx4 v[216:219], v207, s[24:27], s32 offen sc1
    v_accvgpr_read_b32 v220, a128
    v_accvgpr_read_b32 v221, a129
    v_accvgpr_read_b32 v222, a130
    v_accvgpr_read_b32 v223, a131
    v_accvgpr_read_b32 v224, a148
    v_accvgpr_read_b32 v225, a149
    v_accvgpr_read_b32 v226, a150
    v_accvgpr_read_b32 v227, a151
    v_cvt_pk_bf16_f32 v228, v220, v221
    v_cvt_pk_bf16_f32 v229, v222, v223
    v_cvt_pk_bf16_f32 v230, v224, v225
    v_cvt_pk_bf16_f32 v231, v226, v227
    s_mov_b32 s32, 37888
    buffer_store_dwordx4 v[228:231], v207, s[24:27], s32 offen sc1
    v_accvgpr_read_b32 v208, a132
    v_accvgpr_read_b32 v209, a133
    v_accvgpr_read_b32 v210, a134
    v_accvgpr_read_b32 v211, a135
    v_accvgpr_read_b32 v212, a152
    v_accvgpr_read_b32 v213, a153
    v_accvgpr_read_b32 v214, a154
    v_accvgpr_read_b32 v215, a155
    v_cvt_pk_bf16_f32 v216, v208, v209
    v_cvt_pk_bf16_f32 v217, v210, v211
    v_cvt_pk_bf16_f32 v218, v212, v213
    v_cvt_pk_bf16_f32 v219, v214, v215
    s_mov_b32 s32, 38912
    buffer_store_dwordx4 v[216:219], v207, s[24:27], s32 offen sc1
    v_accvgpr_read_b32 v220, a136
    v_accvgpr_read_b32 v221, a137
    v_accvgpr_read_b32 v222, a138
    v_accvgpr_read_b32 v223, a139
    v_accvgpr_read_b32 v224, a156
    v_accvgpr_read_b32 v225, a157
    v_accvgpr_read_b32 v226, a158
    v_accvgpr_read_b32 v227, a159
    v_cvt_pk_bf16_f32 v228, v220, v221
    v_cvt_pk_bf16_f32 v229, v222, v223
    v_cvt_pk_bf16_f32 v230, v224, v225
    v_cvt_pk_bf16_f32 v231, v226, v227
    s_mov_b32 s32, 39936
    buffer_store_dwordx4 v[228:231], v207, s[24:27], s32 offen sc1
    s_cmp_lg_u64 s[64:65], 0
    s_cselect_b32 s3, 1, 0
    v_mov_b32 v202, s3
    s_lshl_b32 s7, s4, 2
    s_add_u32 s7, s7, 16384
    v_mov_b32 v203, s7
    ds_write_b32 v203, v202
    s_waitcnt lgkmcnt(0)
    s_barrier
    v_mov_b32 v203, 16384
    ds_read_b128 v[204:207], v203
    s_waitcnt lgkmcnt(0)
    v_or_b32 v204, v204, v205
    v_or3_b32 v204, v204, v206, v207
    s_nop 0
    v_readfirstlane_b32 s3, v204
    s_cmp_eq_u32 s92, 0
    s_cselect_b32 s3, s3, 0
    s_cmp_eq_u32 s3, 0
    s_cbranch_scc1 L_fine_attn_kernel
    s_mov_b32 s92, 1
    s_waitcnt vmcnt(0)
    s_barrier
    v_mbcnt_lo_u32_b32 v0, -1, 0
    v_mbcnt_hi_u32_b32 v0, -1, v0
    s_lshl_b32 s3, s4, 6
    v_add_u32 v0, s3, v0
    s_branch L_restart_attn_kernel
L_fine_attn_kernel:
L_end_attn_kernel:
    s_endpgm
L_maxpass_attn_kernel:
    s_waitcnt vmcnt(0) lgkmcnt(0)
    v_mov_b32 v120, 0xff800000
    v_mov_b32 v121, 0xff800000
    v_mov_b32 v122, 0xff800000
    v_mov_b32 v123, 0xff800000
    v_mov_b32 v124, 0xff800000
    s_mov_b32 s44, 0
    s_lshl_b32 s33, s6, 12
L_maxloop_attn_kernel:
    s_barrier
    s_mov_b32 m0, s39
    s_nop 0
    buffer_load_dwordx4 v252, s[16:19], s33 offen offset:0 lds
    buffer_load_dwordx4 v253, s[16:19], s33 offen offset:1024 lds
    buffer_load_dwordx4 v254, s[16:19], s33 offen offset:2048 lds
    buffer_load_dwordx4 v255, s[16:19], s33 offen offset:3072 lds
    s_waitcnt vmcnt(0)
    s_barrier
    ds_read_b128 a[184:187], v240 offset:0
    ds_read_b128 a[188:191], v241 offset:0
    ds_read_b128 a[192:195], v242 offset:0
    ds_read_b128 a[196:199], v243 offset:0
    ds_read_b128 a[200:203], v240 offset:4096
    ds_read_b128 a[204:207], v241 offset:4096
    ds_read_b128 a[208:211], v242 offset:4096
    ds_read_b128 a[212:215], v243 offset:4096
    s_waitcnt lgkmcnt(0)
    v_mfma_f32_16x16x32_bf16 v[80:83], a[184:187], v[0:3], 0
    v_mfma_f32_16x16x32_bf16 v[84:87], a[184:187], v[4:7], 0
    v_mfma_f32_16x16x32_bf16 v[88:91], a[184:187], v[8:11], 0
    v_mfma_f32_16x16x32_bf16 v[92:95], a[184:187], v[12:15], 0
    v_mfma_f32_16x16x32_bf16 v[96:99], a[184:187], v[16:19], 0
    v_mfma_f32_16x16x32_bf16 v[80:83], a[188:191], v[20:23], v[80:83]
    v_mfma_f32_16x16x32_bf16 v[84:87], a[188:191], v[24:27], v[84:87]
    v_mfma_f32_16x16x32_bf16 v[88:91], a[188:191], v[28:31], v[88:91]
    v_mfma_f32_16x16x32_bf16 v[92:95], a[188:191], v[32:35], v[92:95]
    v_mfma_f32_16x16x32_bf16 v[96:99], a[188:191], v[36:39], v[96:99]
    v_mfma_f32_16x16x32_bf16 v[80:83], a[192:195], v[40:43], v[80:83]
    v_mfma_f32_16x16x32_bf16 v[84:87], a[192:195], v[44:47], v[84:87]
    v_mfma_f32_16x16x32_bf16 v[88:91], a[192:195], v[48:51], v[88:91]
    v_mfma_f32_16x16x32_bf16 v[92:95], a[192:195], v[52:55], v[92:95]
    v_mfma_f32_16x16x32_bf16 v[96:99], a[192:195], v[56:59], v[96:99]
    v_mfma_f32_16x16x32_bf16 v[80:83], a[196:199], v[60:63], v[80:83]
    v_mfma_f32_16x16x32_bf16 v[84:87], a[196:199], v[64:67], v[84:87]
    v_mfma_f32_16x16x32_bf16 v[88:91], a[196:199], v[68:71], v[88:91]
    v_mfma_f32_16x16x32_bf16 v[92:95], a[196:199], v[72:75], v[92:95]
    v_mfma_f32_16x16x32_bf16 v[96:99], a[196:199], v[76:79], v[96:99]
    v_mfma_f32_16x16x32_bf16 v[100:103], a[200:203], v[0:3], 0
    v_mfma_f32_16x16x32_bf16 v[104:107], a[200:203], v[4:7], 0
    v_mfma_f32_16x16x32_bf16 v[108:111], a[200:203], v[8:11], 0
    v_mfma_f32_16x16x32_bf16 v[112:115], a[200:203], v[12:15], 0
    v_mfma_f32_16x16x32_bf16 v[116:119], a[200:203], v[16:19], 0
    v_mfma_f32_16x16x32_bf16 v[100:103], a[204:207], v[20:23], v[100:103]
    v_mfma_f32_16x16x32_bf16 v[104:107], a[204:207], v[24:27], v[104:107]
    v_mfma_f32_16x16x32_bf16 v[108:111], a[204:207], v[28:31], v[108:111]
    v_mfma_f32_16x16x32_bf16 v[112:115], a[204:207], v[32:35], v[112:115]
    v_mfma_f32_16x16x32_bf16 v[116:119], a[204:207], v[36:39], v[116:119]
    v_mfma_f32_16x16x32_bf16 v[100:103], a[208:211], v[40:43], v[100:103]
    v_mfma_f32_16x16x32_bf16 v[104:107], a[208:211], v[44:47], v[104:107]
    v_mfma_f32_16x16x32_bf16 v[108:111], a[208:211], v[48:51], v[108:111]
    v_mfma_f32_16x16x32_bf16 v[112:115], a[208:211], v[52:55], v[112:115]
    v_mfma_f32_16x16x32_bf16 v[116:119], a[208:211], v[56:59], v[116:119]
    v_mfma_f32_16x16x32_bf16 v[100:103], a[212:215], v[60:63], v[100:103]
    v_mfma_f32_16x16x32_bf16 v[104:107], a[212:215], v[64:67], v[104:107]
    v_mfma_f32_16x16x32_bf16 v[108:111], a[212:215], v[68:71], v[108:111]
    v_mfma_f32_16x16x32_bf16 v[112:115], a[212:215], v[72:75], v[112:115]
    v_mfma_f32_16x16x32_bf16 v[116:119], a[212:215], v[76:79], v[116:119]
    s_nop 7
    s_nop 3
    v_max3_f32 v120, v80, v81, v120
    v_max3_f32 v120, v82, v83, v120
    v_max3_f32 v120, v100, v101, v120
    v_max3_f32 v120, v102, v103, v120
    v_max3_f32 v121, v84, v85, v121
    v_max3_f32 v121, v86, v87, v121
    v_max3_f32 v121, v104, v105, v121
    v_max3_f32 v121, v106, v107, v121
    v_max3_f32 v122, v88, v89, v122
    v_max3_f32 v122, v90, v91, v122
    v_max3_f32 v122, v108, v109, v122
    v_max3_f32 v122, v110, v111, v122
    v_max3_f32 v123, v92, v93, v123
    v_max3_f32 v123, v94, v95, v123
    v_max3_f32 v123, v112, v113, v123
    v_max3_f32 v123, v114, v115, v123
    v_max3_f32 v124, v96, v97, v124
    v_max3_f32 v124, v98, v99, v124
    v_max3_f32 v124, v116, v117, v124
    v_max3_f32 v124, v118, v119, v124
    s_add_u32 s33, s33, 8192
    s_add_u32 s44, s44, 1
    s_cmp_lt_u32 s44, 16
    s_cbranch_scc1 L_maxloop_attn_kernel
    s_barrier
    s_and_b32 s33, s93, 0x1ffff
    s_mov_b32 m0, s39
    s_nop 0
    buffer_load_dwordx4 v252, s[16:19], s33 offen offset:0 lds
    buffer_load_dwordx4 v253, s[16:19], s33 offen offset:1024 lds
    buffer_load_dwordx4 v254, s[16:19], s33 offen offset:2048 lds
    buffer_load_dwordx4 v255, s[16:19], s33 offen offset:3072 lds
    v_lshrrev_b32 v126, 2, v207
    v_xor_b32 v127, 64, v126
    v_xor_b32 v128, 0x80, v126
    ds_bpermute_b32 v129, v127, v120
    ds_bpermute_b32 v130, v127, v121
    ds_bpermute_b32 v131, v127, v122
    ds_bpermute_b32 v132, v127, v123
    ds_bpermute_b32 v133, v127, v124
    s_waitcnt lgkmcnt(0)
    v_max_f32 v120, v120, v129
    v_max_f32 v121, v121, v130
    v_max_f32 v122, v122, v131
    v_max_f32 v123, v123, v132
    v_max_f32 v124, v124, v133
    ds_bpermute_b32 v129, v128, v120
    ds_bpermute_b32 v130, v128, v121
    ds_bpermute_b32 v131, v128, v122
    ds_bpermute_b32 v132, v128, v123
    ds_bpermute_b32 v133, v128, v124
    s_waitcnt lgkmcnt(0)
    v_max_f32 v120, v120, v129
    v_max_f32 v121, v121, v130
    v_max_f32 v122, v122, v131
    v_max_f32 v123, v123, v132
    v_max_f32 v124, v124, v133
    v_sub_f32 v208, 0, v120
    v_sub_f32 v209, 0, v120
    v_sub_f32 v210, 0, v120
    v_sub_f32 v211, 0, v120
    v_sub_f32 v212, 0, v121
    v_sub_f32 v213, 0, v121
    v_sub_f32 v214, 0, v121
    v_sub_f32 v215, 0, v121
    v_sub_f32 v216, 0, v122
    v_sub_f32 v217, 0, v122
    v_sub_f32 v218, 0, v122
    v_sub_f32 v219, 0, v122
    v_sub_f32 v220, 0, v123
    v_sub_f32 v221, 0, v123
    v_sub_f32 v222, 0, v123
    v_sub_f32 v223, 0, v123
    v_sub_f32 v224, 0, v124
    v_sub_f32 v225, 0, v124
    v_sub_f32 v226, 0, v124
    v_sub_f32 v227, 0, v124
    s_waitcnt vmcnt(0)
    s_barrier
    ds_read_b128 a[184:187], v240 offset:0
    ds_read_b128 a[188:191], v241 offset:0
    ds_read_b128 a[192:195], v242 offset:0
    s_branch L_maxdone_attn_kernel
CODE_END:
.section .rodata,"a"
.p2align 6
.amdhsa_kernel attn_kernel
  .amdhsa_next_free_vgpr 512
  .amdhsa_next_free_sgpr 102
  .amdhsa_accum_offset 256
  .amdhsa_group_segment_fixed_size 0
  .amdhsa_kernarg_size 104
  .amdhsa_user_sgpr_count 2
  .amdhsa_user_sgpr_kernarg_segment_ptr 1
  .amdhsa_system_sgpr_workgroup_id_x 1
.end_amdhsa_kernel
.text
.globl reduce_kernel
.p2align 8
.type reduce_kernel,@function
reduce_kernel:

    s_cmp_ge_u32 s2, 256
    s_cbranch_scc1 L_end_reduce_kernel
    s_load_dwordx2 s[4:5], s[0:1], 80
    s_load_dwordx2 s[6:7], s[0:1], 96
    s_getpc_b64 s[34:35]
L_pc_reduce_kernel:
    s_sub_u32 s34, s34, L_pc_reduce_kernel-reduce_kernel
    s_subb_u32 s35, s35, 0
    v_and_b32 v88, 63, v0
    v_lshlrev_b32 v88, 7, v88
    v_min_u32 v88, K3_END-reduce_kernel-4, v88
    global_load_dword v89, v88, s[34:35]
    v_lshrrev_b32 v1, 6, v0
    v_and_b32 v2, 63, v0
    v_readfirstlane_b32 s8, v1
    s_lshr_b32 s9, s2, 4
    s_and_b32 s10, s2, 15
    s_mul_i32 s10, s10, 10
    s_mul_i32 s11, s8, 1
    s_add_u32 s10, s10, s11
    v_lshlrev_b32 v3, 4, v2
    s_waitcnt lgkmcnt(0)
    s_mul_i32 s11, s9, 2621440
    s_add_u32 s11, s11, 33554432
    s_add_u32 s16, s6, s11
    s_addc_u32 s17, s7, 0
    s_mov_b32 s18, 2621440
    s_mov_b32 s19, 0x20000
    s_add_u32 s12, s10, 0
    s_lshl_b32 s12, s12, 10
    buffer_load_dwordx4 v[8:11], v3, s[16:19], s12 offen
    s_add_u32 s12, s12, 163840
    buffer_load_dwordx4 v[12:15], v3, s[16:19], s12 offen
    s_add_u32 s12, s12, 163840
    buffer_load_dwordx4 v[16:19], v3, s[16:19], s12 offen
    s_add_u32 s12, s12, 163840
    buffer_load_dwordx4 v[20:23], v3, s[16:19], s12 offen
    s_add_u32 s12, s12, 163840
    buffer_load_dwordx4 v[24:27], v3, s[16:19], s12 offen
    s_add_u32 s12, s12, 163840
    buffer_load_dwordx4 v[28:31], v3, s[16:19], s12 offen
    s_add_u32 s12, s12, 163840
    buffer_load_dwordx4 v[32:35], v3, s[16:19], s12 offen
    s_add_u32 s12, s12, 163840
    buffer_load_dwordx4 v[36:39], v3, s[16:19], s12 offen
    s_add_u32 s12, s12, 163840
    buffer_load_dwordx4 v[40:43], v3, s[16:19], s12 offen
    s_add_u32 s12, s12, 163840
    buffer_load_dwordx4 v[44:47], v3, s[16:19], s12 offen
    s_add_u32 s12, s12, 163840
    buffer_load_dwordx4 v[48:51], v3, s[16:19], s12 offen
    s_add_u32 s12, s12, 163840
    buffer_load_dwordx4 v[52:55], v3, s[16:19], s12 offen
    s_add_u32 s12, s12, 163840
    buffer_load_dwordx4 v[56:59], v3, s[16:19], s12 offen
    s_add_u32 s12, s12, 163840
    buffer_load_dwordx4 v[60:63], v3, s[16:19], s12 offen
    s_add_u32 s12, s12, 163840
    buffer_load_dwordx4 v[64:67], v3, s[16:19], s12 offen
    s_add_u32 s12, s12, 163840
    buffer_load_dwordx4 v[68:71], v3, s[16:19], s12 offen
    v_and_b32 v4, 15, v2
    v_lshrrev_b32 v5, 4, v2
    v_lshlrev_b32 v4, 11, v4
    v_lshl_add_u32 v4, v5, 3, v4
    s_mov_b32 s28, s4
    s_mov_b32 s29, s5
    s_mov_b32 s30, 2621440
    s_mov_b32 s31, 0x20000
    s_add_u32 s36, s10, 0
    s_mul_hi_u32 s13, s36, 0x1999999a
    s_mul_i32 s14, s13, 10
    s_sub_u32 s14, s36, s14
    s_cmp_ge_u32 s14, 5
    s_cselect_b32 s15, 1, 0
    s_mul_i32 s20, s15, 5
    s_sub_u32 s14, s14, s20
    s_and_b32 s20, s13, 3
    s_bfe_u32 s21, s13, 0x10002
    s_lshr_b32 s22, s13, 3
    s_and_b32 s23, s9, 7
    s_lshr_b32 s24, s9, 3
    s_mul_i32 s23, s23, 160
    s_mul_i32 s22, s22, 80
    s_add_u32 s23, s23, s22
    s_lshl_b32 s14, s14, 4
    s_add_u32 s23, s23, s14
    s_lshl_b32 s23, s23, 11
    s_lshl_b32 s24, s24, 10
    s_add_u32 s23, s23, s24
    s_lshl_b32 s21, s21, 9
    s_add_u32 s23, s23, s21
    s_lshl_b32 s20, s20, 7
    s_add_u32 s23, s23, s20
    s_lshl_b32 s15, s15, 6
    s_add_u32 s38, s23, s15
    s_waitcnt vmcnt(15)
    v_lshlrev_b32 v72, 16, v8
    v_and_b32 v73, 0xffff0000, v8
    v_lshlrev_b32 v74, 16, v9
    v_and_b32 v75, 0xffff0000, v9
    v_lshlrev_b32 v76, 16, v10
    v_and_b32 v77, 0xffff0000, v10
    v_lshlrev_b32 v78, 16, v11
    v_and_b32 v79, 0xffff0000, v11
    s_waitcnt vmcnt(14)
    v_lshlrev_b32 v80, 16, v12
    v_and_b32 v81, 0xffff0000, v12
    v_pk_add_f32 v[72:73], v[72:73], v[80:81]
    v_lshlrev_b32 v82, 16, v13
    v_and_b32 v83, 0xffff0000, v13
    v_pk_add_f32 v[74:75], v[74:75], v[82:83]
    v_lshlrev_b32 v80, 16, v14
    v_and_b32 v81, 0xffff0000, v14
    v_pk_add_f32 v[76:77], v[76:77], v[80:81]
    v_lshlrev_b32 v82, 16, v15
    v_and_b32 v83, 0xffff0000, v15
    v_pk_add_f32 v[78:79], v[78:79], v[82:83]
    s_waitcnt vmcnt(13)
    v_lshlrev_b32 v80, 16, v16
    v_and_b32 v81, 0xffff0000, v16
    v_pk_add_f32 v[72:73], v[72:73], v[80:81]
    v_lshlrev_b32 v82, 16, v17
    v_and_b32 v83, 0xffff0000, v17
    v_pk_add_f32 v[74:75], v[74:75], v[82:83]
    v_lshlrev_b32 v80, 16, v18
    v_and_b32 v81, 0xffff0000, v18
    v_pk_add_f32 v[76:77], v[76:77], v[80:81]
    v_lshlrev_b32 v82, 16, v19
    v_and_b32 v83, 0xffff0000, v19
    v_pk_add_f32 v[78:79], v[78:79], v[82:83]
    s_waitcnt vmcnt(12)
    v_lshlrev_b32 v80, 16, v20
    v_and_b32 v81, 0xffff0000, v20
    v_pk_add_f32 v[72:73], v[72:73], v[80:81]
    v_lshlrev_b32 v82, 16, v21
    v_and_b32 v83, 0xffff0000, v21
    v_pk_add_f32 v[74:75], v[74:75], v[82:83]
    v_lshlrev_b32 v80, 16, v22
    v_and_b32 v81, 0xffff0000, v22
    v_pk_add_f32 v[76:77], v[76:77], v[80:81]
    v_lshlrev_b32 v82, 16, v23
    v_and_b32 v83, 0xffff0000, v23
    v_pk_add_f32 v[78:79], v[78:79], v[82:83]
    s_waitcnt vmcnt(11)
    v_lshlrev_b32 v80, 16, v24
    v_and_b32 v81, 0xffff0000, v24
    v_pk_add_f32 v[72:73], v[72:73], v[80:81]
    v_lshlrev_b32 v82, 16, v25
    v_and_b32 v83, 0xffff0000, v25
    v_pk_add_f32 v[74:75], v[74:75], v[82:83]
    v_lshlrev_b32 v80, 16, v26
    v_and_b32 v81, 0xffff0000, v26
    v_pk_add_f32 v[76:77], v[76:77], v[80:81]
    v_lshlrev_b32 v82, 16, v27
    v_and_b32 v83, 0xffff0000, v27
    v_pk_add_f32 v[78:79], v[78:79], v[82:83]
    s_waitcnt vmcnt(10)
    v_lshlrev_b32 v80, 16, v28
    v_and_b32 v81, 0xffff0000, v28
    v_pk_add_f32 v[72:73], v[72:73], v[80:81]
    v_lshlrev_b32 v82, 16, v29
    v_and_b32 v83, 0xffff0000, v29
    v_pk_add_f32 v[74:75], v[74:75], v[82:83]
    v_lshlrev_b32 v80, 16, v30
    v_and_b32 v81, 0xffff0000, v30
    v_pk_add_f32 v[76:77], v[76:77], v[80:81]
    v_lshlrev_b32 v82, 16, v31
    v_and_b32 v83, 0xffff0000, v31
    v_pk_add_f32 v[78:79], v[78:79], v[82:83]
    s_waitcnt vmcnt(9)
    v_lshlrev_b32 v80, 16, v32
    v_and_b32 v81, 0xffff0000, v32
    v_pk_add_f32 v[72:73], v[72:73], v[80:81]
    v_lshlrev_b32 v82, 16, v33
    v_and_b32 v83, 0xffff0000, v33
    v_pk_add_f32 v[74:75], v[74:75], v[82:83]
    v_lshlrev_b32 v80, 16, v34
    v_and_b32 v81, 0xffff0000, v34
    v_pk_add_f32 v[76:77], v[76:77], v[80:81]
    v_lshlrev_b32 v82, 16, v35
    v_and_b32 v83, 0xffff0000, v35
    v_pk_add_f32 v[78:79], v[78:79], v[82:83]
    s_waitcnt vmcnt(8)
    v_lshlrev_b32 v80, 16, v36
    v_and_b32 v81, 0xffff0000, v36
    v_pk_add_f32 v[72:73], v[72:73], v[80:81]
    v_lshlrev_b32 v82, 16, v37
    v_and_b32 v83, 0xffff0000, v37
    v_pk_add_f32 v[74:75], v[74:75], v[82:83]
    v_lshlrev_b32 v80, 16, v38
    v_and_b32 v81, 0xffff0000, v38
    v_pk_add_f32 v[76:77], v[76:77], v[80:81]
    v_lshlrev_b32 v82, 16, v39
    v_and_b32 v83, 0xffff0000, v39
    v_pk_add_f32 v[78:79], v[78:79], v[82:83]
    s_waitcnt vmcnt(7)
    v_lshlrev_b32 v80, 16, v40
    v_and_b32 v81, 0xffff0000, v40
    v_pk_add_f32 v[72:73], v[72:73], v[80:81]
    v_lshlrev_b32 v82, 16, v41
    v_and_b32 v83, 0xffff0000, v41
    v_pk_add_f32 v[74:75], v[74:75], v[82:83]
    v_lshlrev_b32 v80, 16, v42
    v_and_b32 v81, 0xffff0000, v42
    v_pk_add_f32 v[76:77], v[76:77], v[80:81]
    v_lshlrev_b32 v82, 16, v43
    v_and_b32 v83, 0xffff0000, v43
    v_pk_add_f32 v[78:79], v[78:79], v[82:83]
    s_waitcnt vmcnt(6)
    v_lshlrev_b32 v80, 16, v44
    v_and_b32 v81, 0xffff0000, v44
    v_pk_add_f32 v[72:73], v[72:73], v[80:81]
    v_lshlrev_b32 v82, 16, v45
    v_and_b32 v83, 0xffff0000, v45
    v_pk_add_f32 v[74:75], v[74:75], v[82:83]
    v_lshlrev_b32 v80, 16, v46
    v_and_b32 v81, 0xffff0000, v46
    v_pk_add_f32 v[76:77], v[76:77], v[80:81]
    v_lshlrev_b32 v82, 16, v47
    v_and_b32 v83, 0xffff0000, v47
    v_pk_add_f32 v[78:79], v[78:79], v[82:83]
    s_waitcnt vmcnt(5)
    v_lshlrev_b32 v80, 16, v48
    v_and_b32 v81, 0xffff0000, v48
    v_pk_add_f32 v[72:73], v[72:73], v[80:81]
    v_lshlrev_b32 v82, 16, v49
    v_and_b32 v83, 0xffff0000, v49
    v_pk_add_f32 v[74:75], v[74:75], v[82:83]
    v_lshlrev_b32 v80, 16, v50
    v_and_b32 v81, 0xffff0000, v50
    v_pk_add_f32 v[76:77], v[76:77], v[80:81]
    v_lshlrev_b32 v82, 16, v51
    v_and_b32 v83, 0xffff0000, v51
    v_pk_add_f32 v[78:79], v[78:79], v[82:83]
    s_waitcnt vmcnt(4)
    v_lshlrev_b32 v80, 16, v52
    v_and_b32 v81, 0xffff0000, v52
    v_pk_add_f32 v[72:73], v[72:73], v[80:81]
    v_lshlrev_b32 v82, 16, v53
    v_and_b32 v83, 0xffff0000, v53
    v_pk_add_f32 v[74:75], v[74:75], v[82:83]
    v_lshlrev_b32 v80, 16, v54
    v_and_b32 v81, 0xffff0000, v54
    v_pk_add_f32 v[76:77], v[76:77], v[80:81]
    v_lshlrev_b32 v82, 16, v55
    v_and_b32 v83, 0xffff0000, v55
    v_pk_add_f32 v[78:79], v[78:79], v[82:83]
    s_waitcnt vmcnt(3)
    v_lshlrev_b32 v80, 16, v56
    v_and_b32 v81, 0xffff0000, v56
    v_pk_add_f32 v[72:73], v[72:73], v[80:81]
    v_lshlrev_b32 v82, 16, v57
    v_and_b32 v83, 0xffff0000, v57
    v_pk_add_f32 v[74:75], v[74:75], v[82:83]
    v_lshlrev_b32 v80, 16, v58
    v_and_b32 v81, 0xffff0000, v58
    v_pk_add_f32 v[76:77], v[76:77], v[80:81]
    v_lshlrev_b32 v82, 16, v59
    v_and_b32 v83, 0xffff0000, v59
    v_pk_add_f32 v[78:79], v[78:79], v[82:83]
    s_waitcnt vmcnt(2)
    v_lshlrev_b32 v80, 16, v60
    v_and_b32 v81, 0xffff0000, v60
    v_pk_add_f32 v[72:73], v[72:73], v[80:81]
    v_lshlrev_b32 v82, 16, v61
    v_and_b32 v83, 0xffff0000, v61
    v_pk_add_f32 v[74:75], v[74:75], v[82:83]
    v_lshlrev_b32 v80, 16, v62
    v_and_b32 v81, 0xffff0000, v62
    v_pk_add_f32 v[76:77], v[76:77], v[80:81]
    v_lshlrev_b32 v82, 16, v63
    v_and_b32 v83, 0xffff0000, v63
    v_pk_add_f32 v[78:79], v[78:79], v[82:83]
    s_waitcnt vmcnt(1)
    v_lshlrev_b32 v80, 16, v64
    v_and_b32 v81, 0xffff0000, v64
    v_pk_add_f32 v[72:73], v[72:73], v[80:81]
    v_lshlrev_b32 v82, 16, v65
    v_and_b32 v83, 0xffff0000, v65
    v_pk_add_f32 v[74:75], v[74:75], v[82:83]
    v_lshlrev_b32 v80, 16, v66
    v_and_b32 v81, 0xffff0000, v66
    v_pk_add_f32 v[76:77], v[76:77], v[80:81]
    v_lshlrev_b32 v82, 16, v67
    v_and_b32 v83, 0xffff0000, v67
    v_pk_add_f32 v[78:79], v[78:79], v[82:83]
    s_waitcnt vmcnt(0)
    v_lshlrev_b32 v80, 16, v68
    v_and_b32 v81, 0xffff0000, v68
    v_pk_add_f32 v[72:73], v[72:73], v[80:81]
    v_lshlrev_b32 v82, 16, v69
    v_and_b32 v83, 0xffff0000, v69
    v_pk_add_f32 v[74:75], v[74:75], v[82:83]
    v_lshlrev_b32 v80, 16, v70
    v_and_b32 v81, 0xffff0000, v70
    v_pk_add_f32 v[76:77], v[76:77], v[80:81]
    v_lshlrev_b32 v82, 16, v71
    v_and_b32 v83, 0xffff0000, v71
    v_pk_add_f32 v[78:79], v[78:79], v[82:83]
    v_cvt_pk_bf16_f32 v8, v72, v73
    v_cvt_pk_bf16_f32 v9, v74, v75
    v_cvt_pk_bf16_f32 v10, v76, v77
    v_cvt_pk_bf16_f32 v11, v78, v79
    buffer_store_dwordx2 v[8:9], v4, s[28:31], s38 offen
    buffer_store_dwordx2 v[10:11], v4, s[28:31], s38 offen offset:32
L_end_reduce_kernel:
    s_endpgm
K3_END:
.section .rodata,"a"
.p2align 6
.amdhsa_kernel reduce_kernel
  .amdhsa_next_free_vgpr 96
  .amdhsa_next_free_sgpr 64
  .amdhsa_accum_offset 96
  .amdhsa_group_segment_fixed_size 0
  .amdhsa_kernarg_size 104
  .amdhsa_user_sgpr_count 2
  .amdhsa_user_sgpr_kernarg_segment_ptr 1
  .amdhsa_system_sgpr_workgroup_id_x 1
.end_amdhsa_kernel
.text
```
